```python
import torch

def _softmax(x, axis=-1):
    return torch.softmax(x, dim=axis)
def _gelu(x):
    return torch.nn.functional.gelu(x, approximate="tanh")
def _silu(x):
    return torch.nn.functional.silu(x)
def _sigmoid(x):
    return torch.sigmoid(x)
def _layernorm(x, axis=-1, eps=1e-5):
    m = x.mean(dim=axis, keepdim=True)
    v = x.var(dim=axis, keepdim=True, unbiased=False)
    return (x - m) / torch.sqrt(v + eps)
def _scatter_add(tgt, idx, src, axis=0):
    return tgt.clone().index_add_(axis, idx, src)
def _segment_sum(src, seg, n):
    out = torch.zeros((n,) + src.shape[1:], dtype=src.dtype)
    return out.index_add_(0, seg, src)
def _pad(x, pw):
    flat = tuple(v for pair in reversed(pw) for v in pair)
    return torch.nn.functional.pad(x, flat)

kernel_name = 'parallel_sum__mha_block__glu_gated_bilinear__prompt'

def setup_inputs():

    _w = (lambda a: (lambda t: t.to(torch.bfloat16) if t.is_floating_point() else t)(torch.as_tensor(a)))
    def _A_setup():
        B, S, D, H = 1, 2048, 640, 32
        return {
            "x": _w((lambda *s: torch.randn(*s, dtype=torch.bfloat16) * 0.05)(B, S, D)),
            "wqkv": _w((lambda *s: torch.randn(*s, dtype=torch.bfloat16) * 0.05)(D, 3 * D)),
            "wo": _w((lambda *s: torch.randn(*s, dtype=torch.bfloat16) * 0.05)(D, D)),
        }
    _A_in = _A_setup()

    def _B_setup():
        B, S, D, F = 1, 2048, 640, 1536
        return {
            "x": _w((lambda *s: torch.randn(*s, dtype=torch.bfloat16) * 0.05)(B, S, D)),
            "w_gate": _w((lambda *s: torch.randn(*s, dtype=torch.bfloat16) * 0.8)(D, F) * (D ** -0.5)),
            "w_up": _w((lambda *s: torch.randn(*s, dtype=torch.bfloat16) * 0.8)(D, F) * (D ** -0.5)),
            "w_down": _w((lambda *s: torch.randn(*s, dtype=torch.bfloat16) * 0.8)(F, D) * (F ** -0.5)),
        }
    _B_in = _B_setup()

    return {
        "A_x": _A_in["x"],
        "A_wqkv": _A_in["wqkv"],
        "A_wo": _A_in["wo"],
        "B_x": _B_in["x"],
        "B_w_gate": _B_in["w_gate"],
        "B_w_up": _B_in["w_up"],
        "B_w_down": _B_in["w_down"],
    }

def reference(A_x, A_wqkv, A_wo, B_x, B_w_gate, B_w_up, B_w_down):
    def _A_ref(x, wqkv, wo):
        B, S, D = x.shape
        H = 32
        Dh = D // H
        qkv = (lambda x, *d: x.permute(*d))((x @ wqkv).reshape(B, S, 3, H, Dh), 2, 0, 3, 1, 4)
        q, k, v = qkv[0], qkv[1], qkv[2]
        scores = torch.einsum("bhqd,bhkd->bhqk", q, k) * (Dh ** -0.5)
        p = _softmax(scores, axis=-1)
        o = torch.einsum("bhqk,bhkd->bhqd", p, v)
        return (lambda x, *d: x.permute(*d))(o, 0, 2, 1, 3).reshape(B, S, D) @ wo

    def _B_ref(x, w_gate, w_up, w_down):
        g = torch.einsum("bsd,df->bsf", x, w_gate)
        u = torch.einsum("bsd,df->bsf", x, w_up)
        h = g * u
        return torch.einsum("bsf,fd->bsd", h, w_down)

    x = A_x
    xn = _layernorm(x, axis=-1)
    return x + _A_ref(xn, A_wqkv, A_wo) + _B_ref(xn, B_w_gate, B_w_up, B_w_down)
```

```asm
; @launch kernel=parallel_sum__mha_block__glu_gated_bilinear__prompt_kernel grid=(256,1,1) block=(768,1,1) lds=163840
.amdgcn_target "amdgcn-amd-amdhsa--gfx950"
.text
.globl parallel_sum__mha_block__glu_gated_bilinear__prompt_kernel
.p2align 8
.type parallel_sum__mha_block__glu_gated_bilinear__prompt_kernel,@function
parallel_sum__mha_block__glu_gated_bilinear__prompt_kernel:
    s_cmp_ge_u32 s2, 256
    s_cbranch_scc1 z_end
    s_load_dwordx4 s[4:7], s[0:1], 0
    s_load_dwordx2 s[34:35], s[0:1], 72
    v_lshrrev_b32 v2, 6, v0
    v_and_b32 v1, 63, v0
    v_readfirstlane_b32 s20, v2
    s_nop 3
    s_cmp_ge_u32 s20, 8
    s_cbranch_scc1 z_ffn
    s_and_b32 s3, s2, 7
    s_lshr_b32 s23, s2, 3
    s_lshr_b32 s21, s3, 1
    s_lshl_b32 s21, s21, 3
    s_lshr_b32 s31, s23, 2
    s_add_u32 s21, s21, s31
    s_lshr_b32 s36, s31, 2
    s_add_u32 s36, s36, s31
    s_and_b32 s22, s3, 1
    s_lshl_b32 s22, s22, 2
    s_and_b32 s31, s23, 3
    s_add_u32 s22, s22, s31
    v_lshrrev_b32 v2, 3, v0
    v_and_b32 v3, 7, v1
    v_lshlrev_b32 v3, 4, v3
    v_mul_u32_u24 v19, 1280, v2
    v_add_u32_e64 v19, v19, v3
    v_mul_u32_u24 v11, 1296, v2
    v_add3_u32 v11, v11, v3, 64
    v_add_u32 v11, 192, v11
    s_mul_i32 s30, s21, 81920
    s_lshl_b32 s23, s36, 7
    s_add_u32 s31, s30, 1280
    s_add_u32 s30, s30, s23
    v_lshrrev_b32 v4, 4, v1
    v_and_b32 v5, 15, v1
    v_lshlrev_b32 v6, 2, v4
    v_xor_b32 v6, v6, v5
    v_mul_u32_u24 v10, 3840, v4
    v_lshl_add_u32 v10, v6, 4, v10
    s_waitcnt lgkmcnt(0)
    s_mov_b32 s8, s4
    s_mov_b32 s9, s5
    s_mov_b32 s10, 0x280000
    s_mov_b32 s11, 0x00020000
    s_mov_b32 s12, s6
    s_mov_b32 s13, s7
    s_mov_b32 s14, 0x258000
    s_mov_b32 s15, 0x00020000
    s_mov_b32 s16, s34
    s_mov_b32 s17, s35
    s_mov_b32 s18, 0x2d00000
    s_mov_b32 s19, 0x00020000
    s_mov_b32 s85, 46366720
    s_load_dword s84, s[34:35], s85
    buffer_load_dwordx4 v[28:31], v19, s[8:11], s30 offen
    s_add_u32 s30, s30, 128
    s_cmp_ge_u32 s30, s31
    s_cselect_b32 s23, 1280, 0
    s_sub_u32 s30, s30, s23
    buffer_load_dwordx4 v[32:35], v19, s[8:11], s30 offen
    s_add_u32 s30, s30, 128
    s_cmp_ge_u32 s30, s31
    s_cselect_b32 s23, 1280, 0
    s_sub_u32 s30, s30, s23
    buffer_load_dwordx4 v[36:39], v19, s[8:11], s30 offen
    s_add_u32 s30, s30, 128
    s_cmp_ge_u32 s30, s31
    s_cselect_b32 s23, 1280, 0
    s_sub_u32 s30, s30, s23
    buffer_load_dwordx4 v[40:43], v19, s[8:11], s30 offen
    s_add_u32 s30, s30, 128
    s_cmp_ge_u32 s30, s31
    s_cselect_b32 s23, 1280, 0
    s_sub_u32 s30, s30, s23
    buffer_load_dwordx4 v[44:47], v19, s[8:11], s30 offen
    s_add_u32 s30, s30, 128
    s_cmp_ge_u32 s30, s31
    s_cselect_b32 s23, 1280, 0
    s_sub_u32 s30, s30, s23
    buffer_load_dwordx4 v[48:51], v19, s[8:11], s30 offen
    s_add_u32 s30, s30, 128
    s_cmp_ge_u32 s30, s31
    s_cselect_b32 s23, 1280, 0
    s_sub_u32 s30, s30, s23
    buffer_load_dwordx4 v[52:55], v19, s[8:11], s30 offen
    s_add_u32 s30, s30, 128
    s_cmp_ge_u32 s30, s31
    s_cselect_b32 s23, 1280, 0
    s_sub_u32 s30, s30, s23
    buffer_load_dwordx4 v[56:59], v19, s[8:11], s30 offen
    s_add_u32 s30, s30, 128
    s_cmp_ge_u32 s30, s31
    s_cselect_b32 s23, 1280, 0
    s_sub_u32 s30, s30, s23
    buffer_load_dwordx4 v[60:63], v19, s[8:11], s30 offen
    s_add_u32 s30, s30, 128
    s_cmp_ge_u32 s30, s31
    s_cselect_b32 s23, 1280, 0
    s_sub_u32 s30, s30, s23
    buffer_load_dwordx4 v[64:67], v19, s[8:11], s30 offen
    s_cmp_eq_u32 s22, 7
    s_cselect_b32 s47, 1, 2
    v_and_b32 v5, 31, v1
    v_lshrrev_b32_e64 v4, 5, v1
    v_mul_u32_u24 v7, 1296, v5
    v_lshl_add_u32 v7, v4, 4, v7
    v_add_u32 v7, 256, v7
    s_cmp_lt_u32 s20, 4
    s_cbranch_scc1 z1_load
    s_sub_u32 s38, s20, 4
    v_bfe_u32 v2, v1, 2, 2
    v_bfe_u32 v3, v1, 4, 1
    v_lshlrev_b32 v3, 1, v3
    v_bfe_u32 v6, v1, 1, 1
    v_add_u32 v3, v3, v6
    v_xor_b32 v6, s38, v2
    v_lshl_add_u32 v6, v6, 2, v3
    v_lshlrev_b32_e64 v8, 4, v6
    v_lshl_add_u32 v6, v4, 3, v2
    v_lshl_add_u32 v8, v6, 8, v8
    v_and_b32_e64 v6, 1, v1
    v_lshl_add_u32 v8, v6, 3, v8
    v_add_u32 v8, 83200, v8
    v_add_u32 v9, 61440, v8
    v_mov_b32 v12, 0
    v_mov_b32 v13, 0
    v_mov_b32 v14, 0
    v_mov_b32 v15, 0
    v_mov_b32 v16, 0
    v_mov_b32 v17, 0
    v_mov_b32 v18, 0
    v_mov_b32 v19, 0
    s_lshl_b32 s26, s22, 8
    s_lshl_b32 s31, s38, 5
    s_add_u32 s26, s26, s31
    s_cmp_ge_u32 s22, 5
    s_cbranch_scc1 z1_vadr
    s_add_u32 s23, s26, 0
    s_mov_b32 s46, 196608
    s_mov_b32 s42, 3072
    s_cmp_lt_u32 s23, 640
    s_cselect_b32 s46, 81920, s46
    s_cselect_b32 s42, 1280, s42
    s_cselect_b32 s40, 0, 4194304
    s_cselect_b32 s44, 0x3ea52b5c, 1.0
    s_cselect_b32 s31, 0, 160
    s_lshr_b32 s23, s23, 2
    s_sub_u32 s23, s23, s31
    v_add_u32_e64 v2, s23, v4
    v_mul_u32_u24 v3, 205, v2
    v_lshrrev_b32 v3, 10, v3
    v_mul_u32_u24 v6, 5, v3
    v_sub_u32 v2, v2, v6
    v_and_b32 v6, 1, v3
    v_sub_u32 v2, v2, v6
    v_min_u32 v2, 4, v2
    v_mul_lo_u32 v12, v3, s46
    v_lshrrev_b32_e64 v3, 1, v2
    v_lshl_add_u32 v12, v3, 9, v12
    v_and_b32_e64 v6, 1, v2
    v_lshl_add_u32 v12, v6, 3, v12
    v_lshrrev_b32 v3, 1, v3
    v_sub_u32 v3, 4, v3
    v_lshlrev_b32 v3, v3, v5
    v_add_u32 v12, v12, v3
    v_add_u32 v2, s23, v4
    v_add_u32 v2, 2, v2
    v_mul_u32_u24 v3, 205, v2
    v_lshrrev_b32 v3, 10, v3
    v_mul_u32_u24 v6, 5, v3
    v_sub_u32 v2, v2, v6
    v_and_b32 v6, 1, v3
    v_sub_u32 v2, v2, v6
    v_min_u32 v2, 4, v2
    v_mul_lo_u32 v13, v3, s46
    v_lshrrev_b32_e64 v3, 1, v2
    v_lshl_add_u32 v13, v3, 9, v13
    v_and_b32_e64 v6, 1, v2
    v_lshl_add_u32 v13, v6, 3, v13
    v_lshrrev_b32 v3, 1, v3
    v_sub_u32 v3, 4, v3
    v_lshlrev_b32 v3, v3, v5
    v_add_u32 v13, v13, v3
    v_add_u32 v2, s23, v4
    v_add_u32 v2, 4, v2
    v_mul_u32_u24 v3, 205, v2
    v_lshrrev_b32 v3, 10, v3
    v_mul_u32_u24 v6, 5, v3
    v_sub_u32 v2, v2, v6
    v_and_b32 v6, 1, v3
    v_sub_u32 v2, v2, v6
    v_min_u32 v2, 4, v2
    v_mul_lo_u32 v14, v3, s46
    v_lshrrev_b32_e64 v3, 1, v2
    v_lshl_add_u32 v14, v3, 9, v14
    v_and_b32_e64 v6, 1, v2
    v_lshl_add_u32 v14, v6, 3, v14
    v_lshrrev_b32 v3, 1, v3
    v_sub_u32 v3, 4, v3
    v_lshlrev_b32 v3, v3, v5
    v_add_u32 v14, v14, v3
    v_add_u32 v2, s23, v4
    v_add_u32 v2, 6, v2
    v_mul_u32_u24 v3, 205, v2
    v_lshrrev_b32 v3, 10, v3
    v_mul_u32_u24 v6, 5, v3
    v_sub_u32 v2, v2, v6
    v_and_b32 v6, 1, v3
    v_sub_u32 v2, v2, v6
    v_min_u32 v2, 4, v2
    v_mul_lo_u32 v15, v3, s46
    v_lshrrev_b32_e64 v3, 1, v2
    v_lshl_add_u32 v15, v3, 9, v15
    v_and_b32_e64 v6, 1, v2
    v_lshl_add_u32 v15, v6, 3, v15
    v_lshrrev_b32 v3, 1, v3
    v_sub_u32 v3, 4, v3
    v_lshlrev_b32 v3, v3, v5
    v_add_u32 v15, v15, v3
    s_add_u32 s23, s26, 128
    s_mov_b32 s46, 196608
    s_mov_b32 s43, 3072
    s_cmp_lt_u32 s23, 640
    s_cselect_b32 s46, 81920, s46
    s_cselect_b32 s43, 1280, s43
    s_cselect_b32 s41, 0, 4194304
    s_cselect_b32 s45, 0x3ea52b5c, 1.0
    s_cselect_b32 s31, 0, 160
    s_lshr_b32 s23, s23, 2
    s_sub_u32 s23, s23, s31
    v_add_u32_e64 v2, s23, v4
    v_mul_u32_u24 v3, 205, v2
    v_lshrrev_b32 v3, 10, v3
    v_mul_u32_u24 v6, 5, v3
    v_sub_u32 v2, v2, v6
    v_and_b32 v6, 1, v3
    v_sub_u32 v2, v2, v6
    v_min_u32 v2, 4, v2
    v_mul_lo_u32 v16, v3, s46
    v_lshrrev_b32_e64 v3, 1, v2
    v_lshl_add_u32 v16, v3, 9, v16
    v_and_b32_e64 v6, 1, v2
    v_lshl_add_u32 v16, v6, 3, v16
    v_lshrrev_b32 v3, 1, v3
    v_sub_u32 v3, 4, v3
    v_lshlrev_b32 v3, v3, v5
    v_add_u32 v16, v16, v3
    v_add_u32 v2, s23, v4
    v_add_u32 v2, 2, v2
    v_mul_u32_u24 v3, 205, v2
    v_lshrrev_b32 v3, 10, v3
    v_mul_u32_u24 v6, 5, v3
    v_sub_u32 v2, v2, v6
    v_and_b32 v6, 1, v3
    v_sub_u32 v2, v2, v6
    v_min_u32 v2, 4, v2
    v_mul_lo_u32 v17, v3, s46
    v_lshrrev_b32_e64 v3, 1, v2
    v_lshl_add_u32 v17, v3, 9, v17
    v_and_b32_e64 v6, 1, v2
    v_lshl_add_u32 v17, v6, 3, v17
    v_lshrrev_b32 v3, 1, v3
    v_sub_u32 v3, 4, v3
    v_lshlrev_b32 v3, v3, v5
    v_add_u32 v17, v17, v3
    v_add_u32 v2, s23, v4
    v_add_u32 v2, 4, v2
    v_mul_u32_u24 v3, 205, v2
    v_lshrrev_b32 v3, 10, v3
    v_mul_u32_u24 v6, 5, v3
    v_sub_u32 v2, v2, v6
    v_and_b32 v6, 1, v3
    v_sub_u32 v2, v2, v6
    v_min_u32 v2, 4, v2
    v_mul_lo_u32 v18, v3, s46
    v_lshrrev_b32_e64 v3, 1, v2
    v_lshl_add_u32 v18, v3, 9, v18
    v_and_b32_e64 v6, 1, v2
    v_lshl_add_u32 v18, v6, 3, v18
    v_lshrrev_b32 v3, 1, v3
    v_sub_u32 v3, 4, v3
    v_lshlrev_b32 v3, v3, v5
    v_add_u32 v18, v18, v3
    v_add_u32 v2, s23, v4
    v_add_u32 v2, 6, v2
    v_mul_u32_u24 v3, 205, v2
    v_lshrrev_b32 v3, 10, v3
    v_mul_u32_u24 v6, 5, v3
    v_sub_u32 v2, v2, v6
    v_and_b32 v6, 1, v3
    v_sub_u32 v2, v2, v6
    v_min_u32 v2, 4, v2
    v_mul_lo_u32 v19, v3, s46
    v_lshrrev_b32_e64 v3, 1, v2
    v_lshl_add_u32 v19, v3, 9, v19
    v_and_b32_e64 v6, 1, v2
    v_lshl_add_u32 v19, v6, 3, v19
    v_lshrrev_b32 v3, 1, v3
    v_sub_u32 v3, 4, v3
    v_lshlrev_b32 v3, v3, v5
    v_add_u32_e64 v19, v19, v3
    s_branch z1_adrdone
z1_vadr:
    s_mov_b32 s46, 196608
    s_sub_u32 s23, s26, 1280
    s_mov_b32 s42, 3072
    s_mov_b32 s40, 4195584
    s_mov_b32 s44, 1.0
    v_add_u32 v2, s23, v5
    v_mul_u32_u24 v3, 3277, v2
    v_lshrrev_b32 v3, 16, v3
    v_mul_u32_u24 v6, 20, v3
    v_sub_u32_e64 v2, v2, v6
    v_mul_lo_u32 v12, v3, s46
    v_lshl_add_u32 v2, v2, 1, v4
    v_lshl_add_u32 v12, v2, 4, v12
    s_mov_b32 s43, 3072
    s_mov_b32 s41, 4195584
    s_mov_b32 s45, 1.0
    v_add_u32 v2, s23, v5
    v_add_u32 v2, 128, v2
    v_mul_u32_u24 v3, 3277, v2
    v_lshrrev_b32 v3, 16, v3
    v_mul_u32_u24 v6, 20, v3
    v_sub_u32_e64 v2, v2, v6
    v_mul_lo_u32 v16, v3, s46
    v_lshl_add_u32 v2, v2, 1, v4
    v_lshl_add_u32 v16, v2, 4, v16
z1_adrdone:
    s_lshl_b32 s23, s21, 1
    s_mul_i32 s23, s23, s42
    s_add_u32 s40, s40, s23
    s_lshl_b32 s23, s21, 1
    s_mul_i32 s23, s23, s43
    s_add_u32 s41, s41, s23
    v_mov_b32 v21, 0x3f803f80
    v_mov_b32 v22, 0x00003f80
    v_mov_b32 v23, 0x3f800000
    v_mov_b32 v24, 0
    v_mov_b32 v25, 0
    v_mov_b32 v26, 0
    v_mov_b32 v27, 0
    s_waitcnt vmcnt(9)
    v_dot2c_f32_bf16 v24, v28, v21
    v_dot2c_f32_bf16 v25, v29, v21
    v_dot2c_f32_bf16 v26, v30, v21
    v_dot2c_f32_bf16 v27, v31, v21
    s_waitcnt vmcnt(8)
    v_dot2c_f32_bf16 v24, v32, v21
    v_dot2c_f32_bf16 v25, v33, v21
    v_dot2c_f32_bf16 v26, v34, v21
    v_dot2c_f32_bf16 v27, v35, v21
    s_waitcnt vmcnt(7)
    v_dot2c_f32_bf16 v24, v36, v21
    v_dot2c_f32_bf16 v25, v37, v21
    v_dot2c_f32_bf16 v26, v38, v21
    v_dot2c_f32_bf16 v27, v39, v21
    s_waitcnt vmcnt(6)
    v_dot2c_f32_bf16 v24, v40, v21
    v_dot2c_f32_bf16 v25, v41, v21
    v_dot2c_f32_bf16 v26, v42, v21
    v_dot2c_f32_bf16 v27, v43, v21
    s_waitcnt vmcnt(5)
    v_dot2c_f32_bf16 v24, v44, v21
    v_dot2c_f32_bf16 v25, v45, v21
    v_dot2c_f32_bf16 v26, v46, v21
    v_dot2c_f32_bf16 v27, v47, v21
    s_waitcnt vmcnt(4)
    v_dot2c_f32_bf16 v24, v48, v21
    v_dot2c_f32_bf16 v25, v49, v21
    v_dot2c_f32_bf16 v26, v50, v21
    v_dot2c_f32_bf16 v27, v51, v21
    s_waitcnt vmcnt(3)
    v_dot2c_f32_bf16 v24, v52, v21
    v_dot2c_f32_bf16 v25, v53, v21
    v_dot2c_f32_bf16 v26, v54, v21
    v_dot2c_f32_bf16 v27, v55, v21
    s_waitcnt vmcnt(2)
    v_dot2c_f32_bf16 v24, v56, v21
    v_dot2c_f32_bf16 v25, v57, v21
    v_dot2c_f32_bf16 v26, v58, v21
    v_dot2c_f32_bf16 v27, v59, v21
    s_waitcnt vmcnt(1)
    v_dot2c_f32_bf16 v24, v60, v21
    v_dot2c_f32_bf16 v25, v61, v21
    v_dot2c_f32_bf16 v26, v62, v21
    v_dot2c_f32_bf16 v27, v63, v21
    s_waitcnt vmcnt(0)
    v_dot2c_f32_bf16 v24, v64, v21
    v_dot2c_f32_bf16 v25, v65, v21
    v_dot2c_f32_bf16 v26, v66, v21
    v_dot2c_f32_bf16 v27, v67, v21
    s_nop 2
    v_add_f32 v24, v24, v25
    v_add_f32 v26, v26, v27
    v_add_f32 v20, v24, v26
    s_nop 1
    v_add_f32 v20, v20, v20 quad_perm:[1,0,3,2] row_mask:0xf bank_mask:0xf
    s_nop 1
    v_add_f32 v20, v20, v20 quad_perm:[2,3,0,1] row_mask:0xf bank_mask:0xf
    s_nop 1
    v_add_f32 v20, v20, v20 row_half_mirror row_mask:0xf bank_mask:0xf
    v_mul_f32 v20, 0xbacccccd, v20
    v_dot2_f32_bf16 v68, v28, v22, v20
    v_dot2_f32_bf16 v69, v28, v23, v20
    v_dot2_f32_bf16 v70, v29, v22, v20
    v_dot2_f32_bf16 v71, v29, v23, v20
    v_dot2_f32_bf16 v72, v30, v22, v20
    v_dot2_f32_bf16 v73, v30, v23, v20
    v_dot2_f32_bf16 v74, v31, v22, v20
    v_dot2_f32_bf16 v75, v31, v23, v20
    v_dot2_f32_bf16 v76, v32, v22, v20
    v_dot2_f32_bf16 v77, v32, v23, v20
    v_dot2_f32_bf16 v78, v33, v22, v20
    v_dot2_f32_bf16 v79, v33, v23, v20
    v_dot2_f32_bf16 v80, v34, v22, v20
    v_dot2_f32_bf16 v81, v34, v23, v20
    v_dot2_f32_bf16 v82, v35, v22, v20
    v_dot2_f32_bf16 v83, v35, v23, v20
    v_cvt_pk_bf16_f32 v28, v68, v69
    v_cvt_pk_bf16_f32 v29, v70, v71
    v_cvt_pk_bf16_f32 v30, v72, v73
    v_cvt_pk_bf16_f32 v31, v74, v75
    ds_write_b128 v11, v[28:31] offset:0
    v_dot2_f32_bf16 v84, v36, v22, v20
    v_dot2_f32_bf16 v85, v36, v23, v20
    v_dot2_f32_bf16 v86, v37, v22, v20
    v_dot2_f32_bf16 v87, v37, v23, v20
    v_dot2_f32_bf16 v88, v38, v22, v20
    v_dot2_f32_bf16 v89, v38, v23, v20
    v_dot2_f32_bf16 v90, v39, v22, v20
    v_dot2_f32_bf16 v91, v39, v23, v20
    v_cvt_pk_bf16_f32 v32, v76, v77
    v_cvt_pk_bf16_f32 v33, v78, v79
    v_cvt_pk_bf16_f32 v34, v80, v81
    v_cvt_pk_bf16_f32 v35, v82, v83
    ds_write_b128 v11, v[32:35] offset:128
    v_dot2_f32_bf16 v92, v40, v22, v20
    v_dot2_f32_bf16 v93, v40, v23, v20
    v_dot2_f32_bf16 v94, v41, v22, v20
    v_dot2_f32_bf16 v95, v41, v23, v20
    v_dot2_f32_bf16 v96, v42, v22, v20
    v_dot2_f32_bf16 v97, v42, v23, v20
    v_dot2_f32_bf16 v98, v43, v22, v20
    v_dot2_f32_bf16 v99, v43, v23, v20
    v_cvt_pk_bf16_f32 v36, v84, v85
    v_cvt_pk_bf16_f32 v37, v86, v87
    v_cvt_pk_bf16_f32 v38, v88, v89
    v_cvt_pk_bf16_f32 v39, v90, v91
    ds_write_b128 v11, v[36:39] offset:256
    v_dot2_f32_bf16 v100, v44, v22, v20
    v_dot2_f32_bf16 v101, v44, v23, v20
    v_dot2_f32_bf16 v102, v45, v22, v20
    v_dot2_f32_bf16 v103, v45, v23, v20
    v_dot2_f32_bf16 v104, v46, v22, v20
    v_dot2_f32_bf16 v105, v46, v23, v20
    v_dot2_f32_bf16 v106, v47, v22, v20
    v_dot2_f32_bf16 v107, v47, v23, v20
    v_cvt_pk_bf16_f32 v40, v92, v93
    v_cvt_pk_bf16_f32 v41, v94, v95
    v_cvt_pk_bf16_f32 v42, v96, v97
    v_cvt_pk_bf16_f32 v43, v98, v99
    ds_write_b128 v11, v[40:43] offset:384
    v_dot2_f32_bf16 v108, v48, v22, v20
    v_dot2_f32_bf16 v109, v48, v23, v20
    v_dot2_f32_bf16 v110, v49, v22, v20
    v_dot2_f32_bf16 v111, v49, v23, v20
    v_dot2_f32_bf16 v112, v50, v22, v20
    v_dot2_f32_bf16 v113, v50, v23, v20
    v_dot2_f32_bf16 v114, v51, v22, v20
    v_dot2_f32_bf16 v115, v51, v23, v20
    v_cvt_pk_bf16_f32 v44, v100, v101
    v_cvt_pk_bf16_f32 v45, v102, v103
    v_cvt_pk_bf16_f32 v46, v104, v105
    v_cvt_pk_bf16_f32 v47, v106, v107
    ds_write_b128 v11, v[44:47] offset:512
    v_dot2_f32_bf16 v116, v52, v22, v20
    v_dot2_f32_bf16 v117, v52, v23, v20
    v_dot2_f32_bf16 v118, v53, v22, v20
    v_dot2_f32_bf16 v119, v53, v23, v20
    v_dot2_f32_bf16 v120, v54, v22, v20
    v_dot2_f32_bf16 v121, v54, v23, v20
    v_dot2_f32_bf16 v122, v55, v22, v20
    v_dot2_f32_bf16 v123, v55, v23, v20
    v_cvt_pk_bf16_f32 v48, v108, v109
    v_cvt_pk_bf16_f32 v49, v110, v111
    v_cvt_pk_bf16_f32 v50, v112, v113
    v_cvt_pk_bf16_f32 v51, v114, v115
    ds_write_b128 v11, v[48:51] offset:640
    v_dot2_f32_bf16 v124, v56, v22, v20
    v_dot2_f32_bf16 v125, v56, v23, v20
    v_dot2_f32_bf16 v126, v57, v22, v20
    v_dot2_f32_bf16 v127, v57, v23, v20
    v_dot2_f32_bf16 v128, v58, v22, v20
    v_dot2_f32_bf16 v129, v58, v23, v20
    v_dot2_f32_bf16 v130, v59, v22, v20
    v_dot2_f32_bf16 v131, v59, v23, v20
    v_cvt_pk_bf16_f32 v52, v116, v117
    v_cvt_pk_bf16_f32 v53, v118, v119
    v_cvt_pk_bf16_f32 v54, v120, v121
    v_cvt_pk_bf16_f32 v55, v122, v123
    ds_write_b128 v11, v[52:55] offset:768
    v_dot2_f32_bf16 v132, v60, v22, v20
    v_dot2_f32_bf16 v133, v60, v23, v20
    v_dot2_f32_bf16 v134, v61, v22, v20
    v_dot2_f32_bf16 v135, v61, v23, v20
    v_dot2_f32_bf16 v136, v62, v22, v20
    v_dot2_f32_bf16 v137, v62, v23, v20
    v_dot2_f32_bf16 v138, v63, v22, v20
    v_dot2_f32_bf16 v139, v63, v23, v20
    v_cvt_pk_bf16_f32 v56, v124, v125
    v_cvt_pk_bf16_f32 v57, v126, v127
    v_cvt_pk_bf16_f32 v58, v128, v129
    v_cvt_pk_bf16_f32 v59, v130, v131
    ds_write_b128 v11, v[56:59] offset:896
    v_dot2_f32_bf16 v140, v64, v22, v20
    v_dot2_f32_bf16 v141, v64, v23, v20
    v_dot2_f32_bf16 v142, v65, v22, v20
    v_dot2_f32_bf16 v143, v65, v23, v20
    v_dot2_f32_bf16 v144, v66, v22, v20
    v_dot2_f32_bf16 v145, v66, v23, v20
    v_dot2_f32_bf16 v146, v67, v22, v20
    v_dot2_f32_bf16 v147, v67, v23, v20
    v_cvt_pk_bf16_f32 v60, v132, v133
    v_cvt_pk_bf16_f32 v61, v134, v135
    v_cvt_pk_bf16_f32 v62, v136, v137
    v_cvt_pk_bf16_f32 v63, v138, v139
    ds_write_b128 v11, v[60:63] offset:1024
    v_mov_b32 v24, 0
    v_mov_b32 v25, 0
    v_mov_b32 v26, 0
    v_mov_b32 v27, 0
    v_cvt_pk_bf16_f32 v64, v140, v141
    v_cvt_pk_bf16_f32 v65, v142, v143
    v_cvt_pk_bf16_f32 v66, v144, v145
    v_cvt_pk_bf16_f32 v67, v146, v147
    ds_write_b128 v11, v[64:67] offset:1152
    v_fmac_f32 v24, v68, v68
    v_fmac_f32 v25, v69, v69
    v_fmac_f32 v26, v70, v70
    v_fmac_f32 v27, v71, v71
    v_fmac_f32 v24, v72, v72
    v_fmac_f32 v25, v73, v73
    v_fmac_f32 v26, v74, v74
    v_fmac_f32 v27, v75, v75
    v_fmac_f32 v24, v76, v76
    v_fmac_f32 v25, v77, v77
    v_fmac_f32 v26, v78, v78
    v_fmac_f32 v27, v79, v79
    v_fmac_f32 v24, v80, v80
    v_fmac_f32 v25, v81, v81
    v_fmac_f32 v26, v82, v82
    v_fmac_f32 v27, v83, v83
    v_fmac_f32 v24, v84, v84
    v_fmac_f32 v25, v85, v85
    v_fmac_f32 v26, v86, v86
    v_fmac_f32 v27, v87, v87
    v_fmac_f32 v24, v88, v88
    v_fmac_f32 v25, v89, v89
    v_fmac_f32 v26, v90, v90
    v_fmac_f32 v27, v91, v91
    v_fmac_f32 v24, v92, v92
    v_fmac_f32 v25, v93, v93
    v_fmac_f32 v26, v94, v94
    v_fmac_f32 v27, v95, v95
    v_fmac_f32 v24, v96, v96
    v_fmac_f32 v25, v97, v97
    v_fmac_f32 v26, v98, v98
    v_fmac_f32 v27, v99, v99
    v_fmac_f32 v24, v100, v100
    v_fmac_f32 v25, v101, v101
    v_fmac_f32 v26, v102, v102
    v_fmac_f32 v27, v103, v103
    v_fmac_f32 v24, v104, v104
    v_fmac_f32 v25, v105, v105
    v_fmac_f32 v26, v106, v106
    v_fmac_f32 v27, v107, v107
    v_fmac_f32 v24, v108, v108
    v_fmac_f32 v25, v109, v109
    v_fmac_f32 v26, v110, v110
    v_fmac_f32 v27, v111, v111
    v_fmac_f32 v24, v112, v112
    v_fmac_f32 v25, v113, v113
    v_fmac_f32 v26, v114, v114
    v_fmac_f32 v27, v115, v115
    v_fmac_f32 v24, v116, v116
    v_fmac_f32 v25, v117, v117
    v_fmac_f32 v26, v118, v118
    v_fmac_f32 v27, v119, v119
    v_fmac_f32 v24, v120, v120
    v_fmac_f32 v25, v121, v121
    v_fmac_f32 v26, v122, v122
    v_fmac_f32 v27, v123, v123
    v_fmac_f32 v24, v124, v124
    v_fmac_f32 v25, v125, v125
    v_fmac_f32 v26, v126, v126
    v_fmac_f32 v27, v127, v127
    v_fmac_f32 v24, v128, v128
    v_fmac_f32 v25, v129, v129
    v_fmac_f32 v26, v130, v130
    v_fmac_f32 v27, v131, v131
    v_fmac_f32 v24, v132, v132
    v_fmac_f32 v25, v133, v133
    v_fmac_f32 v26, v134, v134
    v_fmac_f32 v27, v135, v135
    v_fmac_f32 v24, v136, v136
    v_fmac_f32 v25, v137, v137
    v_fmac_f32 v26, v138, v138
    v_fmac_f32 v27, v139, v139
    v_fmac_f32 v24, v140, v140
    v_fmac_f32 v25, v141, v141
    v_fmac_f32 v26, v142, v142
    v_fmac_f32 v27, v143, v143
    v_fmac_f32 v24, v144, v144
    v_fmac_f32 v25, v145, v145
    v_fmac_f32 v26, v146, v146
    v_fmac_f32 v27, v147, v147
    v_add_f32 v24, v24, v25
    v_add_f32 v26, v26, v27
    v_add_f32 v20, v24, v26
    s_nop 1
    v_add_f32 v20, v20, v20 quad_perm:[1,0,3,2] row_mask:0xf bank_mask:0xf
    s_nop 1
    v_add_f32 v20, v20, v20 quad_perm:[2,3,0,1] row_mask:0xf bank_mask:0xf
    s_nop 1
    v_add_f32 v20, v20, v20 row_half_mirror row_mask:0xf bank_mask:0xf
    v_mov_b32 v2, 0x3727c5ac
    v_fmac_f32 v2, 0x3acccccd, v20
    v_rsq_f32 v2, v2
    v_lshrrev_b32 v3, 3, v0
    v_lshlrev_b32_e64 v3, 2, v3
    ds_write_b32 v3, v2 offset:0
    s_waitcnt lgkmcnt(0)
    s_cmp_ge_u32 s22, 5
    s_cbranch_scc1 z1_vmain
    s_barrier
    v_and_b32 v5, 31, v1
    v_lshlrev_b32 v5, 2, v5
    ds_read_b32 v20, v5 offset:0
    ds_read_b32 v21, v5 offset:128
    ds_read_b128 v[28:31], v7 offset:0
    ds_read_b64_tr_b16 v[36:37], v8 offset:0
    ds_read_b64_tr_b16 v[38:39], v8 offset:1024
    ds_read_b128 v[32:35], v7 offset:41472
    ds_read_b128 v[40:43], v7 offset:32
    ds_read_b64_tr_b16 v[48:49], v8 offset:4096
    ds_read_b64_tr_b16 v[50:51], v8 offset:5120
    ds_read_b128 v[44:47], v7 offset:41504
    s_waitcnt lgkmcnt(5)
    v_mfma_f32_32x32x16_bf16 v[68:83], v[36:39], v[28:31], 0
    ds_read_b128 v[52:55], v7 offset:64
    ds_read_b64_tr_b16 v[60:61], v8 offset:8192
    s_waitcnt lgkmcnt(6)
    v_mfma_f32_32x32x16_bf16 v[84:99], v[36:39], v[32:35], 0
    ds_read_b64_tr_b16 v[62:63], v8 offset:9216
    ds_read_b128 v[56:59], v7 offset:41536
    s_waitcnt lgkmcnt(5)
    v_mfma_f32_32x32x16_bf16 v[68:83], v[48:51], v[40:43], v[68:83]
    ds_read_b128 v[28:31], v7 offset:96
    ds_read_b64_tr_b16 v[36:37], v8 offset:12288
    s_waitcnt lgkmcnt(6)
    v_mfma_f32_32x32x16_bf16 v[84:99], v[48:51], v[44:47], v[84:99]
    ds_read_b64_tr_b16 v[38:39], v8 offset:13312
    ds_read_b128 v[32:35], v7 offset:41568
    s_waitcnt lgkmcnt(5)
    v_mfma_f32_32x32x16_bf16 v[68:83], v[60:63], v[52:55], v[68:83]
    ds_read_b128 v[40:43], v7 offset:128
    ds_read_b64_tr_b16 v[48:49], v8 offset:16384
    s_waitcnt lgkmcnt(6)
    v_mfma_f32_32x32x16_bf16 v[84:99], v[60:63], v[56:59], v[84:99]
    ds_read_b64_tr_b16 v[50:51], v8 offset:17408
    ds_read_b128 v[44:47], v7 offset:41600
    s_waitcnt lgkmcnt(5)
    v_mfma_f32_32x32x16_bf16 v[68:83], v[36:39], v[28:31], v[68:83]
    ds_read_b128 v[52:55], v7 offset:160
    ds_read_b64_tr_b16 v[60:61], v8 offset:20480
    s_waitcnt lgkmcnt(6)
    v_mfma_f32_32x32x16_bf16 v[84:99], v[36:39], v[32:35], v[84:99]
    ds_read_b64_tr_b16 v[62:63], v8 offset:21504
    ds_read_b128 v[56:59], v7 offset:41632
    s_barrier
    s_waitcnt lgkmcnt(5)
    v_mfma_f32_32x32x16_bf16 v[68:83], v[48:51], v[40:43], v[68:83]
    ds_read_b128 v[28:31], v7 offset:192
    ds_read_b64_tr_b16 v[36:37], v8 offset:24576
    s_waitcnt lgkmcnt(6)
    v_mfma_f32_32x32x16_bf16 v[84:99], v[48:51], v[44:47], v[84:99]
    ds_read_b64_tr_b16 v[38:39], v8 offset:25600
    ds_read_b128 v[32:35], v7 offset:41664
    s_waitcnt lgkmcnt(5)
    v_mfma_f32_32x32x16_bf16 v[68:83], v[60:63], v[52:55], v[68:83]
    ds_read_b128 v[40:43], v7 offset:224
    ds_read_b64_tr_b16 v[48:49], v8 offset:28672
    s_waitcnt lgkmcnt(6)
    v_mfma_f32_32x32x16_bf16 v[84:99], v[60:63], v[56:59], v[84:99]
    ds_read_b64_tr_b16 v[50:51], v8 offset:29696
    ds_read_b128 v[44:47], v7 offset:41696
    s_waitcnt lgkmcnt(5)
    v_mfma_f32_32x32x16_bf16 v[68:83], v[36:39], v[28:31], v[68:83]
    ds_read_b128 v[52:55], v7 offset:256
    ds_read_b64_tr_b16 v[60:61], v8 offset:32768
    s_waitcnt lgkmcnt(6)
    v_mfma_f32_32x32x16_bf16 v[84:99], v[36:39], v[32:35], v[84:99]
    ds_read_b64_tr_b16 v[62:63], v8 offset:33792
    ds_read_b128 v[56:59], v7 offset:41728
    s_waitcnt lgkmcnt(5)
    v_mfma_f32_32x32x16_bf16 v[68:83], v[48:51], v[40:43], v[68:83]
    ds_read_b128 v[28:31], v7 offset:288
    ds_read_b64_tr_b16 v[36:37], v8 offset:36864
    s_waitcnt lgkmcnt(6)
    v_mfma_f32_32x32x16_bf16 v[84:99], v[48:51], v[44:47], v[84:99]
    ds_read_b64_tr_b16 v[38:39], v8 offset:37888
    ds_read_b128 v[32:35], v7 offset:41760
    s_barrier
    s_waitcnt lgkmcnt(5)
    v_mfma_f32_32x32x16_bf16 v[68:83], v[60:63], v[52:55], v[68:83]
    ds_read_b128 v[40:43], v7 offset:320
    ds_read_b64_tr_b16 v[48:49], v8 offset:40960
    s_waitcnt lgkmcnt(6)
    v_mfma_f32_32x32x16_bf16 v[84:99], v[60:63], v[56:59], v[84:99]
    ds_read_b64_tr_b16 v[50:51], v8 offset:41984
    ds_read_b128 v[44:47], v7 offset:41792
    s_waitcnt lgkmcnt(5)
    v_mfma_f32_32x32x16_bf16 v[68:83], v[36:39], v[28:31], v[68:83]
    ds_read_b128 v[52:55], v7 offset:352
    ds_read_b64_tr_b16 v[60:61], v8 offset:45056
    s_waitcnt lgkmcnt(6)
    v_mfma_f32_32x32x16_bf16 v[84:99], v[36:39], v[32:35], v[84:99]
    ds_read_b64_tr_b16 v[62:63], v8 offset:46080
    ds_read_b128 v[56:59], v7 offset:41824
    s_waitcnt lgkmcnt(5)
    v_mfma_f32_32x32x16_bf16 v[68:83], v[48:51], v[40:43], v[68:83]
    ds_read_b128 v[28:31], v7 offset:384
    ds_read_b64_tr_b16 v[36:37], v8 offset:49152
    s_waitcnt lgkmcnt(6)
    v_mfma_f32_32x32x16_bf16 v[84:99], v[48:51], v[44:47], v[84:99]
    ds_read_b64_tr_b16 v[38:39], v8 offset:50176
    ds_read_b128 v[32:35], v7 offset:41856
    s_waitcnt lgkmcnt(5)
    v_mfma_f32_32x32x16_bf16 v[68:83], v[60:63], v[52:55], v[68:83]
    ds_read_b128 v[40:43], v7 offset:416
    ds_read_b64_tr_b16 v[48:49], v8 offset:53248
    s_waitcnt lgkmcnt(6)
    v_mfma_f32_32x32x16_bf16 v[84:99], v[60:63], v[56:59], v[84:99]
    ds_read_b64_tr_b16 v[50:51], v8 offset:54272
    ds_read_b128 v[44:47], v7 offset:41888
    s_barrier
    s_waitcnt lgkmcnt(5)
    v_mfma_f32_32x32x16_bf16 v[68:83], v[36:39], v[28:31], v[68:83]
    ds_read_b128 v[52:55], v7 offset:448
    ds_read_b64_tr_b16 v[60:61], v8 offset:57344
    s_waitcnt lgkmcnt(6)
    v_mfma_f32_32x32x16_bf16 v[84:99], v[36:39], v[32:35], v[84:99]
    ds_read_b64_tr_b16 v[62:63], v8 offset:58368
    ds_read_b128 v[56:59], v7 offset:41920
    s_waitcnt lgkmcnt(5)
    v_mfma_f32_32x32x16_bf16 v[68:83], v[48:51], v[40:43], v[68:83]
    ds_read_b128 v[28:31], v7 offset:480
    ds_read_b64_tr_b16 v[36:37], v9 offset:0
    s_waitcnt lgkmcnt(6)
    v_mfma_f32_32x32x16_bf16 v[84:99], v[48:51], v[44:47], v[84:99]
    ds_read_b64_tr_b16 v[38:39], v9 offset:1024
    ds_read_b128 v[32:35], v7 offset:41952
    s_waitcnt lgkmcnt(5)
    v_mfma_f32_32x32x16_bf16 v[68:83], v[60:63], v[52:55], v[68:83]
    ds_read_b128 v[40:43], v7 offset:512
    ds_read_b64_tr_b16 v[48:49], v9 offset:4096
    s_waitcnt lgkmcnt(6)
    v_mfma_f32_32x32x16_bf16 v[84:99], v[60:63], v[56:59], v[84:99]
    ds_read_b64_tr_b16 v[50:51], v9 offset:5120
    ds_read_b128 v[44:47], v7 offset:41984
    s_waitcnt lgkmcnt(5)
    v_mfma_f32_32x32x16_bf16 v[68:83], v[36:39], v[28:31], v[68:83]
    ds_read_b128 v[52:55], v7 offset:544
    ds_read_b64_tr_b16 v[60:61], v9 offset:8192
    s_waitcnt lgkmcnt(6)
    v_mfma_f32_32x32x16_bf16 v[84:99], v[36:39], v[32:35], v[84:99]
    ds_read_b64_tr_b16 v[62:63], v9 offset:9216
    ds_read_b128 v[56:59], v7 offset:42016
    s_barrier
    s_waitcnt lgkmcnt(5)
    v_mfma_f32_32x32x16_bf16 v[68:83], v[48:51], v[40:43], v[68:83]
    ds_read_b128 v[28:31], v7 offset:576
    ds_read_b64_tr_b16 v[36:37], v8 offset:0
    s_waitcnt lgkmcnt(6)
    v_mfma_f32_32x32x16_bf16 v[84:99], v[48:51], v[44:47], v[84:99]
    ds_read_b64_tr_b16 v[38:39], v8 offset:1024
    ds_read_b128 v[32:35], v7 offset:42048
    s_waitcnt lgkmcnt(5)
    v_mfma_f32_32x32x16_bf16 v[68:83], v[60:63], v[52:55], v[68:83]
    ds_read_b128 v[40:43], v7 offset:608
    ds_read_b64_tr_b16 v[48:49], v8 offset:4096
    s_waitcnt lgkmcnt(6)
    v_mfma_f32_32x32x16_bf16 v[84:99], v[60:63], v[56:59], v[84:99]
    ds_read_b64_tr_b16 v[50:51], v8 offset:5120
    ds_read_b128 v[44:47], v7 offset:42080
    s_waitcnt lgkmcnt(5)
    v_mfma_f32_32x32x16_bf16 v[68:83], v[36:39], v[28:31], v[68:83]
    ds_read_b128 v[52:55], v7 offset:640
    ds_read_b64_tr_b16 v[60:61], v8 offset:8192
    s_waitcnt lgkmcnt(6)
    v_mfma_f32_32x32x16_bf16 v[84:99], v[36:39], v[32:35], v[84:99]
    ds_read_b64_tr_b16 v[62:63], v8 offset:9216
    ds_read_b128 v[56:59], v7 offset:42112
    s_waitcnt lgkmcnt(5)
    v_mfma_f32_32x32x16_bf16 v[68:83], v[48:51], v[40:43], v[68:83]
    ds_read_b128 v[28:31], v7 offset:672
    ds_read_b64_tr_b16 v[36:37], v8 offset:12288
    s_waitcnt lgkmcnt(6)
    v_mfma_f32_32x32x16_bf16 v[84:99], v[48:51], v[44:47], v[84:99]
    ds_read_b64_tr_b16 v[38:39], v8 offset:13312
    ds_read_b128 v[32:35], v7 offset:42144
    s_barrier
    s_waitcnt lgkmcnt(5)
    v_mfma_f32_32x32x16_bf16 v[68:83], v[60:63], v[52:55], v[68:83]
    ds_read_b128 v[40:43], v7 offset:704
    ds_read_b64_tr_b16 v[48:49], v8 offset:16384
    s_waitcnt lgkmcnt(6)
    v_mfma_f32_32x32x16_bf16 v[84:99], v[60:63], v[56:59], v[84:99]
    ds_read_b64_tr_b16 v[50:51], v8 offset:17408
    ds_read_b128 v[44:47], v7 offset:42176
    s_waitcnt lgkmcnt(5)
    v_mfma_f32_32x32x16_bf16 v[68:83], v[36:39], v[28:31], v[68:83]
    ds_read_b128 v[52:55], v7 offset:736
    ds_read_b64_tr_b16 v[60:61], v8 offset:20480
    s_waitcnt lgkmcnt(6)
    v_mfma_f32_32x32x16_bf16 v[84:99], v[36:39], v[32:35], v[84:99]
    ds_read_b64_tr_b16 v[62:63], v8 offset:21504
    ds_read_b128 v[56:59], v7 offset:42208
    s_waitcnt lgkmcnt(5)
    v_mfma_f32_32x32x16_bf16 v[68:83], v[48:51], v[40:43], v[68:83]
    ds_read_b128 v[28:31], v7 offset:768
    ds_read_b64_tr_b16 v[36:37], v8 offset:24576
    s_waitcnt lgkmcnt(6)
    v_mfma_f32_32x32x16_bf16 v[84:99], v[48:51], v[44:47], v[84:99]
    ds_read_b64_tr_b16 v[38:39], v8 offset:25600
    ds_read_b128 v[32:35], v7 offset:42240
    s_waitcnt lgkmcnt(5)
    v_mfma_f32_32x32x16_bf16 v[68:83], v[60:63], v[52:55], v[68:83]
    ds_read_b128 v[40:43], v7 offset:800
    ds_read_b64_tr_b16 v[48:49], v8 offset:28672
    s_waitcnt lgkmcnt(6)
    v_mfma_f32_32x32x16_bf16 v[84:99], v[60:63], v[56:59], v[84:99]
    ds_read_b64_tr_b16 v[50:51], v8 offset:29696
    ds_read_b128 v[44:47], v7 offset:42272
    s_barrier
    s_waitcnt lgkmcnt(5)
    v_mfma_f32_32x32x16_bf16 v[68:83], v[36:39], v[28:31], v[68:83]
    ds_read_b128 v[52:55], v7 offset:832
    ds_read_b64_tr_b16 v[60:61], v8 offset:32768
    s_waitcnt lgkmcnt(6)
    v_mfma_f32_32x32x16_bf16 v[84:99], v[36:39], v[32:35], v[84:99]
    ds_read_b64_tr_b16 v[62:63], v8 offset:33792
    ds_read_b128 v[56:59], v7 offset:42304
    s_waitcnt lgkmcnt(5)
    v_mfma_f32_32x32x16_bf16 v[68:83], v[48:51], v[40:43], v[68:83]
    ds_read_b128 v[28:31], v7 offset:864
    ds_read_b64_tr_b16 v[36:37], v8 offset:36864
    s_waitcnt lgkmcnt(6)
    v_mfma_f32_32x32x16_bf16 v[84:99], v[48:51], v[44:47], v[84:99]
    ds_read_b64_tr_b16 v[38:39], v8 offset:37888
    ds_read_b128 v[32:35], v7 offset:42336
    s_waitcnt lgkmcnt(5)
    v_mfma_f32_32x32x16_bf16 v[68:83], v[60:63], v[52:55], v[68:83]
    ds_read_b128 v[40:43], v7 offset:896
    ds_read_b64_tr_b16 v[48:49], v8 offset:40960
    s_waitcnt lgkmcnt(6)
    v_mfma_f32_32x32x16_bf16 v[84:99], v[60:63], v[56:59], v[84:99]
    ds_read_b64_tr_b16 v[50:51], v8 offset:41984
    ds_read_b128 v[44:47], v7 offset:42368
    s_waitcnt lgkmcnt(5)
    v_mfma_f32_32x32x16_bf16 v[68:83], v[36:39], v[28:31], v[68:83]
    ds_read_b128 v[52:55], v7 offset:928
    ds_read_b64_tr_b16 v[60:61], v8 offset:45056
    s_waitcnt lgkmcnt(6)
    v_mfma_f32_32x32x16_bf16 v[84:99], v[36:39], v[32:35], v[84:99]
    ds_read_b64_tr_b16 v[62:63], v8 offset:46080
    ds_read_b128 v[56:59], v7 offset:42400
    s_barrier
    s_waitcnt lgkmcnt(5)
    v_mfma_f32_32x32x16_bf16 v[68:83], v[48:51], v[40:43], v[68:83]
    ds_read_b128 v[28:31], v7 offset:960
    ds_read_b64_tr_b16 v[36:37], v8 offset:49152
    s_waitcnt lgkmcnt(6)
    v_mfma_f32_32x32x16_bf16 v[84:99], v[48:51], v[44:47], v[84:99]
    ds_read_b64_tr_b16 v[38:39], v8 offset:50176
    ds_read_b128 v[32:35], v7 offset:42432
    s_waitcnt lgkmcnt(5)
    v_mfma_f32_32x32x16_bf16 v[68:83], v[60:63], v[52:55], v[68:83]
    ds_read_b128 v[40:43], v7 offset:992
    ds_read_b64_tr_b16 v[48:49], v8 offset:53248
    s_waitcnt lgkmcnt(6)
    v_mfma_f32_32x32x16_bf16 v[84:99], v[60:63], v[56:59], v[84:99]
    ds_read_b64_tr_b16 v[50:51], v8 offset:54272
    ds_read_b128 v[44:47], v7 offset:42464
    s_waitcnt lgkmcnt(5)
    v_mfma_f32_32x32x16_bf16 v[68:83], v[36:39], v[28:31], v[68:83]
    ds_read_b128 v[52:55], v7 offset:1024
    ds_read_b64_tr_b16 v[60:61], v8 offset:57344
    s_waitcnt lgkmcnt(6)
    v_mfma_f32_32x32x16_bf16 v[84:99], v[36:39], v[32:35], v[84:99]
    ds_read_b64_tr_b16 v[62:63], v8 offset:58368
    ds_read_b128 v[56:59], v7 offset:42496
    s_waitcnt lgkmcnt(5)
    v_mfma_f32_32x32x16_bf16 v[68:83], v[48:51], v[40:43], v[68:83]
    ds_read_b128 v[28:31], v7 offset:1056
    ds_read_b64_tr_b16 v[36:37], v9 offset:0
    s_waitcnt lgkmcnt(6)
    v_mfma_f32_32x32x16_bf16 v[84:99], v[48:51], v[44:47], v[84:99]
    ds_read_b64_tr_b16 v[38:39], v9 offset:1024
    ds_read_b128 v[32:35], v7 offset:42528
    s_barrier
    s_waitcnt lgkmcnt(5)
    v_mfma_f32_32x32x16_bf16 v[68:83], v[60:63], v[52:55], v[68:83]
    ds_read_b128 v[40:43], v7 offset:1088
    ds_read_b64_tr_b16 v[48:49], v9 offset:4096
    s_waitcnt lgkmcnt(6)
    v_mfma_f32_32x32x16_bf16 v[84:99], v[60:63], v[56:59], v[84:99]
    ds_read_b64_tr_b16 v[50:51], v9 offset:5120
    ds_read_b128 v[44:47], v7 offset:42560
    s_waitcnt lgkmcnt(5)
    v_mfma_f32_32x32x16_bf16 v[68:83], v[36:39], v[28:31], v[68:83]
    ds_read_b128 v[52:55], v7 offset:1120
    ds_read_b64_tr_b16 v[60:61], v9 offset:8192
    s_waitcnt lgkmcnt(6)
    v_mfma_f32_32x32x16_bf16 v[84:99], v[36:39], v[32:35], v[84:99]
    ds_read_b64_tr_b16 v[62:63], v9 offset:9216
    ds_read_b128 v[56:59], v7 offset:42592
    s_waitcnt lgkmcnt(5)
    v_mfma_f32_32x32x16_bf16 v[68:83], v[48:51], v[40:43], v[68:83]
    ds_read_b128 v[28:31], v7 offset:1152
    ds_read_b64_tr_b16 v[36:37], v8 offset:0
    s_waitcnt lgkmcnt(6)
    v_mfma_f32_32x32x16_bf16 v[84:99], v[48:51], v[44:47], v[84:99]
    ds_read_b64_tr_b16 v[38:39], v8 offset:1024
    ds_read_b128 v[32:35], v7 offset:42624
    s_waitcnt lgkmcnt(5)
    v_mfma_f32_32x32x16_bf16 v[68:83], v[60:63], v[52:55], v[68:83]
    ds_read_b128 v[40:43], v7 offset:1184
    ds_read_b64_tr_b16 v[48:49], v8 offset:4096
    s_waitcnt lgkmcnt(6)
    v_mfma_f32_32x32x16_bf16 v[84:99], v[60:63], v[56:59], v[84:99]
    ds_read_b64_tr_b16 v[50:51], v8 offset:5120
    ds_read_b128 v[44:47], v7 offset:42656
    s_barrier
    s_waitcnt lgkmcnt(5)
    v_mfma_f32_32x32x16_bf16 v[68:83], v[36:39], v[28:31], v[68:83]
    ds_read_b128 v[52:55], v7 offset:1216
    ds_read_b64_tr_b16 v[60:61], v8 offset:8192
    s_waitcnt lgkmcnt(6)
    v_mfma_f32_32x32x16_bf16 v[84:99], v[36:39], v[32:35], v[84:99]
    ds_read_b64_tr_b16 v[62:63], v8 offset:9216
    ds_read_b128 v[56:59], v7 offset:42688
    s_waitcnt lgkmcnt(5)
    v_mfma_f32_32x32x16_bf16 v[68:83], v[48:51], v[40:43], v[68:83]
    ds_read_b128 v[28:31], v7 offset:1248
    ds_read_b64_tr_b16 v[36:37], v8 offset:12288
    s_waitcnt lgkmcnt(6)
    v_mfma_f32_32x32x16_bf16 v[84:99], v[48:51], v[44:47], v[84:99]
    ds_read_b64_tr_b16 v[38:39], v8 offset:13312
    ds_read_b128 v[32:35], v7 offset:42720
    s_waitcnt lgkmcnt(5)
    v_mfma_f32_32x32x16_bf16 v[68:83], v[60:63], v[52:55], v[68:83]
    ds_read_b128 v[40:43], v7 offset:0
    ds_read_b64_tr_b16 v[48:49], v8 offset:16384
    s_waitcnt lgkmcnt(6)
    v_mfma_f32_32x32x16_bf16 v[84:99], v[60:63], v[56:59], v[84:99]
    ds_read_b64_tr_b16 v[50:51], v8 offset:17408
    ds_read_b128 v[44:47], v7 offset:41472
    s_waitcnt lgkmcnt(5)
    v_mfma_f32_32x32x16_bf16 v[68:83], v[36:39], v[28:31], v[68:83]
    ds_read_b128 v[52:55], v7 offset:32
    ds_read_b64_tr_b16 v[60:61], v8 offset:20480
    s_waitcnt lgkmcnt(6)
    v_mfma_f32_32x32x16_bf16 v[84:99], v[36:39], v[32:35], v[84:99]
    ds_read_b64_tr_b16 v[62:63], v8 offset:21504
    ds_read_b128 v[56:59], v7 offset:41504
    s_barrier
    s_waitcnt lgkmcnt(5)
    v_mfma_f32_32x32x16_bf16 v[100:115], v[48:51], v[40:43], 0
    ds_read_b128 v[28:31], v7 offset:64
    ds_read_b64_tr_b16 v[36:37], v8 offset:24576
    s_waitcnt lgkmcnt(6)
    v_mfma_f32_32x32x16_bf16 v[116:131], v[48:51], v[44:47], 0
    ds_read_b64_tr_b16 v[38:39], v8 offset:25600
    ds_read_b128 v[32:35], v7 offset:41536
    s_waitcnt lgkmcnt(5)
    v_mfma_f32_32x32x16_bf16 v[100:115], v[60:63], v[52:55], v[100:115]
    ds_read_b128 v[40:43], v7 offset:96
    ds_read_b64_tr_b16 v[48:49], v8 offset:28672
    s_waitcnt lgkmcnt(6)
    v_mfma_f32_32x32x16_bf16 v[116:131], v[60:63], v[56:59], v[116:131]
    ds_read_b64_tr_b16 v[50:51], v8 offset:29696
    ds_read_b128 v[44:47], v7 offset:41568
    s_waitcnt lgkmcnt(5)
    v_mfma_f32_32x32x16_bf16 v[100:115], v[36:39], v[28:31], v[100:115]
    ds_read_b128 v[52:55], v7 offset:128
    ds_read_b64_tr_b16 v[60:61], v8 offset:32768
    s_waitcnt lgkmcnt(6)
    v_mfma_f32_32x32x16_bf16 v[116:131], v[36:39], v[32:35], v[116:131]
    ds_read_b64_tr_b16 v[62:63], v8 offset:33792
    ds_read_b128 v[56:59], v7 offset:41600
    s_waitcnt lgkmcnt(5)
    v_mfma_f32_32x32x16_bf16 v[100:115], v[48:51], v[40:43], v[100:115]
    ds_read_b128 v[28:31], v7 offset:160
    ds_read_b64_tr_b16 v[36:37], v8 offset:36864
    s_waitcnt lgkmcnt(6)
    v_mfma_f32_32x32x16_bf16 v[116:131], v[48:51], v[44:47], v[116:131]
    ds_read_b64_tr_b16 v[38:39], v8 offset:37888
    ds_read_b128 v[32:35], v7 offset:41632
    v_and_b32 v5, 31, v1
    v_lshlrev_b32 v5, 2, v5
    s_barrier
    s_waitcnt lgkmcnt(5)
    v_mfma_f32_32x32x16_bf16 v[100:115], v[60:63], v[52:55], v[100:115]
    ds_read_b128 v[40:43], v7 offset:192
    ds_read_b64_tr_b16 v[48:49], v8 offset:40960
    s_waitcnt lgkmcnt(6)
    v_mfma_f32_32x32x16_bf16 v[116:131], v[60:63], v[56:59], v[116:131]
    ds_read_b64_tr_b16 v[50:51], v8 offset:41984
    ds_read_b128 v[44:47], v7 offset:41664
    s_add_u32 s23, s40, s42
    s_waitcnt lgkmcnt(5)
    v_mfma_f32_32x32x16_bf16 v[100:115], v[36:39], v[28:31], v[100:115]
    ds_read_b128 v[52:55], v7 offset:224
    ds_read_b64_tr_b16 v[60:61], v8 offset:45056
    s_waitcnt lgkmcnt(6)
    v_mfma_f32_32x32x16_bf16 v[116:131], v[36:39], v[32:35], v[116:131]
    ds_read_b64_tr_b16 v[62:63], v8 offset:46080
    ds_read_b128 v[56:59], v7 offset:41696
    v_mul_f32 v6, s44, v20
    s_waitcnt lgkmcnt(5)
    v_mfma_f32_32x32x16_bf16 v[100:115], v[48:51], v[40:43], v[100:115]
    ds_read_b128 v[28:31], v7 offset:256
    ds_read_b64_tr_b16 v[36:37], v8 offset:49152
    s_waitcnt lgkmcnt(6)
    v_mfma_f32_32x32x16_bf16 v[116:131], v[48:51], v[44:47], v[116:131]
    ds_read_b64_tr_b16 v[38:39], v8 offset:50176
    ds_read_b128 v[32:35], v7 offset:41728
    v_mul_f32 v68, v68, v6
    v_mul_f32 v69, v69, v6
    v_mul_f32 v70, v70, v6
    v_mul_f32 v71, v71, v6
    s_waitcnt lgkmcnt(5)
    v_mfma_f32_32x32x16_bf16 v[100:115], v[60:63], v[52:55], v[100:115]
    ds_read_b128 v[40:43], v7 offset:288
    ds_read_b64_tr_b16 v[48:49], v8 offset:53248
    s_waitcnt lgkmcnt(6)
    v_mfma_f32_32x32x16_bf16 v[116:131], v[60:63], v[56:59], v[116:131]
    ds_read_b64_tr_b16 v[50:51], v8 offset:54272
    ds_read_b128 v[44:47], v7 offset:41760
    v_cvt_pk_bf16_f32 v68, v68, v69
    v_cvt_pk_bf16_f32 v69, v70, v71
    buffer_store_dwordx2 v[68:69], v12, s[16:19], s40 offen sc1
    s_barrier
    s_waitcnt lgkmcnt(5)
    v_mfma_f32_32x32x16_bf16 v[100:115], v[36:39], v[28:31], v[100:115]
    ds_read_b128 v[52:55], v7 offset:320
    ds_read_b64_tr_b16 v[60:61], v8 offset:57344
    s_waitcnt lgkmcnt(6)
    v_mfma_f32_32x32x16_bf16 v[116:131], v[36:39], v[32:35], v[116:131]
    ds_read_b64_tr_b16 v[62:63], v8 offset:58368
    ds_read_b128 v[56:59], v7 offset:41792
    v_mul_f32 v72, v72, v6
    v_mul_f32 v73, v73, v6
    v_mul_f32 v74, v74, v6
    v_mul_f32_e64 v75, v75, v6
    s_waitcnt lgkmcnt(5)
    v_mfma_f32_32x32x16_bf16 v[100:115], v[48:51], v[40:43], v[100:115]
    ds_read_b128 v[28:31], v7 offset:352
    ds_read_b64_tr_b16 v[36:37], v9 offset:0
    s_waitcnt lgkmcnt(6)
    v_mfma_f32_32x32x16_bf16 v[116:131], v[48:51], v[44:47], v[116:131]
    ds_read_b64_tr_b16 v[38:39], v9 offset:1024
    ds_read_b128 v[32:35], v7 offset:41824
    v_cvt_pk_bf16_f32 v72, v72, v73
    v_cvt_pk_bf16_f32 v73, v74, v75
    buffer_store_dwordx2 v[72:73], v13, s[16:19], s40 offen sc1
    s_waitcnt lgkmcnt(5)
    v_mfma_f32_32x32x16_bf16 v[100:115], v[60:63], v[52:55], v[100:115]
    ds_read_b128 v[40:43], v7 offset:384
    ds_read_b64_tr_b16 v[48:49], v9 offset:4096
    s_waitcnt lgkmcnt(6)
    v_mfma_f32_32x32x16_bf16 v[116:131], v[60:63], v[56:59], v[116:131]
    ds_read_b64_tr_b16 v[50:51], v9 offset:5120
    ds_read_b128 v[44:47], v7 offset:41856
    v_mul_f32 v76, v76, v6
    v_mul_f32 v77, v77, v6
    v_mul_f32 v78, v78, v6
    v_mul_f32 v79, v79, v6
    s_waitcnt lgkmcnt(5)
    v_mfma_f32_32x32x16_bf16 v[100:115], v[36:39], v[28:31], v[100:115]
    ds_read_b128 v[52:55], v7 offset:416
    ds_read_b64_tr_b16 v[60:61], v9 offset:8192
    s_waitcnt lgkmcnt(6)
    v_mfma_f32_32x32x16_bf16 v[116:131], v[36:39], v[32:35], v[116:131]
    ds_read_b64_tr_b16 v[62:63], v9 offset:9216
    ds_read_b128 v[56:59], v7 offset:41888
    v_cvt_pk_bf16_f32 v76, v76, v77
    v_cvt_pk_bf16_f32 v77, v78, v79
    buffer_store_dwordx2 v[76:77], v14, s[16:19], s40 offen sc1
    s_barrier
    s_waitcnt lgkmcnt(5)
    v_mfma_f32_32x32x16_bf16 v[100:115], v[48:51], v[40:43], v[100:115]
    ds_read_b128 v[28:31], v7 offset:448
    ds_read_b64_tr_b16 v[36:37], v8 offset:0
    s_waitcnt lgkmcnt(6)
    v_mfma_f32_32x32x16_bf16 v[116:131], v[48:51], v[44:47], v[116:131]
    ds_read_b64_tr_b16 v[38:39], v8 offset:1024
    ds_read_b128 v[32:35], v7 offset:41920
    v_mul_f32 v80, v80, v6
    v_mul_f32 v81, v81, v6
    v_mul_f32 v82, v82, v6
    v_mul_f32_e64 v83, v83, v6
    s_waitcnt lgkmcnt(5)
    v_mfma_f32_32x32x16_bf16 v[100:115], v[60:63], v[52:55], v[100:115]
    ds_read_b128 v[40:43], v7 offset:480
    ds_read_b64_tr_b16 v[48:49], v8 offset:4096
    s_waitcnt lgkmcnt(6)
    v_mfma_f32_32x32x16_bf16 v[116:131], v[60:63], v[56:59], v[116:131]
    ds_read_b64_tr_b16 v[50:51], v8 offset:5120
    ds_read_b128 v[44:47], v7 offset:41952
    v_cvt_pk_bf16_f32 v80, v80, v81
    v_cvt_pk_bf16_f32 v81, v82, v83
    buffer_store_dwordx2 v[80:81], v15, s[16:19], s40 offen sc1
    s_waitcnt lgkmcnt(5)
    v_mfma_f32_32x32x16_bf16 v[100:115], v[36:39], v[28:31], v[100:115]
    ds_read_b128 v[52:55], v7 offset:512
    ds_read_b64_tr_b16 v[60:61], v8 offset:8192
    s_waitcnt lgkmcnt(6)
    v_mfma_f32_32x32x16_bf16 v[116:131], v[36:39], v[32:35], v[116:131]
    ds_read_b64_tr_b16 v[62:63], v8 offset:9216
    ds_read_b128 v[56:59], v7 offset:41984
    v_mul_f32_e64 v6, s44, v21
    s_waitcnt lgkmcnt(5)
    v_mfma_f32_32x32x16_bf16 v[100:115], v[48:51], v[40:43], v[100:115]
    ds_read_b128 v[28:31], v7 offset:544
    ds_read_b64_tr_b16 v[36:37], v8 offset:12288
    s_waitcnt lgkmcnt(6)
    v_mfma_f32_32x32x16_bf16 v[116:131], v[48:51], v[44:47], v[116:131]
    ds_read_b64_tr_b16 v[38:39], v8 offset:13312
    ds_read_b128 v[32:35], v7 offset:42016
    v_mul_f32 v84, v84, v6
    v_mul_f32 v85, v85, v6
    v_mul_f32 v86, v86, v6
    v_mul_f32_e64 v87, v87, v6
    s_barrier
    s_waitcnt lgkmcnt(5)
    v_mfma_f32_32x32x16_bf16 v[100:115], v[60:63], v[52:55], v[100:115]
    ds_read_b128 v[40:43], v7 offset:576
    ds_read_b64_tr_b16 v[48:49], v8 offset:16384
    s_waitcnt lgkmcnt(6)
    v_mfma_f32_32x32x16_bf16 v[116:131], v[60:63], v[56:59], v[116:131]
    ds_read_b64_tr_b16 v[50:51], v8 offset:17408
    ds_read_b128 v[44:47], v7 offset:42048
    v_cvt_pk_bf16_f32 v84, v84, v85
    v_cvt_pk_bf16_f32 v85, v86, v87
    buffer_store_dwordx2 v[84:85], v12, s[16:19], s23 offen sc1
    s_waitcnt lgkmcnt(5)
    v_mfma_f32_32x32x16_bf16 v[100:115], v[36:39], v[28:31], v[100:115]
    ds_read_b128 v[52:55], v7 offset:608
    ds_read_b64_tr_b16 v[60:61], v8 offset:20480
    s_waitcnt lgkmcnt(6)
    v_mfma_f32_32x32x16_bf16 v[116:131], v[36:39], v[32:35], v[116:131]
    ds_read_b64_tr_b16 v[62:63], v8 offset:21504
    ds_read_b128 v[56:59], v7 offset:42080
    v_mul_f32 v88, v88, v6
    v_mul_f32 v89, v89, v6
    v_mul_f32 v90, v90, v6
    v_mul_f32 v91, v91, v6
    s_waitcnt lgkmcnt(5)
    v_mfma_f32_32x32x16_bf16 v[100:115], v[48:51], v[40:43], v[100:115]
    ds_read_b128 v[28:31], v7 offset:640
    ds_read_b64_tr_b16 v[36:37], v8 offset:24576
    s_waitcnt lgkmcnt(6)
    v_mfma_f32_32x32x16_bf16 v[116:131], v[48:51], v[44:47], v[116:131]
    ds_read_b64_tr_b16 v[38:39], v8 offset:25600
    ds_read_b128 v[32:35], v7 offset:42112
    v_cvt_pk_bf16_f32 v88, v88, v89
    v_cvt_pk_bf16_f32 v89, v90, v91
    buffer_store_dwordx2 v[88:89], v13, s[16:19], s23 offen sc1
    s_waitcnt lgkmcnt(5)
    v_mfma_f32_32x32x16_bf16 v[100:115], v[60:63], v[52:55], v[100:115]
    ds_read_b128 v[40:43], v7 offset:672
    ds_read_b64_tr_b16 v[48:49], v8 offset:28672
    s_waitcnt lgkmcnt(6)
    v_mfma_f32_32x32x16_bf16 v[116:131], v[60:63], v[56:59], v[116:131]
    ds_read_b64_tr_b16 v[50:51], v8 offset:29696
    ds_read_b128 v[44:47], v7 offset:42144
    v_mul_f32 v92, v92, v6
    v_mul_f32 v93, v93, v6
    v_mul_f32 v94, v94, v6
    v_mul_f32_e64 v95, v95, v6
    s_barrier
    s_waitcnt lgkmcnt(5)
    v_mfma_f32_32x32x16_bf16 v[100:115], v[36:39], v[28:31], v[100:115]
    ds_read_b128 v[52:55], v7 offset:704
    ds_read_b64_tr_b16 v[60:61], v8 offset:32768
    s_waitcnt lgkmcnt(6)
    v_mfma_f32_32x32x16_bf16 v[116:131], v[36:39], v[32:35], v[116:131]
    ds_read_b64_tr_b16 v[62:63], v8 offset:33792
    ds_read_b128 v[56:59], v7 offset:42176
    v_cvt_pk_bf16_f32 v92, v92, v93
    v_cvt_pk_bf16_f32 v93, v94, v95
    buffer_store_dwordx2 v[92:93], v14, s[16:19], s23 offen sc1
    s_waitcnt lgkmcnt(5)
    v_mfma_f32_32x32x16_bf16 v[100:115], v[48:51], v[40:43], v[100:115]
    ds_read_b128 v[28:31], v7 offset:736
    ds_read_b64_tr_b16 v[36:37], v8 offset:36864
    s_waitcnt lgkmcnt(6)
    v_mfma_f32_32x32x16_bf16 v[116:131], v[48:51], v[44:47], v[116:131]
    ds_read_b64_tr_b16 v[38:39], v8 offset:37888
    ds_read_b128 v[32:35], v7 offset:42208
    v_mul_f32 v96, v96, v6
    v_mul_f32 v97, v97, v6
    v_mul_f32 v98, v98, v6
    v_mul_f32 v99, v99, v6
    s_waitcnt lgkmcnt(5)
    v_mfma_f32_32x32x16_bf16 v[100:115], v[60:63], v[52:55], v[100:115]
    ds_read_b128 v[40:43], v7 offset:768
    ds_read_b64_tr_b16 v[48:49], v8 offset:40960
    s_waitcnt lgkmcnt(6)
    v_mfma_f32_32x32x16_bf16 v[116:131], v[60:63], v[56:59], v[116:131]
    ds_read_b64_tr_b16 v[50:51], v8 offset:41984
    ds_read_b128 v[44:47], v7 offset:42240
    v_cvt_pk_bf16_f32 v96, v96, v97
    v_cvt_pk_bf16_f32 v97, v98, v99
    buffer_store_dwordx2 v[96:97], v15, s[16:19], s23 offen sc1
    s_waitcnt lgkmcnt(5)
    v_mfma_f32_32x32x16_bf16 v[100:115], v[36:39], v[28:31], v[100:115]
    ds_read_b128 v[52:55], v7 offset:800
    ds_read_b64_tr_b16 v[60:61], v8 offset:45056
    s_waitcnt lgkmcnt(6)
    v_mfma_f32_32x32x16_bf16 v[116:131], v[36:39], v[32:35], v[116:131]
    ds_read_b64_tr_b16 v[62:63], v8 offset:46080
    ds_read_b128 v[56:59], v7 offset:42272
    s_barrier
    s_waitcnt lgkmcnt(5)
    v_mfma_f32_32x32x16_bf16 v[100:115], v[48:51], v[40:43], v[100:115]
    ds_read_b128 v[28:31], v7 offset:832
    ds_read_b64_tr_b16 v[36:37], v8 offset:49152
    s_waitcnt lgkmcnt(6)
    v_mfma_f32_32x32x16_bf16 v[116:131], v[48:51], v[44:47], v[116:131]
    ds_read_b64_tr_b16 v[38:39], v8 offset:50176
    ds_read_b128 v[32:35], v7 offset:42304
    s_waitcnt lgkmcnt(5)
    v_mfma_f32_32x32x16_bf16 v[100:115], v[60:63], v[52:55], v[100:115]
    ds_read_b128 v[40:43], v7 offset:864
    ds_read_b64_tr_b16 v[48:49], v8 offset:53248
    s_waitcnt lgkmcnt(6)
    v_mfma_f32_32x32x16_bf16 v[116:131], v[60:63], v[56:59], v[116:131]
    ds_read_b64_tr_b16 v[50:51], v8 offset:54272
    ds_read_b128 v[44:47], v7 offset:42336
    s_waitcnt lgkmcnt(5)
    v_mfma_f32_32x32x16_bf16 v[100:115], v[36:39], v[28:31], v[100:115]
    ds_read_b128 v[52:55], v7 offset:896
    ds_read_b64_tr_b16 v[60:61], v8 offset:57344
    s_waitcnt lgkmcnt(6)
    v_mfma_f32_32x32x16_bf16 v[116:131], v[36:39], v[32:35], v[116:131]
    ds_read_b64_tr_b16 v[62:63], v8 offset:58368
    ds_read_b128 v[56:59], v7 offset:42368
    s_waitcnt lgkmcnt(5)
    v_mfma_f32_32x32x16_bf16 v[100:115], v[48:51], v[40:43], v[100:115]
    ds_read_b128 v[28:31], v7 offset:928
    ds_read_b64_tr_b16 v[36:37], v9 offset:0
    s_waitcnt lgkmcnt(6)
    v_mfma_f32_32x32x16_bf16 v[116:131], v[48:51], v[44:47], v[116:131]
    ds_read_b64_tr_b16 v[38:39], v9 offset:1024
    ds_read_b128 v[32:35], v7 offset:42400
    s_barrier
    s_waitcnt lgkmcnt(5)
    v_mfma_f32_32x32x16_bf16 v[100:115], v[60:63], v[52:55], v[100:115]
    ds_read_b128 v[40:43], v7 offset:960
    ds_read_b64_tr_b16 v[48:49], v9 offset:4096
    s_waitcnt lgkmcnt(6)
    v_mfma_f32_32x32x16_bf16 v[116:131], v[60:63], v[56:59], v[116:131]
    ds_read_b64_tr_b16 v[50:51], v9 offset:5120
    ds_read_b128 v[44:47], v7 offset:42432
    s_waitcnt lgkmcnt(5)
    v_mfma_f32_32x32x16_bf16 v[100:115], v[36:39], v[28:31], v[100:115]
    ds_read_b128 v[52:55], v7 offset:992
    ds_read_b64_tr_b16 v[60:61], v9 offset:8192
    s_waitcnt lgkmcnt(6)
    v_mfma_f32_32x32x16_bf16 v[116:131], v[36:39], v[32:35], v[116:131]
    ds_read_b64_tr_b16 v[62:63], v9 offset:9216
    ds_read_b128 v[56:59], v7 offset:42464
    s_waitcnt lgkmcnt(5)
    v_mfma_f32_32x32x16_bf16 v[100:115], v[48:51], v[40:43], v[100:115]
    ds_read_b128 v[28:31], v7 offset:1024
    ds_read_b64_tr_b16 v[36:37], v8 offset:0
    s_waitcnt lgkmcnt(6)
    v_mfma_f32_32x32x16_bf16 v[116:131], v[48:51], v[44:47], v[116:131]
    ds_read_b64_tr_b16 v[38:39], v8 offset:1024
    ds_read_b128 v[32:35], v7 offset:42496
    s_waitcnt lgkmcnt(5)
    v_mfma_f32_32x32x16_bf16 v[100:115], v[60:63], v[52:55], v[100:115]
    ds_read_b128 v[40:43], v7 offset:1056
    ds_read_b64_tr_b16 v[48:49], v8 offset:4096
    s_waitcnt lgkmcnt(6)
    v_mfma_f32_32x32x16_bf16 v[116:131], v[60:63], v[56:59], v[116:131]
    ds_read_b64_tr_b16 v[50:51], v8 offset:5120
    ds_read_b128 v[44:47], v7 offset:42528
    s_barrier
    s_waitcnt lgkmcnt(5)
    v_mfma_f32_32x32x16_bf16 v[100:115], v[36:39], v[28:31], v[100:115]
    ds_read_b128 v[52:55], v7 offset:1088
    ds_read_b64_tr_b16 v[60:61], v8 offset:8192
    s_waitcnt lgkmcnt(6)
    v_mfma_f32_32x32x16_bf16 v[116:131], v[36:39], v[32:35], v[116:131]
    ds_read_b64_tr_b16 v[62:63], v8 offset:9216
    ds_read_b128 v[56:59], v7 offset:42560
    s_waitcnt lgkmcnt(5)
    v_mfma_f32_32x32x16_bf16 v[100:115], v[48:51], v[40:43], v[100:115]
    ds_read_b128 v[28:31], v7 offset:1120
    ds_read_b64_tr_b16 v[36:37], v8 offset:12288
    s_waitcnt lgkmcnt(6)
    v_mfma_f32_32x32x16_bf16 v[116:131], v[48:51], v[44:47], v[116:131]
    ds_read_b64_tr_b16 v[38:39], v8 offset:13312
    ds_read_b128 v[32:35], v7 offset:42592
    s_waitcnt lgkmcnt(5)
    v_mfma_f32_32x32x16_bf16 v[100:115], v[60:63], v[52:55], v[100:115]
    ds_read_b128 v[40:43], v7 offset:1152
    ds_read_b64_tr_b16 v[48:49], v8 offset:16384
    s_waitcnt lgkmcnt(6)
    v_mfma_f32_32x32x16_bf16 v[116:131], v[60:63], v[56:59], v[116:131]
    ds_read_b64_tr_b16 v[50:51], v8 offset:17408
    ds_read_b128 v[44:47], v7 offset:42624
    s_waitcnt lgkmcnt(5)
    v_mfma_f32_32x32x16_bf16 v[100:115], v[36:39], v[28:31], v[100:115]
    ds_read_b128 v[52:55], v7 offset:1184
    ds_read_b64_tr_b16 v[60:61], v8 offset:20480
    s_waitcnt lgkmcnt(6)
    v_mfma_f32_32x32x16_bf16 v[116:131], v[36:39], v[32:35], v[116:131]
    ds_read_b64_tr_b16 v[62:63], v8 offset:21504
    ds_read_b128 v[56:59], v7 offset:42656
    s_barrier
    s_waitcnt lgkmcnt(5)
    v_mfma_f32_32x32x16_bf16 v[100:115], v[48:51], v[40:43], v[100:115]
    ds_read_b128 v[28:31], v7 offset:1216
    ds_read_b64_tr_b16 v[36:37], v8 offset:24576
    s_waitcnt lgkmcnt(6)
    v_mfma_f32_32x32x16_bf16 v[116:131], v[48:51], v[44:47], v[116:131]
    ds_read_b64_tr_b16 v[38:39], v8 offset:25600
    ds_read_b128 v[32:35], v7 offset:42688
    s_waitcnt lgkmcnt(5)
    v_mfma_f32_32x32x16_bf16 v[100:115], v[60:63], v[52:55], v[100:115]
    ds_read_b128 v[40:43], v7 offset:1248
    ds_read_b64_tr_b16 v[48:49], v8 offset:28672
    s_waitcnt lgkmcnt(6)
    v_mfma_f32_32x32x16_bf16 v[116:131], v[60:63], v[56:59], v[116:131]
    ds_read_b64_tr_b16 v[50:51], v8 offset:29696
    ds_read_b128 v[44:47], v7 offset:42720
    s_waitcnt lgkmcnt(5)
    v_mfma_f32_32x32x16_bf16 v[100:115], v[36:39], v[28:31], v[100:115]
    s_waitcnt lgkmcnt(4)
    v_mfma_f32_32x32x16_bf16 v[116:131], v[36:39], v[32:35], v[116:131]
    s_waitcnt lgkmcnt(1)
    v_mfma_f32_32x32x16_bf16 v[100:115], v[48:51], v[40:43], v[100:115]
    s_waitcnt lgkmcnt(0)
    v_mfma_f32_32x32x16_bf16 v[116:131], v[48:51], v[44:47], v[116:131]
    s_nop 10
    v_and_b32 v5, 31, v1
    v_lshlrev_b32 v5, 2, v5
    s_add_u32 s23, s41, s43
    v_mul_f32 v6, s45, v20
    v_mul_f32 v100, v100, v6
    v_mul_f32 v101, v101, v6
    v_mul_f32 v102, v102, v6
    v_mul_f32 v103, v103, v6
    v_cvt_pk_bf16_f32 v100, v100, v101
    v_cvt_pk_bf16_f32 v101, v102, v103
    buffer_store_dwordx2 v[100:101], v16, s[16:19], s41 offen sc1
    v_mul_f32 v104, v104, v6
    v_mul_f32 v105, v105, v6
    v_mul_f32 v106, v106, v6
    v_mul_f32 v107, v107, v6
    v_cvt_pk_bf16_f32 v104, v104, v105
    v_cvt_pk_bf16_f32 v105, v106, v107
    buffer_store_dwordx2 v[104:105], v17, s[16:19], s41 offen sc1
    v_mul_f32 v108, v108, v6
    v_mul_f32 v109, v109, v6
    v_mul_f32 v110, v110, v6
    v_mul_f32 v111, v111, v6
    v_cvt_pk_bf16_f32 v108, v108, v109
    v_cvt_pk_bf16_f32 v109, v110, v111
    buffer_store_dwordx2 v[108:109], v18, s[16:19], s41 offen sc1
    v_mul_f32 v112, v112, v6
    v_mul_f32 v113, v113, v6
    v_mul_f32 v114, v114, v6
    v_mul_f32 v115, v115, v6
    v_cvt_pk_bf16_f32 v112, v112, v113
    v_cvt_pk_bf16_f32 v113, v114, v115
    buffer_store_dwordx2 v[112:113], v19, s[16:19], s41 offen sc1
    v_mul_f32 v6, s45, v21
    v_mul_f32 v116, v116, v6
    v_mul_f32 v117, v117, v6
    v_mul_f32 v118, v118, v6
    v_mul_f32_e64 v119, v119, v6
    v_cvt_pk_bf16_f32 v116, v116, v117
    v_cvt_pk_bf16_f32 v117, v118, v119
    buffer_store_dwordx2 v[116:117], v16, s[16:19], s23 offen sc1
    v_mul_f32 v120, v120, v6
    v_mul_f32 v121, v121, v6
    v_mul_f32 v122, v122, v6
    v_mul_f32 v123, v123, v6
    v_cvt_pk_bf16_f32 v120, v120, v121
    v_cvt_pk_bf16_f32 v121, v122, v123
    buffer_store_dwordx2 v[120:121], v17, s[16:19], s23 offen sc1
    v_mul_f32 v124, v124, v6
    v_mul_f32 v125, v125, v6
    v_mul_f32 v126, v126, v6
    v_mul_f32 v127, v127, v6
    v_cvt_pk_bf16_f32 v124, v124, v125
    v_cvt_pk_bf16_f32 v125, v126, v127
    buffer_store_dwordx2 v[124:125], v18, s[16:19], s23 offen sc1
    v_mul_f32 v128, v128, v6
    v_mul_f32 v129, v129, v6
    v_mul_f32 v130, v130, v6
    v_mul_f32 v131, v131, v6
    v_cvt_pk_bf16_f32 v128, v128, v129
    v_cvt_pk_bf16_f32 v129, v130, v131
    buffer_store_dwordx2 v[128:129], v19, s[16:19], s23 offen sc1
    s_branch z1_pub
z1_vmain:
    s_barrier
    v_lshrrev_b32 v4, 5, v1
    v_lshlrev_b32 v4, 4, v4
    ds_read_b128 v[132:135], v4 offset:0
    ds_read_b128 v[136:139], v4 offset:32
    ds_read_b128 v[140:143], v4 offset:64
    ds_read_b128 v[144:147], v4 offset:96
    ds_read_b128 v[148:151], v4 offset:128
    ds_read_b128 v[152:155], v4 offset:160
    ds_read_b128 v[156:159], v4 offset:192
    ds_read_b128 v[160:163], v4 offset:224
    ds_read_b128 v[28:31], v7 offset:0
    ds_read_b64_tr_b16 v[36:37], v8 offset:0
    ds_read_b64_tr_b16 v[38:39], v8 offset:1024
    ds_read_b128 v[32:35], v7 offset:41472
    ds_read_b128 v[40:43], v7 offset:32
    ds_read_b64_tr_b16 v[48:49], v8 offset:4096
    ds_read_b64_tr_b16 v[50:51], v8 offset:5120
    ds_read_b128 v[44:47], v7 offset:41504
    s_waitcnt lgkmcnt(5)
    v_mfma_f32_32x32x16_bf16 v[68:83], v[28:31], v[36:39], 0
    ds_read_b128 v[52:55], v7 offset:64
    ds_read_b64_tr_b16 v[60:61], v8 offset:8192
    s_waitcnt lgkmcnt(6)
    v_mfma_f32_32x32x16_bf16 v[84:99], v[32:35], v[36:39], 0
    ds_read_b64_tr_b16 v[62:63], v8 offset:9216
    ds_read_b128 v[56:59], v7 offset:41536
    s_waitcnt lgkmcnt(5)
    v_mfma_f32_32x32x16_bf16 v[68:83], v[40:43], v[48:51], v[68:83]
    ds_read_b128 v[28:31], v7 offset:96
    ds_read_b64_tr_b16 v[36:37], v8 offset:12288
    s_waitcnt lgkmcnt(6)
    v_mfma_f32_32x32x16_bf16 v[84:99], v[44:47], v[48:51], v[84:99]
    ds_read_b64_tr_b16 v[38:39], v8 offset:13312
    ds_read_b128 v[32:35], v7 offset:41568
    s_waitcnt lgkmcnt(5)
    v_mfma_f32_32x32x16_bf16 v[68:83], v[52:55], v[60:63], v[68:83]
    ds_read_b128 v[40:43], v7 offset:128
    ds_read_b64_tr_b16 v[48:49], v8 offset:16384
    s_waitcnt lgkmcnt(6)
    v_mfma_f32_32x32x16_bf16 v[84:99], v[56:59], v[60:63], v[84:99]
    ds_read_b64_tr_b16 v[50:51], v8 offset:17408
    ds_read_b128 v[44:47], v7 offset:41600
    s_waitcnt lgkmcnt(5)
    v_mfma_f32_32x32x16_bf16 v[68:83], v[28:31], v[36:39], v[68:83]
    ds_read_b128 v[52:55], v7 offset:160
    ds_read_b64_tr_b16 v[60:61], v8 offset:20480
    s_waitcnt lgkmcnt(6)
    v_mfma_f32_32x32x16_bf16 v[84:99], v[32:35], v[36:39], v[84:99]
    ds_read_b64_tr_b16 v[62:63], v8 offset:21504
    ds_read_b128 v[56:59], v7 offset:41632
    s_barrier
    s_waitcnt lgkmcnt(5)
    v_mfma_f32_32x32x16_bf16 v[68:83], v[40:43], v[48:51], v[68:83]
    ds_read_b128 v[28:31], v7 offset:192
    ds_read_b64_tr_b16 v[36:37], v8 offset:24576
    s_waitcnt lgkmcnt(6)
    v_mfma_f32_32x32x16_bf16 v[84:99], v[44:47], v[48:51], v[84:99]
    ds_read_b64_tr_b16 v[38:39], v8 offset:25600
    ds_read_b128 v[32:35], v7 offset:41664
    s_waitcnt lgkmcnt(5)
    v_mfma_f32_32x32x16_bf16 v[68:83], v[52:55], v[60:63], v[68:83]
    ds_read_b128 v[40:43], v7 offset:224
    ds_read_b64_tr_b16 v[48:49], v8 offset:28672
    s_waitcnt lgkmcnt(6)
    v_mfma_f32_32x32x16_bf16 v[84:99], v[56:59], v[60:63], v[84:99]
    ds_read_b64_tr_b16 v[50:51], v8 offset:29696
    ds_read_b128 v[44:47], v7 offset:41696
    s_waitcnt lgkmcnt(5)
    v_mfma_f32_32x32x16_bf16 v[68:83], v[28:31], v[36:39], v[68:83]
    ds_read_b128 v[52:55], v7 offset:256
    ds_read_b64_tr_b16 v[60:61], v8 offset:32768
    s_waitcnt lgkmcnt(6)
    v_mfma_f32_32x32x16_bf16 v[84:99], v[32:35], v[36:39], v[84:99]
    ds_read_b64_tr_b16 v[62:63], v8 offset:33792
    ds_read_b128 v[56:59], v7 offset:41728
    s_waitcnt lgkmcnt(5)
    v_mfma_f32_32x32x16_bf16 v[68:83], v[40:43], v[48:51], v[68:83]
    ds_read_b128 v[28:31], v7 offset:288
    ds_read_b64_tr_b16 v[36:37], v8 offset:36864
    s_waitcnt lgkmcnt(6)
    v_mfma_f32_32x32x16_bf16 v[84:99], v[44:47], v[48:51], v[84:99]
    ds_read_b64_tr_b16 v[38:39], v8 offset:37888
    ds_read_b128 v[32:35], v7 offset:41760
    s_barrier
    s_waitcnt lgkmcnt(5)
    v_mfma_f32_32x32x16_bf16 v[68:83], v[52:55], v[60:63], v[68:83]
    ds_read_b128 v[40:43], v7 offset:320
    ds_read_b64_tr_b16 v[48:49], v8 offset:40960
    s_waitcnt lgkmcnt(6)
    v_mfma_f32_32x32x16_bf16 v[84:99], v[56:59], v[60:63], v[84:99]
    ds_read_b64_tr_b16 v[50:51], v8 offset:41984
    ds_read_b128 v[44:47], v7 offset:41792
    s_waitcnt lgkmcnt(5)
    v_mfma_f32_32x32x16_bf16 v[68:83], v[28:31], v[36:39], v[68:83]
    ds_read_b128 v[52:55], v7 offset:352
    ds_read_b64_tr_b16 v[60:61], v8 offset:45056
    s_waitcnt lgkmcnt(6)
    v_mfma_f32_32x32x16_bf16 v[84:99], v[32:35], v[36:39], v[84:99]
    ds_read_b64_tr_b16 v[62:63], v8 offset:46080
    ds_read_b128 v[56:59], v7 offset:41824
    s_waitcnt lgkmcnt(5)
    v_mfma_f32_32x32x16_bf16 v[68:83], v[40:43], v[48:51], v[68:83]
    ds_read_b128 v[28:31], v7 offset:384
    ds_read_b64_tr_b16 v[36:37], v8 offset:49152
    s_waitcnt lgkmcnt(6)
    v_mfma_f32_32x32x16_bf16 v[84:99], v[44:47], v[48:51], v[84:99]
    ds_read_b64_tr_b16 v[38:39], v8 offset:50176
    ds_read_b128 v[32:35], v7 offset:41856
    s_waitcnt lgkmcnt(5)
    v_mfma_f32_32x32x16_bf16 v[68:83], v[52:55], v[60:63], v[68:83]
    ds_read_b128 v[40:43], v7 offset:416
    ds_read_b64_tr_b16 v[48:49], v8 offset:53248
    s_waitcnt lgkmcnt(6)
    v_mfma_f32_32x32x16_bf16 v[84:99], v[56:59], v[60:63], v[84:99]
    ds_read_b64_tr_b16 v[50:51], v8 offset:54272
    ds_read_b128 v[44:47], v7 offset:41888
    s_barrier
    s_waitcnt lgkmcnt(5)
    v_mfma_f32_32x32x16_bf16 v[68:83], v[28:31], v[36:39], v[68:83]
    ds_read_b128 v[52:55], v7 offset:448
    ds_read_b64_tr_b16 v[60:61], v8 offset:57344
    s_waitcnt lgkmcnt(6)
    v_mfma_f32_32x32x16_bf16 v[84:99], v[32:35], v[36:39], v[84:99]
    ds_read_b64_tr_b16 v[62:63], v8 offset:58368
    ds_read_b128 v[56:59], v7 offset:41920
    s_waitcnt lgkmcnt(5)
    v_mfma_f32_32x32x16_bf16 v[68:83], v[40:43], v[48:51], v[68:83]
    ds_read_b128 v[28:31], v7 offset:480
    ds_read_b64_tr_b16 v[36:37], v9 offset:0
    s_waitcnt lgkmcnt(6)
    v_mfma_f32_32x32x16_bf16 v[84:99], v[44:47], v[48:51], v[84:99]
    ds_read_b64_tr_b16 v[38:39], v9 offset:1024
    ds_read_b128 v[32:35], v7 offset:41952
    s_waitcnt lgkmcnt(5)
    v_mfma_f32_32x32x16_bf16 v[68:83], v[52:55], v[60:63], v[68:83]
    ds_read_b128 v[40:43], v7 offset:512
    ds_read_b64_tr_b16 v[48:49], v9 offset:4096
    s_waitcnt lgkmcnt(6)
    v_mfma_f32_32x32x16_bf16 v[84:99], v[56:59], v[60:63], v[84:99]
    ds_read_b64_tr_b16 v[50:51], v9 offset:5120
    ds_read_b128 v[44:47], v7 offset:41984
    s_waitcnt lgkmcnt(5)
    v_mfma_f32_32x32x16_bf16 v[68:83], v[28:31], v[36:39], v[68:83]
    ds_read_b128 v[52:55], v7 offset:544
    ds_read_b64_tr_b16 v[60:61], v9 offset:8192
    s_waitcnt lgkmcnt(6)
    v_mfma_f32_32x32x16_bf16 v[84:99], v[32:35], v[36:39], v[84:99]
    ds_read_b64_tr_b16 v[62:63], v9 offset:9216
    ds_read_b128 v[56:59], v7 offset:42016
    s_barrier
    s_waitcnt lgkmcnt(5)
    v_mfma_f32_32x32x16_bf16 v[68:83], v[40:43], v[48:51], v[68:83]
    ds_read_b128 v[28:31], v7 offset:576
    ds_read_b64_tr_b16 v[36:37], v8 offset:0
    s_waitcnt lgkmcnt(6)
    v_mfma_f32_32x32x16_bf16 v[84:99], v[44:47], v[48:51], v[84:99]
    ds_read_b64_tr_b16 v[38:39], v8 offset:1024
    ds_read_b128 v[32:35], v7 offset:42048
    s_waitcnt lgkmcnt(5)
    v_mfma_f32_32x32x16_bf16 v[68:83], v[52:55], v[60:63], v[68:83]
    ds_read_b128 v[40:43], v7 offset:608
    ds_read_b64_tr_b16 v[48:49], v8 offset:4096
    s_waitcnt lgkmcnt(6)
    v_mfma_f32_32x32x16_bf16 v[84:99], v[56:59], v[60:63], v[84:99]
    ds_read_b64_tr_b16 v[50:51], v8 offset:5120
    ds_read_b128 v[44:47], v7 offset:42080
    s_waitcnt lgkmcnt(5)
    v_mfma_f32_32x32x16_bf16 v[68:83], v[28:31], v[36:39], v[68:83]
    ds_read_b128 v[52:55], v7 offset:640
    ds_read_b64_tr_b16 v[60:61], v8 offset:8192
    s_waitcnt lgkmcnt(6)
    v_mfma_f32_32x32x16_bf16 v[84:99], v[32:35], v[36:39], v[84:99]
    ds_read_b64_tr_b16 v[62:63], v8 offset:9216
    ds_read_b128 v[56:59], v7 offset:42112
    s_waitcnt lgkmcnt(5)
    v_mfma_f32_32x32x16_bf16 v[68:83], v[40:43], v[48:51], v[68:83]
    ds_read_b128 v[28:31], v7 offset:672
    ds_read_b64_tr_b16 v[36:37], v8 offset:12288
    s_waitcnt lgkmcnt(6)
    v_mfma_f32_32x32x16_bf16 v[84:99], v[44:47], v[48:51], v[84:99]
    ds_read_b64_tr_b16 v[38:39], v8 offset:13312
    ds_read_b128 v[32:35], v7 offset:42144
    s_barrier
    s_waitcnt lgkmcnt(5)
    v_mfma_f32_32x32x16_bf16 v[68:83], v[52:55], v[60:63], v[68:83]
    ds_read_b128 v[40:43], v7 offset:704
    ds_read_b64_tr_b16 v[48:49], v8 offset:16384
    s_waitcnt lgkmcnt(6)
    v_mfma_f32_32x32x16_bf16 v[84:99], v[56:59], v[60:63], v[84:99]
    ds_read_b64_tr_b16 v[50:51], v8 offset:17408
    ds_read_b128 v[44:47], v7 offset:42176
    s_waitcnt lgkmcnt(5)
    v_mfma_f32_32x32x16_bf16 v[68:83], v[28:31], v[36:39], v[68:83]
    ds_read_b128 v[52:55], v7 offset:736
    ds_read_b64_tr_b16 v[60:61], v8 offset:20480
    s_waitcnt lgkmcnt(6)
    v_mfma_f32_32x32x16_bf16 v[84:99], v[32:35], v[36:39], v[84:99]
    ds_read_b64_tr_b16 v[62:63], v8 offset:21504
    ds_read_b128 v[56:59], v7 offset:42208
    s_waitcnt lgkmcnt(5)
    v_mfma_f32_32x32x16_bf16 v[68:83], v[40:43], v[48:51], v[68:83]
    ds_read_b128 v[28:31], v7 offset:768
    ds_read_b64_tr_b16 v[36:37], v8 offset:24576
    s_waitcnt lgkmcnt(6)
    v_mfma_f32_32x32x16_bf16 v[84:99], v[44:47], v[48:51], v[84:99]
    ds_read_b64_tr_b16 v[38:39], v8 offset:25600
    ds_read_b128 v[32:35], v7 offset:42240
    s_waitcnt lgkmcnt(5)
    v_mfma_f32_32x32x16_bf16 v[68:83], v[52:55], v[60:63], v[68:83]
    ds_read_b128 v[40:43], v7 offset:800
    ds_read_b64_tr_b16 v[48:49], v8 offset:28672
    s_waitcnt lgkmcnt(6)
    v_mfma_f32_32x32x16_bf16 v[84:99], v[56:59], v[60:63], v[84:99]
    ds_read_b64_tr_b16 v[50:51], v8 offset:29696
    ds_read_b128 v[44:47], v7 offset:42272
    s_barrier
    s_waitcnt lgkmcnt(5)
    v_mfma_f32_32x32x16_bf16 v[68:83], v[28:31], v[36:39], v[68:83]
    ds_read_b128 v[52:55], v7 offset:832
    ds_read_b64_tr_b16 v[60:61], v8 offset:32768
    s_waitcnt lgkmcnt(6)
    v_mfma_f32_32x32x16_bf16 v[84:99], v[32:35], v[36:39], v[84:99]
    ds_read_b64_tr_b16 v[62:63], v8 offset:33792
    ds_read_b128 v[56:59], v7 offset:42304
    s_waitcnt lgkmcnt(5)
    v_mfma_f32_32x32x16_bf16 v[68:83], v[40:43], v[48:51], v[68:83]
    ds_read_b128 v[28:31], v7 offset:864
    ds_read_b64_tr_b16 v[36:37], v8 offset:36864
    s_waitcnt lgkmcnt(6)
    v_mfma_f32_32x32x16_bf16 v[84:99], v[44:47], v[48:51], v[84:99]
    ds_read_b64_tr_b16 v[38:39], v8 offset:37888
    ds_read_b128 v[32:35], v7 offset:42336
    s_waitcnt lgkmcnt(5)
    v_mfma_f32_32x32x16_bf16 v[68:83], v[52:55], v[60:63], v[68:83]
    ds_read_b128 v[40:43], v7 offset:896
    ds_read_b64_tr_b16 v[48:49], v8 offset:40960
    s_waitcnt lgkmcnt(6)
    v_mfma_f32_32x32x16_bf16 v[84:99], v[56:59], v[60:63], v[84:99]
    ds_read_b64_tr_b16 v[50:51], v8 offset:41984
    ds_read_b128 v[44:47], v7 offset:42368
    s_waitcnt lgkmcnt(5)
    v_mfma_f32_32x32x16_bf16 v[68:83], v[28:31], v[36:39], v[68:83]
    ds_read_b128 v[52:55], v7 offset:928
    ds_read_b64_tr_b16 v[60:61], v8 offset:45056
    s_waitcnt lgkmcnt(6)
    v_mfma_f32_32x32x16_bf16 v[84:99], v[32:35], v[36:39], v[84:99]
    ds_read_b64_tr_b16 v[62:63], v8 offset:46080
    ds_read_b128 v[56:59], v7 offset:42400
    s_barrier
    s_waitcnt lgkmcnt(5)
    v_mfma_f32_32x32x16_bf16 v[68:83], v[40:43], v[48:51], v[68:83]
    ds_read_b128 v[28:31], v7 offset:960
    ds_read_b64_tr_b16 v[36:37], v8 offset:49152
    s_waitcnt lgkmcnt(6)
    v_mfma_f32_32x32x16_bf16 v[84:99], v[44:47], v[48:51], v[84:99]
    ds_read_b64_tr_b16 v[38:39], v8 offset:50176
    ds_read_b128 v[32:35], v7 offset:42432
    s_waitcnt lgkmcnt(5)
    v_mfma_f32_32x32x16_bf16 v[68:83], v[52:55], v[60:63], v[68:83]
    ds_read_b128 v[40:43], v7 offset:992
    ds_read_b64_tr_b16 v[48:49], v8 offset:53248
    s_waitcnt lgkmcnt(6)
    v_mfma_f32_32x32x16_bf16 v[84:99], v[56:59], v[60:63], v[84:99]
    ds_read_b64_tr_b16 v[50:51], v8 offset:54272
    ds_read_b128 v[44:47], v7 offset:42464
    s_waitcnt lgkmcnt(5)
    v_mfma_f32_32x32x16_bf16 v[68:83], v[28:31], v[36:39], v[68:83]
    ds_read_b128 v[52:55], v7 offset:1024
    ds_read_b64_tr_b16 v[60:61], v8 offset:57344
    s_waitcnt lgkmcnt(6)
    v_mfma_f32_32x32x16_bf16 v[84:99], v[32:35], v[36:39], v[84:99]
    ds_read_b64_tr_b16 v[62:63], v8 offset:58368
    ds_read_b128 v[56:59], v7 offset:42496
    s_waitcnt lgkmcnt(5)
    v_mfma_f32_32x32x16_bf16 v[68:83], v[40:43], v[48:51], v[68:83]
    ds_read_b128 v[28:31], v7 offset:1056
    ds_read_b64_tr_b16 v[36:37], v9 offset:0
    s_waitcnt lgkmcnt(6)
    v_mfma_f32_32x32x16_bf16 v[84:99], v[44:47], v[48:51], v[84:99]
    ds_read_b64_tr_b16 v[38:39], v9 offset:1024
    ds_read_b128 v[32:35], v7 offset:42528
    s_barrier
    s_waitcnt lgkmcnt(5)
    v_mfma_f32_32x32x16_bf16 v[68:83], v[52:55], v[60:63], v[68:83]
    ds_read_b128 v[40:43], v7 offset:1088
    ds_read_b64_tr_b16 v[48:49], v9 offset:4096
    s_waitcnt lgkmcnt(6)
    v_mfma_f32_32x32x16_bf16 v[84:99], v[56:59], v[60:63], v[84:99]
    ds_read_b64_tr_b16 v[50:51], v9 offset:5120
    ds_read_b128 v[44:47], v7 offset:42560
    s_waitcnt lgkmcnt(5)
    v_mfma_f32_32x32x16_bf16 v[68:83], v[28:31], v[36:39], v[68:83]
    ds_read_b128 v[52:55], v7 offset:1120
    ds_read_b64_tr_b16 v[60:61], v9 offset:8192
    s_waitcnt lgkmcnt(6)
    v_mfma_f32_32x32x16_bf16 v[84:99], v[32:35], v[36:39], v[84:99]
    ds_read_b64_tr_b16 v[62:63], v9 offset:9216
    ds_read_b128 v[56:59], v7 offset:42592
    s_waitcnt lgkmcnt(5)
    v_mfma_f32_32x32x16_bf16 v[68:83], v[40:43], v[48:51], v[68:83]
    ds_read_b128 v[28:31], v7 offset:1152
    ds_read_b64_tr_b16 v[36:37], v8 offset:0
    s_waitcnt lgkmcnt(6)
    v_mfma_f32_32x32x16_bf16 v[84:99], v[44:47], v[48:51], v[84:99]
    ds_read_b64_tr_b16 v[38:39], v8 offset:1024
    ds_read_b128 v[32:35], v7 offset:42624
    s_waitcnt lgkmcnt(5)
    v_mfma_f32_32x32x16_bf16 v[68:83], v[52:55], v[60:63], v[68:83]
    ds_read_b128 v[40:43], v7 offset:1184
    ds_read_b64_tr_b16 v[48:49], v8 offset:4096
    s_waitcnt lgkmcnt(6)
    v_mfma_f32_32x32x16_bf16 v[84:99], v[56:59], v[60:63], v[84:99]
    ds_read_b64_tr_b16 v[50:51], v8 offset:5120
    ds_read_b128 v[44:47], v7 offset:42656
    s_barrier
    s_waitcnt lgkmcnt(5)
    v_mfma_f32_32x32x16_bf16 v[68:83], v[28:31], v[36:39], v[68:83]
    ds_read_b128 v[52:55], v7 offset:1216
    ds_read_b64_tr_b16 v[60:61], v8 offset:8192
    s_waitcnt lgkmcnt(6)
    v_mfma_f32_32x32x16_bf16 v[84:99], v[32:35], v[36:39], v[84:99]
    ds_read_b64_tr_b16 v[62:63], v8 offset:9216
    ds_read_b128 v[56:59], v7 offset:42688
    s_waitcnt lgkmcnt(5)
    v_mfma_f32_32x32x16_bf16 v[68:83], v[40:43], v[48:51], v[68:83]
    ds_read_b128 v[28:31], v7 offset:1248
    ds_read_b64_tr_b16 v[36:37], v8 offset:12288
    s_waitcnt lgkmcnt(6)
    v_mfma_f32_32x32x16_bf16 v[84:99], v[44:47], v[48:51], v[84:99]
    ds_read_b64_tr_b16 v[38:39], v8 offset:13312
    ds_read_b128 v[32:35], v7 offset:42720
    s_cmp_eq_u32 s47, 1
    s_cbranch_scc1 onepass_2
    s_waitcnt lgkmcnt(5)
    v_mfma_f32_32x32x16_bf16 v[68:83], v[52:55], v[60:63], v[68:83]
    ds_read_b128 v[40:43], v7 offset:0
    ds_read_b64_tr_b16 v[48:49], v8 offset:16384
    s_waitcnt lgkmcnt(6)
    v_mfma_f32_32x32x16_bf16 v[84:99], v[56:59], v[60:63], v[84:99]
    ds_read_b64_tr_b16 v[50:51], v8 offset:17408
    ds_read_b128 v[44:47], v7 offset:41472
    s_waitcnt lgkmcnt(5)
    v_mfma_f32_32x32x16_bf16 v[68:83], v[28:31], v[36:39], v[68:83]
    ds_read_b128 v[52:55], v7 offset:32
    ds_read_b64_tr_b16 v[60:61], v8 offset:20480
    s_waitcnt lgkmcnt(6)
    v_mfma_f32_32x32x16_bf16 v[84:99], v[32:35], v[36:39], v[84:99]
    ds_read_b64_tr_b16 v[62:63], v8 offset:21504
    ds_read_b128 v[56:59], v7 offset:41504
    s_barrier
    s_waitcnt lgkmcnt(5)
    v_mfma_f32_32x32x16_bf16 v[100:115], v[40:43], v[48:51], 0
    ds_read_b128 v[28:31], v7 offset:64
    ds_read_b64_tr_b16 v[36:37], v8 offset:24576
    s_waitcnt lgkmcnt(6)
    v_mfma_f32_32x32x16_bf16 v[116:131], v[44:47], v[48:51], 0
    ds_read_b64_tr_b16 v[38:39], v8 offset:25600
    ds_read_b128 v[32:35], v7 offset:41536
    s_waitcnt lgkmcnt(5)
    v_mfma_f32_32x32x16_bf16 v[100:115], v[52:55], v[60:63], v[100:115]
    ds_read_b128 v[40:43], v7 offset:96
    ds_read_b64_tr_b16 v[48:49], v8 offset:28672
    s_waitcnt lgkmcnt(6)
    v_mfma_f32_32x32x16_bf16 v[116:131], v[56:59], v[60:63], v[116:131]
    ds_read_b64_tr_b16 v[50:51], v8 offset:29696
    ds_read_b128 v[44:47], v7 offset:41568
    s_waitcnt lgkmcnt(5)
    v_mfma_f32_32x32x16_bf16 v[100:115], v[28:31], v[36:39], v[100:115]
    ds_read_b128 v[52:55], v7 offset:128
    ds_read_b64_tr_b16 v[60:61], v8 offset:32768
    s_waitcnt lgkmcnt(6)
    v_mfma_f32_32x32x16_bf16 v[116:131], v[32:35], v[36:39], v[116:131]
    ds_read_b64_tr_b16 v[62:63], v8 offset:33792
    ds_read_b128 v[56:59], v7 offset:41600
    s_waitcnt lgkmcnt(5)
    v_mfma_f32_32x32x16_bf16 v[100:115], v[40:43], v[48:51], v[100:115]
    ds_read_b128 v[28:31], v7 offset:160
    ds_read_b64_tr_b16 v[36:37], v8 offset:36864
    s_waitcnt lgkmcnt(6)
    v_mfma_f32_32x32x16_bf16 v[116:131], v[44:47], v[48:51], v[116:131]
    ds_read_b64_tr_b16 v[38:39], v8 offset:37888
    ds_read_b128 v[32:35], v7 offset:41632
    s_add_u32 s23, s40, s42
    s_barrier
    s_waitcnt lgkmcnt(5)
    v_mfma_f32_32x32x16_bf16 v[100:115], v[52:55], v[60:63], v[100:115]
    ds_read_b128 v[40:43], v7 offset:192
    ds_read_b64_tr_b16 v[48:49], v8 offset:40960
    s_waitcnt lgkmcnt(6)
    v_mfma_f32_32x32x16_bf16 v[116:131], v[56:59], v[60:63], v[116:131]
    ds_read_b64_tr_b16 v[50:51], v8 offset:41984
    ds_read_b128 v[44:47], v7 offset:41664
    v_mul_f32 v68, v68, v132
    v_mul_f32 v69, v69, v133
    v_mul_f32 v70, v70, v134
    v_mul_f32_e64 v71, v71, v135
    s_waitcnt lgkmcnt(5)
    v_mfma_f32_32x32x16_bf16 v[100:115], v[28:31], v[36:39], v[100:115]
    ds_read_b128 v[52:55], v7 offset:224
    ds_read_b64_tr_b16 v[60:61], v8 offset:45056
    s_waitcnt lgkmcnt(6)
    v_mfma_f32_32x32x16_bf16 v[116:131], v[32:35], v[36:39], v[116:131]
    ds_read_b64_tr_b16 v[62:63], v8 offset:46080
    ds_read_b128 v[56:59], v7 offset:41696
    v_mul_f32 v72, v72, v136
    v_mul_f32 v73, v73, v137
    v_mul_f32 v74, v74, v138
    v_mul_f32 v75, v75, v139
    s_waitcnt lgkmcnt(5)
    v_mfma_f32_32x32x16_bf16 v[100:115], v[40:43], v[48:51], v[100:115]
    ds_read_b128 v[28:31], v7 offset:256
    ds_read_b64_tr_b16 v[36:37], v8 offset:49152
    s_waitcnt lgkmcnt(6)
    v_mfma_f32_32x32x16_bf16 v[116:131], v[44:47], v[48:51], v[116:131]
    ds_read_b64_tr_b16 v[38:39], v8 offset:50176
    ds_read_b128 v[32:35], v7 offset:41728
    v_cvt_pk_bf16_f32 v68, v68, v69
    v_cvt_pk_bf16_f32 v69, v70, v71
    v_cvt_pk_bf16_f32 v70, v72, v73
    v_cvt_pk_bf16_f32 v71, v74, v75
    buffer_store_dwordx4 v[68:71], v12, s[16:19], s40 offen offset:0 sc1
    s_waitcnt lgkmcnt(5)
    v_mfma_f32_32x32x16_bf16 v[100:115], v[52:55], v[60:63], v[100:115]
    ds_read_b128 v[40:43], v7 offset:288
    ds_read_b64_tr_b16 v[48:49], v8 offset:53248
    s_waitcnt lgkmcnt(6)
    v_mfma_f32_32x32x16_bf16 v[116:131], v[56:59], v[60:63], v[116:131]
    ds_read_b64_tr_b16 v[50:51], v8 offset:54272
    ds_read_b128 v[44:47], v7 offset:41760
    v_mul_f32 v76, v76, v140
    v_mul_f32 v77, v77, v141
    v_mul_f32 v78, v78, v142
    v_mul_f32_e64 v79, v79, v143
    s_barrier
    s_waitcnt lgkmcnt(5)
    v_mfma_f32_32x32x16_bf16 v[100:115], v[28:31], v[36:39], v[100:115]
    ds_read_b128 v[52:55], v7 offset:320
    ds_read_b64_tr_b16 v[60:61], v8 offset:57344
    s_waitcnt lgkmcnt(6)
    v_mfma_f32_32x32x16_bf16 v[116:131], v[32:35], v[36:39], v[116:131]
    ds_read_b64_tr_b16 v[62:63], v8 offset:58368
    ds_read_b128 v[56:59], v7 offset:41792
    v_mul_f32 v80, v80, v144
    v_mul_f32 v81, v81, v145
    v_mul_f32 v82, v82, v146
    v_mul_f32 v83, v83, v147
    s_waitcnt lgkmcnt(5)
    v_mfma_f32_32x32x16_bf16 v[100:115], v[40:43], v[48:51], v[100:115]
    ds_read_b128 v[28:31], v7 offset:352
    ds_read_b64_tr_b16 v[36:37], v9 offset:0
    s_waitcnt lgkmcnt(6)
    v_mfma_f32_32x32x16_bf16 v[116:131], v[44:47], v[48:51], v[116:131]
    ds_read_b64_tr_b16 v[38:39], v9 offset:1024
    ds_read_b128 v[32:35], v7 offset:41824
    v_cvt_pk_bf16_f32 v76, v76, v77
    v_cvt_pk_bf16_f32 v77, v78, v79
    v_cvt_pk_bf16_f32 v78, v80, v81
    v_cvt_pk_bf16_f32 v79, v82, v83
    buffer_store_dwordx4 v[76:79], v12, s[16:19], s40 offen offset:768 sc1
    s_waitcnt lgkmcnt(5)
    v_mfma_f32_32x32x16_bf16 v[100:115], v[52:55], v[60:63], v[100:115]
    ds_read_b128 v[40:43], v7 offset:384
    ds_read_b64_tr_b16 v[48:49], v9 offset:4096
    s_waitcnt lgkmcnt(6)
    v_mfma_f32_32x32x16_bf16 v[116:131], v[56:59], v[60:63], v[116:131]
    ds_read_b64_tr_b16 v[50:51], v9 offset:5120
    ds_read_b128 v[44:47], v7 offset:41856
    v_mul_f32 v84, v84, v148
    v_mul_f32 v85, v85, v149
    v_mul_f32 v86, v86, v150
    v_mul_f32 v87, v87, v151
    s_waitcnt lgkmcnt(5)
    v_mfma_f32_32x32x16_bf16 v[100:115], v[28:31], v[36:39], v[100:115]
    ds_read_b128 v[52:55], v7 offset:416
    ds_read_b64_tr_b16 v[60:61], v9 offset:8192
    s_waitcnt lgkmcnt(6)
    v_mfma_f32_32x32x16_bf16 v[116:131], v[32:35], v[36:39], v[116:131]
    ds_read_b64_tr_b16 v[62:63], v9 offset:9216
    ds_read_b128 v[56:59], v7 offset:41888
    v_mul_f32 v88, v88, v152
    v_mul_f32 v89, v89, v153
    v_mul_f32 v90, v90, v154
    v_mul_f32_e64 v91, v91, v155
    s_barrier
    s_waitcnt lgkmcnt(5)
    v_mfma_f32_32x32x16_bf16 v[100:115], v[40:43], v[48:51], v[100:115]
    ds_read_b128 v[28:31], v7 offset:448
    ds_read_b64_tr_b16 v[36:37], v8 offset:0
    s_waitcnt lgkmcnt(6)
    v_mfma_f32_32x32x16_bf16 v[116:131], v[44:47], v[48:51], v[116:131]
    ds_read_b64_tr_b16 v[38:39], v8 offset:1024
    ds_read_b128 v[32:35], v7 offset:41920
    v_cvt_pk_bf16_f32 v84, v84, v85
    v_cvt_pk_bf16_f32 v85, v86, v87
    v_cvt_pk_bf16_f32 v86, v88, v89
    v_cvt_pk_bf16_f32 v87, v90, v91
    buffer_store_dwordx4 v[84:87], v12, s[16:19], s23 offen offset:0 sc1
    s_waitcnt lgkmcnt(5)
    v_mfma_f32_32x32x16_bf16 v[100:115], v[52:55], v[60:63], v[100:115]
    ds_read_b128 v[40:43], v7 offset:480
    ds_read_b64_tr_b16 v[48:49], v8 offset:4096
    s_waitcnt lgkmcnt(6)
    v_mfma_f32_32x32x16_bf16 v[116:131], v[56:59], v[60:63], v[116:131]
    ds_read_b64_tr_b16 v[50:51], v8 offset:5120
    ds_read_b128 v[44:47], v7 offset:41952
    v_mul_f32 v92, v92, v156
    v_mul_f32 v93, v93, v157
    v_mul_f32 v94, v94, v158
    v_mul_f32 v95, v95, v159
    s_waitcnt lgkmcnt(5)
    v_mfma_f32_32x32x16_bf16 v[100:115], v[28:31], v[36:39], v[100:115]
    ds_read_b128 v[52:55], v7 offset:512
    ds_read_b64_tr_b16 v[60:61], v8 offset:8192
    s_waitcnt lgkmcnt(6)
    v_mfma_f32_32x32x16_bf16 v[116:131], v[32:35], v[36:39], v[116:131]
    ds_read_b64_tr_b16 v[62:63], v8 offset:9216
    ds_read_b128 v[56:59], v7 offset:41984
    v_mul_f32 v96, v96, v160
    v_mul_f32 v97, v97, v161
    v_mul_f32 v98, v98, v162
    v_mul_f32 v99, v99, v163
    s_waitcnt lgkmcnt(5)
    v_mfma_f32_32x32x16_bf16 v[100:115], v[40:43], v[48:51], v[100:115]
    ds_read_b128 v[28:31], v7 offset:544
    ds_read_b64_tr_b16 v[36:37], v8 offset:12288
    s_waitcnt lgkmcnt(6)
    v_mfma_f32_32x32x16_bf16 v[116:131], v[44:47], v[48:51], v[116:131]
    ds_read_b64_tr_b16 v[38:39], v8 offset:13312
    ds_read_b128 v[32:35], v7 offset:42016
    v_cvt_pk_bf16_f32 v92, v92, v93
    v_cvt_pk_bf16_f32 v93, v94, v95
    v_cvt_pk_bf16_f32 v94, v96, v97
    v_cvt_pk_bf16_f32 v95, v98, v99
    buffer_store_dwordx4 v[92:95], v12, s[16:19], s23 offen offset:768 sc1
    s_barrier
    s_waitcnt lgkmcnt(5)
    v_mfma_f32_32x32x16_bf16 v[100:115], v[52:55], v[60:63], v[100:115]
    ds_read_b128 v[40:43], v7 offset:576
    ds_read_b64_tr_b16 v[48:49], v8 offset:16384
    s_waitcnt lgkmcnt(6)
    v_mfma_f32_32x32x16_bf16 v[116:131], v[56:59], v[60:63], v[116:131]
    ds_read_b64_tr_b16 v[50:51], v8 offset:17408
    ds_read_b128 v[44:47], v7 offset:42048
    s_waitcnt lgkmcnt(5)
    v_mfma_f32_32x32x16_bf16 v[100:115], v[28:31], v[36:39], v[100:115]
    ds_read_b128 v[52:55], v7 offset:608
    ds_read_b64_tr_b16 v[60:61], v8 offset:20480
    s_waitcnt lgkmcnt(6)
    v_mfma_f32_32x32x16_bf16 v[116:131], v[32:35], v[36:39], v[116:131]
    ds_read_b64_tr_b16 v[62:63], v8 offset:21504
    ds_read_b128 v[56:59], v7 offset:42080
    s_waitcnt lgkmcnt(5)
    v_mfma_f32_32x32x16_bf16 v[100:115], v[40:43], v[48:51], v[100:115]
    ds_read_b128 v[28:31], v7 offset:640
    ds_read_b64_tr_b16 v[36:37], v8 offset:24576
    s_waitcnt lgkmcnt(6)
    v_mfma_f32_32x32x16_bf16 v[116:131], v[44:47], v[48:51], v[116:131]
    ds_read_b64_tr_b16 v[38:39], v8 offset:25600
    ds_read_b128 v[32:35], v7 offset:42112
    s_waitcnt lgkmcnt(5)
    v_mfma_f32_32x32x16_bf16 v[100:115], v[52:55], v[60:63], v[100:115]
    ds_read_b128 v[40:43], v7 offset:672
    ds_read_b64_tr_b16 v[48:49], v8 offset:28672
    s_waitcnt lgkmcnt(6)
    v_mfma_f32_32x32x16_bf16 v[116:131], v[56:59], v[60:63], v[116:131]
    ds_read_b64_tr_b16 v[50:51], v8 offset:29696
    ds_read_b128 v[44:47], v7 offset:42144
    s_barrier
    s_waitcnt lgkmcnt(5)
    v_mfma_f32_32x32x16_bf16 v[100:115], v[28:31], v[36:39], v[100:115]
    ds_read_b128 v[52:55], v7 offset:704
    ds_read_b64_tr_b16 v[60:61], v8 offset:32768
    s_waitcnt lgkmcnt(6)
    v_mfma_f32_32x32x16_bf16 v[116:131], v[32:35], v[36:39], v[116:131]
    ds_read_b64_tr_b16 v[62:63], v8 offset:33792
    ds_read_b128 v[56:59], v7 offset:42176
    s_waitcnt lgkmcnt(5)
    v_mfma_f32_32x32x16_bf16 v[100:115], v[40:43], v[48:51], v[100:115]
    ds_read_b128 v[28:31], v7 offset:736
    ds_read_b64_tr_b16 v[36:37], v8 offset:36864
    s_waitcnt lgkmcnt(6)
    v_mfma_f32_32x32x16_bf16 v[116:131], v[44:47], v[48:51], v[116:131]
    ds_read_b64_tr_b16 v[38:39], v8 offset:37888
    ds_read_b128 v[32:35], v7 offset:42208
    s_waitcnt lgkmcnt(5)
    v_mfma_f32_32x32x16_bf16 v[100:115], v[52:55], v[60:63], v[100:115]
    ds_read_b128 v[40:43], v7 offset:768
    ds_read_b64_tr_b16 v[48:49], v8 offset:40960
    s_waitcnt lgkmcnt(6)
    v_mfma_f32_32x32x16_bf16 v[116:131], v[56:59], v[60:63], v[116:131]
    ds_read_b64_tr_b16 v[50:51], v8 offset:41984
    ds_read_b128 v[44:47], v7 offset:42240
    s_waitcnt lgkmcnt(5)
    v_mfma_f32_32x32x16_bf16 v[100:115], v[28:31], v[36:39], v[100:115]
    ds_read_b128 v[52:55], v7 offset:800
    ds_read_b64_tr_b16 v[60:61], v8 offset:45056
    s_waitcnt lgkmcnt(6)
    v_mfma_f32_32x32x16_bf16 v[116:131], v[32:35], v[36:39], v[116:131]
    ds_read_b64_tr_b16 v[62:63], v8 offset:46080
    ds_read_b128 v[56:59], v7 offset:42272
    s_barrier
    s_waitcnt lgkmcnt(5)
    v_mfma_f32_32x32x16_bf16 v[100:115], v[40:43], v[48:51], v[100:115]
    ds_read_b128 v[28:31], v7 offset:832
    ds_read_b64_tr_b16 v[36:37], v8 offset:49152
    s_waitcnt lgkmcnt(6)
    v_mfma_f32_32x32x16_bf16 v[116:131], v[44:47], v[48:51], v[116:131]
    ds_read_b64_tr_b16 v[38:39], v8 offset:50176
    ds_read_b128 v[32:35], v7 offset:42304
    s_waitcnt lgkmcnt(5)
    v_mfma_f32_32x32x16_bf16 v[100:115], v[52:55], v[60:63], v[100:115]
    ds_read_b128 v[40:43], v7 offset:864
    ds_read_b64_tr_b16 v[48:49], v8 offset:53248
    s_waitcnt lgkmcnt(6)
    v_mfma_f32_32x32x16_bf16 v[116:131], v[56:59], v[60:63], v[116:131]
    ds_read_b64_tr_b16 v[50:51], v8 offset:54272
    ds_read_b128 v[44:47], v7 offset:42336
    s_waitcnt lgkmcnt(5)
    v_mfma_f32_32x32x16_bf16 v[100:115], v[28:31], v[36:39], v[100:115]
    ds_read_b128 v[52:55], v7 offset:896
    ds_read_b64_tr_b16 v[60:61], v8 offset:57344
    s_waitcnt lgkmcnt(6)
    v_mfma_f32_32x32x16_bf16 v[116:131], v[32:35], v[36:39], v[116:131]
    ds_read_b64_tr_b16 v[62:63], v8 offset:58368
    ds_read_b128 v[56:59], v7 offset:42368
    s_waitcnt lgkmcnt(5)
    v_mfma_f32_32x32x16_bf16 v[100:115], v[40:43], v[48:51], v[100:115]
    ds_read_b128 v[28:31], v7 offset:928
    ds_read_b64_tr_b16 v[36:37], v9 offset:0
    s_waitcnt lgkmcnt(6)
    v_mfma_f32_32x32x16_bf16 v[116:131], v[44:47], v[48:51], v[116:131]
    ds_read_b64_tr_b16 v[38:39], v9 offset:1024
    ds_read_b128 v[32:35], v7 offset:42400
    s_barrier
    s_waitcnt lgkmcnt(5)
    v_mfma_f32_32x32x16_bf16 v[100:115], v[52:55], v[60:63], v[100:115]
    ds_read_b128 v[40:43], v7 offset:960
    ds_read_b64_tr_b16 v[48:49], v9 offset:4096
    s_waitcnt lgkmcnt(6)
    v_mfma_f32_32x32x16_bf16 v[116:131], v[56:59], v[60:63], v[116:131]
    ds_read_b64_tr_b16 v[50:51], v9 offset:5120
    ds_read_b128 v[44:47], v7 offset:42432
    s_waitcnt lgkmcnt(5)
    v_mfma_f32_32x32x16_bf16 v[100:115], v[28:31], v[36:39], v[100:115]
    ds_read_b128 v[52:55], v7 offset:992
    ds_read_b64_tr_b16 v[60:61], v9 offset:8192
    s_waitcnt lgkmcnt(6)
    v_mfma_f32_32x32x16_bf16 v[116:131], v[32:35], v[36:39], v[116:131]
    ds_read_b64_tr_b16 v[62:63], v9 offset:9216
    ds_read_b128 v[56:59], v7 offset:42464
    s_waitcnt lgkmcnt(5)
    v_mfma_f32_32x32x16_bf16 v[100:115], v[40:43], v[48:51], v[100:115]
    ds_read_b128 v[28:31], v7 offset:1024
    ds_read_b64_tr_b16 v[36:37], v8 offset:0
    s_waitcnt lgkmcnt(6)
    v_mfma_f32_32x32x16_bf16 v[116:131], v[44:47], v[48:51], v[116:131]
    ds_read_b64_tr_b16 v[38:39], v8 offset:1024
    ds_read_b128 v[32:35], v7 offset:42496
    s_waitcnt lgkmcnt(5)
    v_mfma_f32_32x32x16_bf16 v[100:115], v[52:55], v[60:63], v[100:115]
    ds_read_b128 v[40:43], v7 offset:1056
    ds_read_b64_tr_b16 v[48:49], v8 offset:4096
    s_waitcnt lgkmcnt(6)
    v_mfma_f32_32x32x16_bf16 v[116:131], v[56:59], v[60:63], v[116:131]
    ds_read_b64_tr_b16 v[50:51], v8 offset:5120
    ds_read_b128 v[44:47], v7 offset:42528
    s_barrier
    s_waitcnt lgkmcnt(5)
    v_mfma_f32_32x32x16_bf16 v[100:115], v[28:31], v[36:39], v[100:115]
    ds_read_b128 v[52:55], v7 offset:1088
    ds_read_b64_tr_b16 v[60:61], v8 offset:8192
    s_waitcnt lgkmcnt(6)
    v_mfma_f32_32x32x16_bf16 v[116:131], v[32:35], v[36:39], v[116:131]
    ds_read_b64_tr_b16 v[62:63], v8 offset:9216
    ds_read_b128 v[56:59], v7 offset:42560
    s_waitcnt lgkmcnt(5)
    v_mfma_f32_32x32x16_bf16 v[100:115], v[40:43], v[48:51], v[100:115]
    ds_read_b128 v[28:31], v7 offset:1120
    ds_read_b64_tr_b16 v[36:37], v8 offset:12288
    s_waitcnt lgkmcnt(6)
    v_mfma_f32_32x32x16_bf16 v[116:131], v[44:47], v[48:51], v[116:131]
    ds_read_b64_tr_b16 v[38:39], v8 offset:13312
    ds_read_b128 v[32:35], v7 offset:42592
    s_waitcnt lgkmcnt(5)
    v_mfma_f32_32x32x16_bf16 v[100:115], v[52:55], v[60:63], v[100:115]
    ds_read_b128 v[40:43], v7 offset:1152
    ds_read_b64_tr_b16 v[48:49], v8 offset:16384
    s_waitcnt lgkmcnt(6)
    v_mfma_f32_32x32x16_bf16 v[116:131], v[56:59], v[60:63], v[116:131]
    ds_read_b64_tr_b16 v[50:51], v8 offset:17408
    ds_read_b128 v[44:47], v7 offset:42624
    s_waitcnt lgkmcnt(5)
    v_mfma_f32_32x32x16_bf16 v[100:115], v[28:31], v[36:39], v[100:115]
    ds_read_b128 v[52:55], v7 offset:1184
    ds_read_b64_tr_b16 v[60:61], v8 offset:20480
    s_waitcnt lgkmcnt(6)
    v_mfma_f32_32x32x16_bf16 v[116:131], v[32:35], v[36:39], v[116:131]
    ds_read_b64_tr_b16 v[62:63], v8 offset:21504
    ds_read_b128 v[56:59], v7 offset:42656
    s_barrier
    s_waitcnt lgkmcnt(5)
    v_mfma_f32_32x32x16_bf16 v[100:115], v[40:43], v[48:51], v[100:115]
    ds_read_b128 v[28:31], v7 offset:1216
    ds_read_b64_tr_b16 v[36:37], v8 offset:24576
    s_waitcnt lgkmcnt(6)
    v_mfma_f32_32x32x16_bf16 v[116:131], v[44:47], v[48:51], v[116:131]
    ds_read_b64_tr_b16 v[38:39], v8 offset:25600
    ds_read_b128 v[32:35], v7 offset:42688
    s_waitcnt lgkmcnt(5)
    v_mfma_f32_32x32x16_bf16 v[100:115], v[52:55], v[60:63], v[100:115]
    ds_read_b128 v[40:43], v7 offset:1248
    ds_read_b64_tr_b16 v[48:49], v8 offset:28672
    s_waitcnt lgkmcnt(6)
    v_mfma_f32_32x32x16_bf16 v[116:131], v[56:59], v[60:63], v[116:131]
    ds_read_b64_tr_b16 v[50:51], v8 offset:29696
    ds_read_b128 v[44:47], v7 offset:42720
    s_waitcnt lgkmcnt(5)
    v_mfma_f32_32x32x16_bf16 v[100:115], v[28:31], v[36:39], v[100:115]
    s_waitcnt lgkmcnt(4)
    v_mfma_f32_32x32x16_bf16 v[116:131], v[32:35], v[36:39], v[116:131]
    s_waitcnt lgkmcnt(1)
    v_mfma_f32_32x32x16_bf16 v[100:115], v[40:43], v[48:51], v[100:115]
    s_waitcnt lgkmcnt(0)
    v_mfma_f32_32x32x16_bf16 v[116:131], v[44:47], v[48:51], v[116:131]
    s_nop 10
    s_add_u32 s23, s41, s43
    v_mul_f32 v100, v100, v132
    v_mul_f32 v101, v101, v133
    v_mul_f32 v102, v102, v134
    v_mul_f32 v103, v103, v135
    v_mul_f32 v104, v104, v136
    v_mul_f32 v105, v105, v137
    v_mul_f32 v106, v106, v138
    v_mul_f32_e64 v107, v107, v139
    v_cvt_pk_bf16_f32 v100, v100, v101
    v_cvt_pk_bf16_f32 v101, v102, v103
    v_cvt_pk_bf16_f32 v102, v104, v105
    v_cvt_pk_bf16_f32 v103, v106, v107
    buffer_store_dwordx4 v[100:103], v16, s[16:19], s41 offen offset:0 sc1
    v_mul_f32 v108, v108, v140
    v_mul_f32 v109, v109, v141
    v_mul_f32 v110, v110, v142
    v_mul_f32 v111, v111, v143
    v_mul_f32 v112, v112, v144
    v_mul_f32 v113, v113, v145
    v_mul_f32 v114, v114, v146
    v_mul_f32 v115, v115, v147
    v_cvt_pk_bf16_f32 v108, v108, v109
    v_cvt_pk_bf16_f32 v109, v110, v111
    v_cvt_pk_bf16_f32 v110, v112, v113
    v_cvt_pk_bf16_f32 v111, v114, v115
    buffer_store_dwordx4 v[108:111], v16, s[16:19], s41 offen offset:768 sc1
    v_mul_f32 v116, v116, v148
    v_mul_f32 v117, v117, v149
    v_mul_f32 v118, v118, v150
    v_mul_f32 v119, v119, v151
    v_mul_f32 v120, v120, v152
    v_mul_f32 v121, v121, v153
    v_mul_f32 v122, v122, v154
    v_mul_f32 v123, v123, v155
    v_cvt_pk_bf16_f32 v116, v116, v117
    v_cvt_pk_bf16_f32 v117, v118, v119
    v_cvt_pk_bf16_f32 v118, v120, v121
    v_cvt_pk_bf16_f32 v119, v122, v123
    buffer_store_dwordx4 v[116:119], v16, s[16:19], s23 offen offset:0 sc1
    v_mul_f32 v124, v124, v156
    v_mul_f32 v125, v125, v157
    v_mul_f32 v126, v126, v158
    v_mul_f32 v127, v127, v159
    v_mul_f32 v128, v128, v160
    v_mul_f32 v129, v129, v161
    v_mul_f32 v130, v130, v162
    v_mul_f32 v131, v131, v163
    v_cvt_pk_bf16_f32 v124, v124, v125
    v_cvt_pk_bf16_f32 v125, v126, v127
    v_cvt_pk_bf16_f32 v126, v128, v129
    v_cvt_pk_bf16_f32 v127, v130, v131
    buffer_store_dwordx4 v[124:127], v16, s[16:19], s23 offen offset:768 sc1
    s_branch z1_pub
onepass_2:
    s_waitcnt lgkmcnt(0)
    v_mfma_f32_32x32x16_bf16 v[68:83], v[52:55], v[60:63], v[68:83]
    v_mfma_f32_32x32x16_bf16 v[84:99], v[56:59], v[60:63], v[84:99]
    v_mfma_f32_32x32x16_bf16 v[68:83], v[28:31], v[36:39], v[68:83]
    v_mfma_f32_32x32x16_bf16 v[84:99], v[32:35], v[36:39], v[84:99]
    s_nop 15
    s_add_u32 s23, s40, s42
    v_mul_f32 v68, v68, v132
    v_mul_f32 v69, v69, v133
    v_mul_f32 v70, v70, v134
    v_mul_f32 v71, v71, v135
    v_mul_f32 v72, v72, v136
    v_mul_f32 v73, v73, v137
    v_mul_f32 v74, v74, v138
    v_mul_f32 v75, v75, v139
    v_cvt_pk_bf16_f32 v68, v68, v69
    v_cvt_pk_bf16_f32 v69, v70, v71
    v_cvt_pk_bf16_f32 v70, v72, v73
    v_cvt_pk_bf16_f32 v71, v74, v75
    buffer_store_dwordx4 v[68:71], v12, s[16:19], s40 offen offset:0 sc1
    v_mul_f32 v76, v76, v140
    v_mul_f32 v77, v77, v141
    v_mul_f32 v78, v78, v142
    v_mul_f32 v79, v79, v143
    v_mul_f32 v80, v80, v144
    v_mul_f32 v81, v81, v145
    v_mul_f32 v82, v82, v146
    v_mul_f32 v83, v83, v147
    v_cvt_pk_bf16_f32 v76, v76, v77
    v_cvt_pk_bf16_f32 v77, v78, v79
    v_cvt_pk_bf16_f32 v78, v80, v81
    v_cvt_pk_bf16_f32 v79, v82, v83
    buffer_store_dwordx4 v[76:79], v12, s[16:19], s40 offen offset:768 sc1
    v_mul_f32 v84, v84, v148
    v_mul_f32 v85, v85, v149
    v_mul_f32 v86, v86, v150
    v_mul_f32 v87, v87, v151
    v_mul_f32 v88, v88, v152
    v_mul_f32 v89, v89, v153
    v_mul_f32 v90, v90, v154
    v_mul_f32 v91, v91, v155
    v_cvt_pk_bf16_f32 v84, v84, v85
    v_cvt_pk_bf16_f32 v85, v86, v87
    v_cvt_pk_bf16_f32 v86, v88, v89
    v_cvt_pk_bf16_f32 v87, v90, v91
    buffer_store_dwordx4 v[84:87], v12, s[16:19], s23 offen offset:0 sc1
    v_mul_f32 v92, v92, v156
    v_mul_f32 v93, v93, v157
    v_mul_f32 v94, v94, v158
    v_mul_f32 v95, v95, v159
    v_mul_f32 v96, v96, v160
    v_mul_f32 v97, v97, v161
    v_mul_f32 v98, v98, v162
    v_mul_f32 v99, v99, v163
    v_cvt_pk_bf16_f32 v92, v92, v93
    v_cvt_pk_bf16_f32 v93, v94, v95
    v_cvt_pk_bf16_f32 v94, v96, v97
    v_cvt_pk_bf16_f32 v95, v98, v99
    buffer_store_dwordx4 v[92:95], v12, s[16:19], s23 offen offset:768 sc1
    s_branch z1_pub
z1_pub:
    s_waitcnt lgkmcnt(0)
    s_mul_i32 s84, s84, 0x9e3779b1
    s_add_u32 s84, s84, 0x7f4a7c15
    s_waitcnt vmcnt(0)
    s_barrier
    s_branch z_attn
z1_load:
    s_mov_b32 s31, s20
    s_lshl_b32 s33, s36, 2
    s_lshl_b32 s23, s33, 2
    s_add_u32 s23, s23, s31
    s_mul_i32 s24, s23, 15360
    s_lshl_b32 s23, s22, 9
    s_add_u32 s24, s24, s23
    s_lshl_b32 s25, s31, 10
    s_add_u32 s25, s25, 83200
    s_mul_i32 s46, s22, 10
    s_add_u32 s46, s46, s31
    s_cmp_ge_u32 s46, 40
    s_cselect_b32 s26, 40, 0
    s_cselect_b32 s30, 41472, 0
    s_cselect_b32 s44, 40960, 0
    s_sub_u32 s26, s46, s26
    s_lshl_b32 s23, s26, 5
    s_add_u32 s30, s30, s23
    v_add_u32_e64 v12, s30, v7
    s_lshl_b32 s23, s36, 2
    s_add_u32 s26, s26, s23
    s_cmp_ge_u32 s26, 40
    s_cselect_b32 s23, 40, 0
    s_sub_u32 s26, s26, s23
    s_lshl_b32 s26, s26, 10
    s_add_u32 s26, s26, s44
    s_mul_i32 s23, s21, 81920
    s_add_u32 s26, s26, s23
    s_add_u32 s40, s26, 16777216
    s_add_u32 s46, s46, 4
    s_cmp_ge_u32 s46, 40
    s_cselect_b32 s26, 40, 0
    s_cselect_b32 s30, 41472, 0
    s_cselect_b32 s44, 40960, 0
    s_sub_u32 s26, s46, s26
    s_lshl_b32 s23, s26, 5
    s_add_u32 s30, s30, s23
    v_add_u32_e64 v13, s30, v7
    s_lshl_b32 s23, s36, 2
    s_add_u32 s26, s26, s23
    s_cmp_ge_u32 s26, 40
    s_cselect_b32 s23, 40, 0
    s_sub_u32 s26, s26, s23
    s_lshl_b32 s26, s26, 10
    s_add_u32 s26, s26, s44
    s_mul_i32 s23, s21, 81920
    s_add_u32 s26, s26, s23
    s_add_u32 s41, s26, 16777216
    s_add_u32 s46, s46, 4
    s_cmp_ge_u32 s46, 40
    s_cselect_b32 s26, 40, 0
    s_cselect_b32 s30, 41472, 0
    s_cselect_b32 s44, 40960, 0
    s_sub_u32 s26, s46, s26
    s_lshl_b32 s23, s26, 5
    s_add_u32 s30, s30, s23
    v_add_u32_e64 v14, s30, v7
    s_lshl_b32 s23, s36, 2
    s_add_u32 s26, s26, s23
    s_cmp_ge_u32 s26, 40
    s_cselect_b32 s23, 40, 0
    s_sub_u32 s26, s26, s23
    s_lshl_b32 s26, s26, 10
    s_add_u32 s26, s26, s44
    s_mul_i32 s23, s21, 81920
    s_add_u32 s26, s26, s23
    s_add_u32 s42, s26, 16777216
    s_add_u32 s46, s46, 4
    s_cmp_ge_u32 s31, 2
    s_cselect_b32 s42, 47185920, s42
    s_lshl_b32 s23, s21, 8
    s_add_u32 s30, s23, 19922944
    s_lshl_b32 s26, s22, 2
    s_add_u32 s26, s26, s31
    s_cmp_eq_u32 s26, 3
    s_cselect_b32 s30, s30, 47185920
    s_lshl_b32 s44, s21, 3
    s_add_u32 s44, s44, s22
    s_lshl_b32 s44, s44, 7
    s_add_u32 s44, s44, 46170112
    s_lshl_b32 s45, s22, 5
    s_add_u32 s45, s45, s21
    s_lshl_b32 s45, s45, 7
    s_add_u32 s45, s45, 46137344
    s_cmp_lg_u32 s31, 0
    s_cselect_b32 s44, 47185920, s44
    s_cselect_b32 s45, 47185920, s45
    v_lshrrev_b32_e64 v15, 1, v1
    v_mul_u32_u24 v15, 3840, v15
    v_and_b32_e64 v16, 1, v1
    v_lshl_add_u32 v15, v16, 7, v15
    s_and_b32 s23, s21, 7
    s_lshl_b32 s23, s23, 2
    s_add_u32 s23, s23, s31
    s_mul_i32 s46, s23, 76800
    s_lshl_b32 s23, s22, 9
    s_add_u32 s46, s46, s23
    s_add_u32 s46, s46, 256
    v_mov_b32 v21, 0x3f803f80
    v_mov_b32 v22, 0x00003f80
    v_mov_b32 v23, 0x3f800000
    v_mov_b32 v24, 0
    v_mov_b32 v25, 0
    v_mov_b32 v26, 0
    v_mov_b32 v27, 0
    s_waitcnt vmcnt(9)
    v_dot2c_f32_bf16 v24, v28, v21
    v_dot2c_f32_bf16 v25, v29, v21
    v_dot2c_f32_bf16 v26, v30, v21
    v_dot2c_f32_bf16 v27, v31, v21
    s_waitcnt vmcnt(8)
    v_dot2c_f32_bf16 v24, v32, v21
    v_dot2c_f32_bf16 v25, v33, v21
    v_dot2c_f32_bf16 v26, v34, v21
    v_dot2c_f32_bf16 v27, v35, v21
    s_waitcnt vmcnt(7)
    v_dot2c_f32_bf16 v24, v36, v21
    v_dot2c_f32_bf16 v25, v37, v21
    v_dot2c_f32_bf16 v26, v38, v21
    v_dot2c_f32_bf16 v27, v39, v21
    s_waitcnt vmcnt(6)
    v_dot2c_f32_bf16 v24, v40, v21
    v_dot2c_f32_bf16 v25, v41, v21
    v_dot2c_f32_bf16 v26, v42, v21
    v_dot2c_f32_bf16 v27, v43, v21
    s_waitcnt vmcnt(5)
    v_dot2c_f32_bf16 v24, v44, v21
    v_dot2c_f32_bf16 v25, v45, v21
    v_dot2c_f32_bf16 v26, v46, v21
    v_dot2c_f32_bf16 v27, v47, v21
    s_waitcnt vmcnt(4)
    v_dot2c_f32_bf16 v24, v48, v21
    v_dot2c_f32_bf16 v25, v49, v21
    v_dot2c_f32_bf16 v26, v50, v21
    v_dot2c_f32_bf16 v27, v51, v21
    s_waitcnt vmcnt(3)
    v_dot2c_f32_bf16 v24, v52, v21
    v_dot2c_f32_bf16 v25, v53, v21
    v_dot2c_f32_bf16 v26, v54, v21
    v_dot2c_f32_bf16 v27, v55, v21
    s_waitcnt vmcnt(2)
    v_dot2c_f32_bf16 v24, v56, v21
    v_dot2c_f32_bf16 v25, v57, v21
    v_dot2c_f32_bf16 v26, v58, v21
    v_dot2c_f32_bf16 v27, v59, v21
    s_waitcnt vmcnt(1)
    v_dot2c_f32_bf16 v24, v60, v21
    v_dot2c_f32_bf16 v25, v61, v21
    v_dot2c_f32_bf16 v26, v62, v21
    v_dot2c_f32_bf16 v27, v63, v21
    s_waitcnt vmcnt(0)
    v_dot2c_f32_bf16 v24, v64, v21
    v_dot2c_f32_bf16 v25, v65, v21
    v_dot2c_f32_bf16 v26, v66, v21
    v_dot2c_f32_bf16 v27, v67, v21
    s_nop 2
    v_add_f32 v24, v24, v25
    v_add_f32 v26, v26, v27
    v_add_f32_e64 v20, v24, v26
    s_nop 1
    v_add_f32 v20, v20, v20 quad_perm:[1,0,3,2] row_mask:0xf bank_mask:0xf
    s_nop 1
    v_add_f32 v20, v20, v20 quad_perm:[2,3,0,1] row_mask:0xf bank_mask:0xf
    s_nop 1
    v_add_f32 v20, v20, v20 row_half_mirror row_mask:0xf bank_mask:0xf
    v_mul_f32 v20, 0xbacccccd, v20
    v_dot2_f32_bf16 v68, v28, v22, v20
    v_dot2_f32_bf16 v69, v28, v23, v20
    v_dot2_f32_bf16 v70, v29, v22, v20
    v_dot2_f32_bf16 v71, v29, v23, v20
    v_dot2_f32_bf16 v72, v30, v22, v20
    v_dot2_f32_bf16 v73, v30, v23, v20
    v_dot2_f32_bf16 v74, v31, v22, v20
    v_dot2_f32_bf16 v75, v31, v23, v20
    s_add_u32 m0, s25, 0
    s_add_u32 s33, s33, 1
    buffer_load_dwordx4 v10, s[12:15], s24 offen lds
    s_cmp_eq_u32 s33, 40
    s_cselect_b32 s23, 2457600, 0
    s_cselect_b32 s33, 0, s33
    s_add_u32 s24, s24, 61440
    s_sub_u32 s24, s24, s23
    v_dot2_f32_bf16 v76, v32, v22, v20
    v_dot2_f32_bf16 v77, v32, v23, v20
    v_dot2_f32_bf16 v78, v33, v22, v20
    v_dot2_f32_bf16 v79, v33, v23, v20
    v_dot2_f32_bf16 v80, v34, v22, v20
    v_dot2_f32_bf16 v81, v34, v23, v20
    v_dot2_f32_bf16 v82, v35, v22, v20
    v_dot2_f32_bf16 v83, v35, v23, v20
    v_cvt_pk_bf16_f32 v28, v68, v69
    v_cvt_pk_bf16_f32 v29, v70, v71
    v_cvt_pk_bf16_f32 v30, v72, v73
    v_cvt_pk_bf16_f32 v31, v74, v75
    ds_write_b128 v11, v[28:31] offset:0
    s_add_u32 m0, s25, 4096
    s_add_u32 s33, s33, 1
    buffer_load_dwordx4 v10, s[12:15], s24 offen lds
    s_cmp_eq_u32 s33, 40
    s_cselect_b32 s23, 2457600, 0
    s_cselect_b32 s33, 0, s33
    s_add_u32 s24, s24, 61440
    s_sub_u32 s24, s24, s23
    v_dot2_f32_bf16 v84, v36, v22, v20
    v_dot2_f32_bf16 v85, v36, v23, v20
    v_dot2_f32_bf16 v86, v37, v22, v20
    v_dot2_f32_bf16 v87, v37, v23, v20
    v_dot2_f32_bf16 v88, v38, v22, v20
    v_dot2_f32_bf16 v89, v38, v23, v20
    v_dot2_f32_bf16 v90, v39, v22, v20
    v_dot2_f32_bf16 v91, v39, v23, v20
    v_cvt_pk_bf16_f32 v32, v76, v77
    v_cvt_pk_bf16_f32 v33, v78, v79
    v_cvt_pk_bf16_f32 v34, v80, v81
    v_cvt_pk_bf16_f32 v35, v82, v83
    ds_write_b128 v11, v[32:35] offset:128
    s_add_u32 m0, s25, 8192
    s_add_u32 s33, s33, 1
    buffer_load_dwordx4 v10, s[12:15], s24 offen lds
    s_cmp_eq_u32 s33, 40
    s_cselect_b32 s23, 2457600, 0
    s_cselect_b32 s33, 0, s33
    s_add_u32 s24, s24, 61440
    s_sub_u32 s24, s24, s23
    v_dot2_f32_bf16 v92, v40, v22, v20
    v_dot2_f32_bf16 v93, v40, v23, v20
    v_dot2_f32_bf16 v94, v41, v22, v20
    v_dot2_f32_bf16 v95, v41, v23, v20
    v_dot2_f32_bf16 v96, v42, v22, v20
    v_dot2_f32_bf16 v97, v42, v23, v20
    v_dot2_f32_bf16 v98, v43, v22, v20
    v_dot2_f32_bf16 v99, v43, v23, v20
    v_cvt_pk_bf16_f32 v36, v84, v85
    v_cvt_pk_bf16_f32 v37, v86, v87
    v_cvt_pk_bf16_f32 v38, v88, v89
    v_cvt_pk_bf16_f32 v39, v90, v91
    ds_write_b128 v11, v[36:39] offset:256
    s_add_u32 m0, s25, 12288
    s_add_u32 s33, s33, 1
    buffer_load_dwordx4 v10, s[12:15], s24 offen lds
    s_cmp_eq_u32 s33, 40
    s_cselect_b32 s23, 2457600, 0
    s_cselect_b32 s33, 0, s33
    s_add_u32 s24, s24, 61440
    s_sub_u32 s24, s24, s23
    v_dot2_f32_bf16 v100, v44, v22, v20
    v_dot2_f32_bf16 v101, v44, v23, v20
    v_dot2_f32_bf16 v102, v45, v22, v20
    v_dot2_f32_bf16 v103, v45, v23, v20
    v_dot2_f32_bf16 v104, v46, v22, v20
    v_dot2_f32_bf16 v105, v46, v23, v20
    v_dot2_f32_bf16 v106, v47, v22, v20
    v_dot2_f32_bf16 v107, v47, v23, v20
    v_cvt_pk_bf16_f32 v40, v92, v93
    v_cvt_pk_bf16_f32 v41, v94, v95
    v_cvt_pk_bf16_f32 v42, v96, v97
    v_cvt_pk_bf16_f32 v43, v98, v99
    ds_write_b128 v11, v[40:43] offset:384
    s_add_u32 m0, s25, 16384
    s_add_u32 s33, s33, 1
    buffer_load_dwordx4 v10, s[12:15], s24 offen lds
    s_cmp_eq_u32 s33, 40
    s_cselect_b32 s23, 2457600, 0
    s_cselect_b32 s33, 0, s33
    s_add_u32 s24, s24, 61440
    s_sub_u32 s24, s24, s23
    v_dot2_f32_bf16 v108, v48, v22, v20
    v_dot2_f32_bf16 v109, v48, v23, v20
    v_dot2_f32_bf16 v110, v49, v22, v20
    v_dot2_f32_bf16 v111, v49, v23, v20
    v_dot2_f32_bf16 v112, v50, v22, v20
    v_dot2_f32_bf16 v113, v50, v23, v20
    v_dot2_f32_bf16 v114, v51, v22, v20
    v_dot2_f32_bf16 v115, v51, v23, v20
    v_cvt_pk_bf16_f32 v44, v100, v101
    v_cvt_pk_bf16_f32 v45, v102, v103
    v_cvt_pk_bf16_f32 v46, v104, v105
    v_cvt_pk_bf16_f32 v47, v106, v107
    ds_write_b128 v11, v[44:47] offset:512
    s_add_u32 m0, s25, 20480
    s_add_u32 s33, s33, 1
    buffer_load_dwordx4 v10, s[12:15], s24 offen lds
    s_cmp_eq_u32 s33, 40
    s_cselect_b32 s23, 2457600, 0
    s_cselect_b32 s33, 0, s33
    s_add_u32 s24, s24, 61440
    s_sub_u32 s24, s24, s23
    v_dot2_f32_bf16 v116, v52, v22, v20
    v_dot2_f32_bf16 v117, v52, v23, v20
    v_dot2_f32_bf16 v118, v53, v22, v20
    v_dot2_f32_bf16 v119, v53, v23, v20
    v_dot2_f32_bf16 v120, v54, v22, v20
    v_dot2_f32_bf16 v121, v54, v23, v20
    v_dot2_f32_bf16 v122, v55, v22, v20
    v_dot2_f32_bf16 v123, v55, v23, v20
    v_cvt_pk_bf16_f32 v48, v108, v109
    v_cvt_pk_bf16_f32 v49, v110, v111
    v_cvt_pk_bf16_f32 v50, v112, v113
    v_cvt_pk_bf16_f32 v51, v114, v115
    ds_write_b128 v11, v[48:51] offset:640
    s_add_u32 m0, s25, 24576
    s_add_u32 s33, s33, 1
    buffer_load_dwordx4 v10, s[12:15], s24 offen lds
    s_cmp_eq_u32 s33, 40
    s_cselect_b32 s23, 2457600, 0
    s_cselect_b32 s33, 0, s33
    s_add_u32 s24, s24, 61440
    s_sub_u32 s24, s24, s23
    v_dot2_f32_bf16 v124, v56, v22, v20
    v_dot2_f32_bf16 v125, v56, v23, v20
    v_dot2_f32_bf16 v126, v57, v22, v20
    v_dot2_f32_bf16 v127, v57, v23, v20
    v_dot2_f32_bf16 v128, v58, v22, v20
    v_dot2_f32_bf16 v129, v58, v23, v20
    v_dot2_f32_bf16 v130, v59, v22, v20
    v_dot2_f32_bf16 v131, v59, v23, v20
    v_cvt_pk_bf16_f32 v52, v116, v117
    v_cvt_pk_bf16_f32 v53, v118, v119
    v_cvt_pk_bf16_f32 v54, v120, v121
    v_cvt_pk_bf16_f32 v55, v122, v123
    ds_write_b128 v11, v[52:55] offset:768
    s_add_u32 m0, s25, 28672
    s_add_u32 s33, s33, 1
    buffer_load_dwordx4 v10, s[12:15], s24 offen lds
    s_cmp_eq_u32 s33, 40
    s_cselect_b32 s23, 2457600, 0
    s_cselect_b32 s33, 0, s33
    s_add_u32 s24, s24, 61440
    s_sub_u32 s24, s24, s23
    v_dot2_f32_bf16 v132, v60, v22, v20
    v_dot2_f32_bf16 v133, v60, v23, v20
    v_dot2_f32_bf16 v134, v61, v22, v20
    v_dot2_f32_bf16 v135, v61, v23, v20
    v_dot2_f32_bf16 v136, v62, v22, v20
    v_dot2_f32_bf16 v137, v62, v23, v20
    v_dot2_f32_bf16 v138, v63, v22, v20
    v_dot2_f32_bf16 v139, v63, v23, v20
    v_cvt_pk_bf16_f32 v56, v124, v125
    v_cvt_pk_bf16_f32 v57, v126, v127
    v_cvt_pk_bf16_f32 v58, v128, v129
    v_cvt_pk_bf16_f32 v59, v130, v131
    ds_write_b128 v11, v[56:59] offset:896
    s_add_u32 m0, s25, 32768
    s_add_u32 s33, s33, 1
    buffer_load_dwordx4 v10, s[12:15], s24 offen lds
    s_cmp_eq_u32 s33, 40
    s_cselect_b32 s23, 2457600, 0
    s_cselect_b32 s33, 0, s33
    s_add_u32 s24, s24, 61440
    s_sub_u32 s24, s24, s23
    v_dot2_f32_bf16 v140, v64, v22, v20
    v_dot2_f32_bf16 v141, v64, v23, v20
    v_dot2_f32_bf16 v142, v65, v22, v20
    v_dot2_f32_bf16 v143, v65, v23, v20
    v_dot2_f32_bf16 v144, v66, v22, v20
    v_dot2_f32_bf16 v145, v66, v23, v20
    v_dot2_f32_bf16 v146, v67, v22, v20
    v_dot2_f32_bf16 v147, v67, v23, v20
    v_cvt_pk_bf16_f32 v60, v132, v133
    v_cvt_pk_bf16_f32 v61, v134, v135
    v_cvt_pk_bf16_f32 v62, v136, v137
    v_cvt_pk_bf16_f32 v63, v138, v139
    ds_write_b128 v11, v[60:63] offset:1024
    s_add_u32 m0, s25, 36864
    s_add_u32 s33, s33, 1
    buffer_load_dwordx4 v10, s[12:15], s24 offen lds
    s_cmp_eq_u32 s33, 40
    s_cselect_b32 s23, 2457600, 0
    s_cselect_b32 s33, 0, s33
    s_add_u32 s24, s24, 61440
    s_sub_u32 s24, s24, s23
    v_mov_b32 v24, 0
    v_mov_b32 v25, 0
    v_mov_b32 v26, 0
    v_mov_b32_e64 v27, 0
    v_cvt_pk_bf16_f32 v64, v140, v141
    v_cvt_pk_bf16_f32 v65, v142, v143
    v_cvt_pk_bf16_f32 v66, v144, v145
    v_cvt_pk_bf16_f32 v67, v146, v147
    ds_write_b128 v11, v[64:67] offset:1152
    v_fmac_f32 v24, v68, v68
    v_fmac_f32 v25, v69, v69
    v_fmac_f32 v26, v70, v70
    v_fmac_f32 v27, v71, v71
    v_fmac_f32 v24, v72, v72
    v_fmac_f32 v25, v73, v73
    v_fmac_f32 v26, v74, v74
    v_fmac_f32 v27, v75, v75
    v_fmac_f32 v24, v76, v76
    v_fmac_f32 v25, v77, v77
    s_add_u32 m0, s25, 40960
    s_add_u32 s33, s33, 1
    buffer_load_dwordx4 v10, s[12:15], s24 offen lds
    s_cmp_eq_u32 s33, 40
    s_cselect_b32 s23, 2457600, 0
    s_cselect_b32 s33, 0, s33
    s_add_u32 s24, s24, 61440
    s_sub_u32 s24, s24, s23
    v_fmac_f32 v26, v78, v78
    v_fmac_f32 v27, v79, v79
    v_fmac_f32 v24, v80, v80
    v_fmac_f32 v25, v81, v81
    v_fmac_f32 v26, v82, v82
    v_fmac_f32 v27, v83, v83
    v_fmac_f32 v24, v84, v84
    v_fmac_f32 v25, v85, v85
    v_fmac_f32 v26, v86, v86
    v_fmac_f32 v27, v87, v87
    s_add_u32 m0, s25, 45056
    s_add_u32 s33, s33, 1
    buffer_load_dwordx4 v10, s[12:15], s24 offen lds
    s_cmp_eq_u32 s33, 40
    s_cselect_b32 s23, 2457600, 0
    s_cselect_b32 s33, 0, s33
    s_add_u32 s24, s24, 61440
    s_sub_u32 s24, s24, s23
    v_fmac_f32 v24, v88, v88
    v_fmac_f32 v25, v89, v89
    v_fmac_f32 v26, v90, v90
    v_fmac_f32 v27, v91, v91
    v_fmac_f32 v24, v92, v92
    v_fmac_f32 v25, v93, v93
    v_fmac_f32 v26, v94, v94
    v_fmac_f32 v27, v95, v95
    v_fmac_f32 v24, v96, v96
    v_fmac_f32 v25, v97, v97
    s_add_u32 m0, s25, 49152
    s_add_u32 s33, s33, 1
    buffer_load_dwordx4 v10, s[12:15], s24 offen lds
    s_cmp_eq_u32 s33, 40
    s_cselect_b32 s23, 2457600, 0
    s_cselect_b32 s33, 0, s33
    s_add_u32 s24, s24, 61440
    s_sub_u32 s24, s24, s23
    v_fmac_f32 v26, v98, v98
    v_fmac_f32 v27, v99, v99
    v_fmac_f32 v24, v100, v100
    v_fmac_f32 v25, v101, v101
    v_fmac_f32 v26, v102, v102
    v_fmac_f32 v27, v103, v103
    v_fmac_f32 v24, v104, v104
    v_fmac_f32 v25, v105, v105
    v_fmac_f32 v26, v106, v106
    v_fmac_f32 v27, v107, v107
    s_add_u32 m0, s25, 53248
    s_add_u32 s33, s33, 1
    buffer_load_dwordx4 v10, s[12:15], s24 offen lds
    s_cmp_eq_u32 s33, 40
    s_cselect_b32 s23, 2457600, 0
    s_cselect_b32 s33, 0, s33
    s_add_u32 s24, s24, 61440
    s_sub_u32 s24, s24, s23
    v_fmac_f32 v24, v108, v108
    v_fmac_f32 v25, v109, v109
    v_fmac_f32 v26, v110, v110
    v_fmac_f32 v27, v111, v111
    v_fmac_f32 v24, v112, v112
    v_fmac_f32 v25, v113, v113
    v_fmac_f32 v26, v114, v114
    v_fmac_f32 v27, v115, v115
    v_fmac_f32 v24, v116, v116
    v_fmac_f32 v25, v117, v117
    s_add_u32 m0, s25, 57344
    s_add_u32 s33, s33, 1
    buffer_load_dwordx4 v10, s[12:15], s24 offen lds
    s_cmp_eq_u32 s33, 40
    s_cselect_b32 s23, 2457600, 0
    s_cselect_b32 s33, 0, s33
    s_add_u32 s24, s24, 61440
    s_sub_u32 s24, s24, s23
    v_fmac_f32 v26, v118, v118
    v_fmac_f32 v27, v119, v119
    v_fmac_f32 v24, v120, v120
    v_fmac_f32 v25, v121, v121
    v_fmac_f32 v26, v122, v122
    v_fmac_f32 v27, v123, v123
    v_fmac_f32 v24, v124, v124
    v_fmac_f32 v25, v125, v125
    v_fmac_f32 v26, v126, v126
    v_fmac_f32 v27, v127, v127
    s_add_u32 m0, s25, 61440
    s_add_u32 s33, s33, 1
    buffer_load_dwordx4 v10, s[12:15], s24 offen lds
    s_cmp_eq_u32 s33, 40
    s_cselect_b32 s23, 2457600, 0
    s_cselect_b32 s33, 0, s33
    s_add_u32 s24, s24, 61440
    s_sub_u32 s24, s24, s23
    v_fmac_f32 v24, v128, v128
    v_fmac_f32 v25, v129, v129
    v_fmac_f32 v26, v130, v130
    v_fmac_f32 v27, v131, v131
    v_fmac_f32 v24, v132, v132
    v_fmac_f32 v25, v133, v133
    v_fmac_f32 v26, v134, v134
    v_fmac_f32 v27, v135, v135
    v_fmac_f32 v24, v136, v136
    v_fmac_f32 v25, v137, v137
    s_add_u32 m0, s25, 65536
    s_add_u32 s33, s33, 1
    buffer_load_dwordx4 v10, s[12:15], s24 offen lds
    s_cmp_eq_u32 s33, 40
    s_cselect_b32 s23, 2457600, 0
    s_cselect_b32 s33, 0, s33
    s_add_u32 s24, s24, 61440
    s_sub_u32 s24, s24, s23
    v_fmac_f32 v26, v138, v138
    v_fmac_f32 v27, v139, v139
    v_fmac_f32 v24, v140, v140
    v_fmac_f32 v25, v141, v141
    v_fmac_f32 v26, v142, v142
    v_fmac_f32 v27, v143, v143
    v_fmac_f32 v24, v144, v144
    v_fmac_f32 v25, v145, v145
    v_fmac_f32 v26, v146, v146
    v_fmac_f32 v27, v147, v147
    s_add_u32 m0, s25, 69632
    s_add_u32 s33, s33, 1
    buffer_load_dwordx4 v10, s[12:15], s24 offen lds
    s_cmp_eq_u32 s33, 40
    s_cselect_b32 s23, 2457600, 0
    s_cselect_b32 s33, 0, s33
    s_add_u32 s24, s24, 61440
    s_sub_u32 s24, s24, s23
    v_add_f32 v24, v24, v25
    v_add_f32 v26, v26, v27
    v_add_f32 v20, v24, v26
    s_nop 1
    v_add_f32 v20, v20, v20 quad_perm:[1,0,3,2] row_mask:0xf bank_mask:0xf
    s_nop 1
    v_add_f32 v20, v20, v20 quad_perm:[2,3,0,1] row_mask:0xf bank_mask:0xf
    s_nop 1
    v_add_f32 v20, v20, v20 row_half_mirror row_mask:0xf bank_mask:0xf
    v_mov_b32 v2, 0x3727c5ac
    v_fmac_f32 v2, 0x3acccccd, v20
    v_rsq_f32 v2, v2
    v_lshrrev_b32 v3, 3, v0
    v_lshlrev_b32_e64 v3, 2, v3
    ds_write_b32 v3, v2 offset:0
    s_mov_b32 exec_hi, 0xff
    buffer_load_dword v16, v15, s[12:15], s46 offen
    s_mov_b32 exec_hi, -1
    v_lshlrev_b32 v5, 4, v1
    v_lshlrev_b32 v6, 2, v1
    v_mov_b32 v4, 0
    s_waitcnt vmcnt(13) lgkmcnt(0)
    s_barrier
    ds_read_b128 v[28:31], v12
    ds_read_b128 v[32:35], v13
    ds_read_b128 v[36:39], v14
    ds_read_b32 v3, v6 offset:0
    s_waitcnt vmcnt(9) lgkmcnt(0)
    s_barrier
    s_add_u32 m0, s25, 0
    s_add_u32 s33, s33, 1
    buffer_load_dwordx4 v10, s[12:15], s24 offen lds
    s_cmp_eq_u32 s33, 40
    s_cselect_b32 s23, 2457600, 0
    s_cselect_b32 s33, 0, s33
    s_add_u32 s24, s24, 61440
    s_sub_u32 s24, s24, s23
    s_add_u32 m0, s25, 4096
    s_add_u32 s33, s33, 1
    buffer_load_dwordx4 v10, s[12:15], s24 offen lds
    s_cmp_eq_u32 s33, 40
    s_cselect_b32 s23, 2457600, 0
    s_cselect_b32 s33, 0, s33
    s_add_u32 s24, s24, 61440
    s_sub_u32 s24, s24, s23
    s_add_u32 m0, s25, 8192
    s_add_u32 s33, s33, 1
    buffer_load_dwordx4 v10, s[12:15], s24 offen lds
    s_cmp_eq_u32 s33, 40
    s_cselect_b32 s23, 2457600, 0
    s_cselect_b32 s33, 0, s33
    s_add_u32 s24, s24, 61440
    s_sub_u32 s24, s24, s23
    s_add_u32 m0, s25, 12288
    s_add_u32 s33, s33, 1
    buffer_load_dwordx4 v10, s[12:15], s24 offen lds
    s_cmp_eq_u32 s33, 40
    s_cselect_b32 s23, 2457600, 0
    s_cselect_b32 s33, 0, s33
    s_add_u32 s24, s24, 61440
    s_sub_u32 s24, s24, s23
    buffer_store_dwordx4 v[28:31], v5, s[16:19], s40 offen sc1
    buffer_store_dwordx4 v[32:35], v5, s[16:19], s41 offen sc1
    buffer_store_dwordx4 v[36:39], v5, s[16:19], s42 offen sc1
    buffer_store_dword v3, v6, s[16:19], s30 offen sc1
    s_waitcnt vmcnt(13) lgkmcnt(0)
    s_barrier
    s_add_u32 m0, s25, 16384
    s_add_u32 s33, s33, 1
    buffer_load_dwordx4 v10, s[12:15], s24 offen lds
    s_cmp_eq_u32 s33, 40
    s_cselect_b32 s23, 2457600, 0
    s_cselect_b32 s33, 0, s33
    s_add_u32 s24, s24, 61440
    s_sub_u32 s24, s24, s23
    s_add_u32 m0, s25, 20480
    s_add_u32 s33, s33, 1
    buffer_load_dwordx4 v10, s[12:15], s24 offen lds
    s_cmp_eq_u32 s33, 40
    s_cselect_b32 s23, 2457600, 0
    s_cselect_b32 s33, 0, s33
    s_add_u32 s24, s24, 61440
    s_sub_u32 s24, s24, s23
    s_add_u32 m0, s25, 24576
    s_add_u32 s33, s33, 1
    buffer_load_dwordx4 v10, s[12:15], s24 offen lds
    s_cmp_eq_u32 s33, 40
    s_cselect_b32 s23, 2457600, 0
    s_cselect_b32 s33, 0, s33
    s_add_u32 s24, s24, 61440
    s_sub_u32 s24, s24, s23
    s_add_u32 m0, s25, 28672
    s_add_u32 s33, s33, 1
    buffer_load_dwordx4 v10, s[12:15], s24 offen lds
    s_cmp_eq_u32 s33, 40
    s_cselect_b32 s23, 2457600, 0
    s_cselect_b32 s33, 0, s33
    s_add_u32 s24, s24, 61440
    s_sub_u32 s24, s24, s23
    s_waitcnt vmcnt(13) lgkmcnt(0)
    s_barrier
    s_add_u32 m0, s25, 32768
    s_add_u32 s33, s33, 1
    buffer_load_dwordx4 v10, s[12:15], s24 offen lds
    s_cmp_eq_u32 s33, 40
    s_cselect_b32 s23, 2457600, 0
    s_cselect_b32 s33, 0, s33
    s_add_u32 s24, s24, 61440
    s_sub_u32 s24, s24, s23
    s_add_u32 m0, s25, 36864
    s_add_u32 s33, s33, 1
    buffer_load_dwordx4 v10, s[12:15], s24 offen lds
    s_cmp_eq_u32 s33, 40
    s_cselect_b32 s23, 2457600, 0
    s_cselect_b32 s33, 0, s33
    s_add_u32 s24, s24, 61440
    s_sub_u32 s24, s24, s23
    s_add_u32 m0, s25, 40960
    s_add_u32 s33, s33, 1
    buffer_load_dwordx4 v10, s[12:15], s24 offen lds
    s_cmp_eq_u32 s33, 40
    s_cselect_b32 s23, 2457600, 0
    s_cselect_b32 s33, 0, s33
    s_add_u32 s24, s24, 61440
    s_sub_u32 s24, s24, s23
    s_add_u32 m0, s25, 45056
    s_add_u32 s33, s33, 1
    buffer_load_dwordx4 v10, s[12:15], s24 offen lds
    s_cmp_eq_u32 s33, 40
    s_cselect_b32 s23, 2457600, 0
    s_cselect_b32 s33, 0, s33
    s_add_u32 s24, s24, 61440
    s_sub_u32 s24, s24, s23
    s_waitcnt vmcnt(12) lgkmcnt(0)
    s_barrier
    s_add_u32 m0, s25, 49152
    s_add_u32 s33, s33, 1
    buffer_load_dwordx4 v10, s[12:15], s24 offen lds
    s_cmp_eq_u32 s33, 40
    s_cselect_b32 s23, 2457600, 0
    s_cselect_b32 s33, 0, s33
    s_add_u32 s24, s24, 61440
    s_sub_u32 s24, s24, s23
    s_add_u32 m0, s25, 53248
    s_add_u32 s33, s33, 1
    buffer_load_dwordx4 v10, s[12:15], s24 offen lds
    s_cmp_eq_u32 s33, 40
    s_cselect_b32 s23, 2457600, 0
    s_cselect_b32 s33, 0, s33
    s_add_u32 s24, s24, 61440
    s_sub_u32 s24, s24, s23
    s_add_u32 m0, s25, 57344
    s_add_u32 s33, s33, 1
    buffer_load_dwordx4 v10, s[12:15], s24 offen lds
    s_cmp_eq_u32 s33, 40
    s_cselect_b32 s23, 2457600, 0
    s_cselect_b32 s33, 0, s33
    s_add_u32 s24, s24, 61440
    s_sub_u32 s24, s24, s23
    s_add_u32 m0, s25, 61440
    s_add_u32 s33, s33, 1
    buffer_load_dwordx4 v10, s[12:15], s24 offen lds
    s_cmp_eq_u32 s33, 40
    s_cselect_b32 s23, 2457600, 0
    s_cselect_b32 s33, 0, s33
    s_add_u32 s24, s24, 61440
    s_sub_u32 s24, s24, s23
    s_waitcnt vmcnt(8) lgkmcnt(0)
    s_barrier
    s_add_u32 m0, s25, 65536
    s_add_u32 s33, s33, 1
    buffer_load_dwordx4 v10, s[12:15], s24 offen lds
    s_cmp_eq_u32 s33, 40
    s_cselect_b32 s23, 2457600, 0
    s_cselect_b32 s33, 0, s33
    s_add_u32 s24, s24, 61440
    s_sub_u32 s24, s24, s23
    s_add_u32 m0, s25, 69632
    s_add_u32 s33, s33, 1
    buffer_load_dwordx4 v10, s[12:15], s24 offen lds
    s_cmp_eq_u32 s33, 40
    s_cselect_b32 s23, 2457600, 0
    s_cselect_b32 s33, 0, s33
    s_add_u32 s24, s24, 61440
    s_sub_u32 s24, s24, s23
    s_add_u32 m0, s25, 0
    s_add_u32 s33, s33, 1
    buffer_load_dwordx4 v10, s[12:15], s24 offen lds
    s_cmp_eq_u32 s33, 40
    s_cselect_b32 s23, 2457600, 0
    s_cselect_b32 s33, 0, s33
    s_add_u32 s24, s24, 61440
    s_sub_u32 s24, s24, s23
    s_add_u32 m0, s25, 4096
    s_add_u32 s33, s33, 1
    buffer_load_dwordx4 v10, s[12:15], s24 offen lds
    s_cmp_eq_u32 s33, 40
    s_cselect_b32 s23, 2457600, 0
    s_cselect_b32 s33, 0, s33
    s_add_u32 s24, s24, 61440
    s_sub_u32 s24, s24, s23
    s_waitcnt vmcnt(8) lgkmcnt(0)
    s_barrier
    s_add_u32 m0, s25, 8192
    s_add_u32 s33, s33, 1
    buffer_load_dwordx4 v10, s[12:15], s24 offen lds
    s_cmp_eq_u32 s33, 40
    s_cselect_b32 s23, 2457600, 0
    s_cselect_b32 s33, 0, s33
    s_add_u32 s24, s24, 61440
    s_sub_u32 s24, s24, s23
    s_add_u32 m0, s25, 12288
    s_add_u32 s33, s33, 1
    buffer_load_dwordx4 v10, s[12:15], s24 offen lds
    s_cmp_eq_u32 s33, 40
    s_cselect_b32 s23, 2457600, 0
    s_cselect_b32 s33, 0, s33
    s_add_u32 s24, s24, 61696
    s_sub_u32 s24, s24, s23
    s_add_u32 m0, s25, 16384
    s_add_u32 s33, s33, 1
    buffer_load_dwordx4 v10, s[12:15], s24 offen lds
    s_cmp_eq_u32 s33, 40
    s_cselect_b32 s23, 2457600, 0
    s_cselect_b32 s33, 0, s33
    s_add_u32 s24, s24, 61440
    s_sub_u32 s24, s24, s23
    s_add_u32 m0, s25, 20480
    s_add_u32 s33, s33, 1
    buffer_load_dwordx4 v10, s[12:15], s24 offen lds
    s_cmp_eq_u32 s33, 40
    s_cselect_b32 s23, 2457600, 0
    s_cselect_b32 s33, 0, s33
    s_add_u32 s24, s24, 61440
    s_sub_u32 s24, s24, s23
    s_waitcnt lgkmcnt(0)
    s_mul_i32 s84, s84, 0x9e3779b1
    s_add_u32 s84, s84, 0x7f4a7c15
    v_mov_b32_e64 v3, s84
    s_mov_b32 exec_hi, 0
    buffer_store_dword v3, v6, s[16:19], s44 offen sc1
    s_mov_b32 exec_hi, -1
    s_waitcnt vmcnt(9) lgkmcnt(0)
    s_barrier
    s_add_u32 m0, s25, 24576
    s_add_u32 s33, s33, 1
    buffer_load_dwordx4 v10, s[12:15], s24 offen lds
    s_cmp_eq_u32 s33, 40
    s_cselect_b32 s23, 2457600, 0
    s_cselect_b32 s33, 0, s33
    s_add_u32 s24, s24, 61440
    s_sub_u32 s24, s24, s23
    s_add_u32 m0, s25, 28672
    s_add_u32 s33, s33, 1
    buffer_load_dwordx4 v10, s[12:15], s24 offen lds
    s_cmp_eq_u32 s33, 40
    s_cselect_b32 s23, 2457600, 0
    s_cselect_b32 s33, 0, s33
    s_add_u32 s24, s24, 61440
    s_sub_u32 s24, s24, s23
    s_add_u32 m0, s25, 32768
    s_add_u32 s33, s33, 1
    buffer_load_dwordx4 v10, s[12:15], s24 offen lds
    s_cmp_eq_u32 s33, 40
    s_cselect_b32 s23, 2457600, 0
    s_cselect_b32 s33, 0, s33
    s_add_u32 s24, s24, 61440
    s_sub_u32 s24, s24, s23
    s_add_u32 m0, s25, 36864
    s_add_u32 s33, s33, 1
    buffer_load_dwordx4 v10, s[12:15], s24 offen lds
    s_cmp_eq_u32 s33, 40
    s_cselect_b32 s23, 2457600, 0
    s_cselect_b32 s33, 0, s33
    s_add_u32 s24, s24, 61440
    s_sub_u32 s24, s24, s23
    s_waitcnt vmcnt(9) lgkmcnt(0)
    s_barrier
    s_add_u32 m0, s25, 40960
    s_add_u32 s33, s33, 1
    buffer_load_dwordx4 v10, s[12:15], s24 offen lds
    s_cmp_eq_u32 s33, 40
    s_cselect_b32 s23, 2457600, 0
    s_cselect_b32 s33, 0, s33
    s_add_u32 s24, s24, 61440
    s_sub_u32 s24, s24, s23
    s_add_u32 m0, s25, 45056
    s_add_u32 s33, s33, 1
    buffer_load_dwordx4 v10, s[12:15], s24 offen lds
    s_cmp_eq_u32 s33, 40
    s_cselect_b32 s23, 2457600, 0
    s_cselect_b32 s33, 0, s33
    s_add_u32 s24, s24, 61440
    s_sub_u32 s24, s24, s23
    s_add_u32 m0, s25, 49152
    s_add_u32 s33, s33, 1
    buffer_load_dwordx4 v10, s[12:15], s24 offen lds
    s_cmp_eq_u32 s33, 40
    s_cselect_b32 s23, 2457600, 0
    s_cselect_b32 s33, 0, s33
    s_add_u32 s24, s24, 61440
    s_sub_u32 s24, s24, s23
    s_add_u32 m0, s25, 53248
    s_add_u32 s33, s33, 1
    buffer_load_dwordx4 v10, s[12:15], s24 offen lds
    s_cmp_eq_u32 s33, 40
    s_cselect_b32 s23, 2457600, 0
    s_cselect_b32 s33, 0, s33
    s_add_u32 s24, s24, 61440
    s_sub_u32 s24, s24, s23
    s_waitcnt vmcnt(9) lgkmcnt(0)
    s_barrier
    s_add_u32 m0, s25, 57344
    s_add_u32 s33, s33, 1
    buffer_load_dwordx4 v10, s[12:15], s24 offen lds
    s_cmp_eq_u32 s33, 40
    s_cselect_b32 s23, 2457600, 0
    s_cselect_b32 s33, 0, s33
    s_add_u32 s24, s24, 61440
    s_sub_u32 s24, s24, s23
    s_add_u32 m0, s25, 61440
    s_add_u32 s33, s33, 1
    buffer_load_dwordx4 v10, s[12:15], s24 offen lds
    s_cmp_eq_u32 s33, 40
    s_cselect_b32 s23, 2457600, 0
    s_cselect_b32 s33, 0, s33
    s_add_u32 s24, s24, 61440
    s_sub_u32 s24, s24, s23
    s_add_u32 m0, s25, 65536
    s_add_u32 s33, s33, 1
    buffer_load_dwordx4 v10, s[12:15], s24 offen lds
    s_cmp_eq_u32 s33, 40
    s_cselect_b32 s23, 2457600, 0
    s_cselect_b32 s33, 0, s33
    s_add_u32 s24, s24, 61440
    s_sub_u32 s24, s24, s23
    s_add_u32 m0, s25, 69632
    s_add_u32 s33, s33, 1
    buffer_load_dwordx4 v10, s[12:15], s24 offen lds
    s_cmp_eq_u32 s33, 40
    s_cselect_b32 s23, 2457600, 0
    s_cselect_b32 s33, 0, s33
    s_add_u32 s24, s24, 61440
    s_sub_u32 s24, s24, s23
    s_cmp_eq_u32 s47, 1
    s_cbranch_scc1 z1_ld1
    s_waitcnt vmcnt(8) lgkmcnt(0)
    s_barrier
    s_add_u32 m0, s25, 0
    s_add_u32 s33, s33, 1
    buffer_load_dwordx4 v10, s[12:15], s24 offen lds
    s_cmp_eq_u32 s33, 40
    s_cselect_b32 s23, 2457600, 0
    s_cselect_b32 s33, 0, s33
    s_add_u32 s24, s24, 61440
    s_sub_u32 s24, s24, s23
    s_add_u32 m0, s25, 4096
    s_add_u32 s33, s33, 1
    buffer_load_dwordx4 v10, s[12:15], s24 offen lds
    s_cmp_eq_u32 s33, 40
    s_cselect_b32 s23, 2457600, 0
    s_cselect_b32 s33, 0, s33
    s_add_u32 s24, s24, 61440
    s_sub_u32 s24, s24, s23
    s_add_u32 m0, s25, 8192
    s_add_u32 s33, s33, 1
    buffer_load_dwordx4 v10, s[12:15], s24 offen lds
    s_cmp_eq_u32 s33, 40
    s_cselect_b32 s23, 2457600, 0
    s_cselect_b32 s33, 0, s33
    s_add_u32 s24, s24, 61440
    s_sub_u32 s24, s24, s23
    s_add_u32 m0, s25, 12288
    s_add_u32 s33, s33, 1
    buffer_load_dwordx4 v10, s[12:15], s24 offen lds
    s_cmp_eq_u32 s33, 40
    s_cselect_b32 s23, 2457600, 0
    s_cselect_b32 s33, 0, s33
    s_add_u32 s24, s24, 61440
    s_sub_u32 s24, s24, s23
    s_waitcnt vmcnt(8) lgkmcnt(0)
    s_barrier
    s_add_u32 m0, s25, 16384
    s_add_u32 s33, s33, 1
    buffer_load_dwordx4 v10, s[12:15], s24 offen lds
    s_cmp_eq_u32 s33, 40
    s_cselect_b32 s23, 2457600, 0
    s_cselect_b32 s33, 0, s33
    s_add_u32 s24, s24, 61440
    s_sub_u32 s24, s24, s23
    s_add_u32 m0, s25, 20480
    s_add_u32 s33, s33, 1
    buffer_load_dwordx4 v10, s[12:15], s24 offen lds
    s_cmp_eq_u32 s33, 40
    s_cselect_b32 s23, 2457600, 0
    s_cselect_b32 s33, 0, s33
    s_add_u32 s24, s24, 61440
    s_sub_u32 s24, s24, s23
    s_add_u32 m0, s25, 24576
    s_add_u32 s33, s33, 1
    buffer_load_dwordx4 v10, s[12:15], s24 offen lds
    s_cmp_eq_u32 s33, 40
    s_cselect_b32 s23, 2457600, 0
    s_cselect_b32 s33, 0, s33
    s_add_u32 s24, s24, 61440
    s_sub_u32 s24, s24, s23
    s_add_u32 m0, s25, 28672
    s_add_u32 s33, s33, 1
    buffer_load_dwordx4 v10, s[12:15], s24 offen lds
    s_cmp_eq_u32 s33, 40
    s_cselect_b32 s23, 2457600, 0
    s_cselect_b32 s33, 0, s33
    s_add_u32 s24, s24, 61440
    s_sub_u32 s24, s24, s23
    s_waitcnt vmcnt(8) lgkmcnt(0)
    s_barrier
    s_add_u32 m0, s25, 32768
    s_add_u32 s33, s33, 1
    buffer_load_dwordx4 v10, s[12:15], s24 offen lds
    s_cmp_eq_u32 s33, 40
    s_cselect_b32 s23, 2457600, 0
    s_cselect_b32 s33, 0, s33
    s_add_u32 s24, s24, 61440
    s_sub_u32 s24, s24, s23
    s_add_u32 m0, s25, 36864
    s_add_u32 s33, s33, 1
    buffer_load_dwordx4 v10, s[12:15], s24 offen lds
    s_cmp_eq_u32 s33, 40
    s_cselect_b32 s23, 2457600, 0
    s_cselect_b32 s33, 0, s33
    s_add_u32 s24, s24, 61440
    s_sub_u32 s24, s24, s23
    s_add_u32 m0, s25, 40960
    s_add_u32 s33, s33, 1
    buffer_load_dwordx4 v10, s[12:15], s24 offen lds
    s_cmp_eq_u32 s33, 40
    s_cselect_b32 s23, 2457600, 0
    s_cselect_b32 s33, 0, s33
    s_add_u32 s24, s24, 61440
    s_sub_u32 s24, s24, s23
    s_add_u32 m0, s25, 45056
    s_add_u32 s33, s33, 1
    buffer_load_dwordx4 v10, s[12:15], s24 offen lds
    s_cmp_eq_u32 s33, 40
    s_cselect_b32 s23, 2457600, 0
    s_cselect_b32 s33, 0, s33
    s_add_u32 s24, s24, 61440
    s_sub_u32 s24, s24, s23
    s_waitcnt vmcnt(8) lgkmcnt(0)
    s_barrier
    s_add_u32 m0, s25, 49152
    s_add_u32 s33, s33, 1
    buffer_load_dwordx4 v10, s[12:15], s24 offen lds
    s_cmp_eq_u32 s33, 40
    s_cselect_b32 s23, 2457600, 0
    s_cselect_b32 s33, 0, s33
    s_add_u32 s24, s24, 61440
    s_sub_u32 s24, s24, s23
    s_add_u32 m0, s25, 53248
    s_add_u32 s33, s33, 1
    buffer_load_dwordx4 v10, s[12:15], s24 offen lds
    s_cmp_eq_u32 s33, 40
    s_cselect_b32 s23, 2457600, 0
    s_cselect_b32 s33, 0, s33
    s_add_u32 s24, s24, 61440
    s_sub_u32 s24, s24, s23
    s_add_u32 m0, s25, 57344
    s_add_u32 s33, s33, 1
    buffer_load_dwordx4 v10, s[12:15], s24 offen lds
    s_cmp_eq_u32 s33, 40
    s_cselect_b32 s23, 2457600, 0
    s_cselect_b32 s33, 0, s33
    s_add_u32 s24, s24, 61440
    s_sub_u32 s24, s24, s23
    s_add_u32 m0, s25, 61440
    s_add_u32 s33, s33, 1
    buffer_load_dwordx4 v10, s[12:15], s24 offen lds
    s_cmp_eq_u32 s33, 40
    s_cselect_b32 s23, 2457600, 0
    s_cselect_b32 s33, 0, s33
    s_add_u32 s24, s24, 61440
    s_sub_u32 s24, s24, s23
    s_waitcnt vmcnt(8) lgkmcnt(0)
    s_barrier
    s_add_u32 m0, s25, 65536
    s_add_u32 s33, s33, 1
    buffer_load_dwordx4 v10, s[12:15], s24 offen lds
    s_cmp_eq_u32 s33, 40
    s_cselect_b32 s23, 2457600, 0
    s_cselect_b32 s33, 0, s33
    s_add_u32 s24, s24, 61440
    s_sub_u32 s24, s24, s23
    s_add_u32 m0, s25, 69632
    s_add_u32 s33, s33, 1
    buffer_load_dwordx4 v10, s[12:15], s24 offen lds
    s_cmp_eq_u32 s33, 40
    s_cselect_b32 s23, 2457600, 0
    s_cselect_b32 s33, 0, s33
    s_add_u32 s24, s24, 61440
    s_sub_u32 s24, s24, s23
    s_add_u32 m0, s25, 0
    s_add_u32 s33, s33, 1
    buffer_load_dwordx4 v10, s[12:15], s24 offen lds
    s_cmp_eq_u32 s33, 40
    s_cselect_b32 s23, 2457600, 0
    s_cselect_b32 s33, 0, s33
    s_add_u32 s24, s24, 61440
    s_sub_u32 s24, s24, s23
    s_add_u32 m0, s25, 4096
    s_add_u32 s33, s33, 1
    buffer_load_dwordx4 v10, s[12:15], s24 offen lds
    s_cmp_eq_u32 s33, 40
    s_cselect_b32 s23, 2457600, 0
    s_cselect_b32 s33, 0, s33
    s_add_u32 s24, s24, 61440
    s_sub_u32 s24, s24, s23
    s_waitcnt vmcnt(8) lgkmcnt(0)
    s_barrier
    s_add_u32 m0, s25, 8192
    s_add_u32 s33, s33, 1
    buffer_load_dwordx4 v10, s[12:15], s24 offen lds
    s_cmp_eq_u32 s33, 40
    s_cselect_b32 s23, 2457600, 0
    s_cselect_b32 s33, 0, s33
    s_add_u32 s24, s24, 61440
    s_sub_u32 s24, s24, s23
    s_add_u32 m0, s25, 12288
    s_add_u32 s33, s33, 1
    buffer_load_dwordx4 v10, s[12:15], s24 offen lds
    s_cmp_eq_u32 s33, 40
    s_cselect_b32 s23, 2457600, 0
    s_cselect_b32 s33, 0, s33
    s_add_u32 s24, s24, 61440
    s_sub_u32 s24, s24, s23
    s_add_u32 m0, s25, 16384
    s_add_u32 s33, s33, 1
    buffer_load_dwordx4 v10, s[12:15], s24 offen lds
    s_cmp_eq_u32 s33, 40
    s_cselect_b32 s23, 2457600, 0
    s_cselect_b32 s33, 0, s33
    s_add_u32 s24, s24, 61440
    s_sub_u32 s24, s24, s23
    s_add_u32 m0, s25, 20480
    s_add_u32 s33, s33, 1
    buffer_load_dwordx4 v10, s[12:15], s24 offen lds
    s_cmp_eq_u32 s33, 40
    s_cselect_b32 s23, 2457600, 0
    s_cselect_b32 s33, 0, s33
    s_add_u32 s24, s24, 61440
    s_sub_u32 s24, s24, s23
    s_waitcnt vmcnt(8) lgkmcnt(0)
    s_barrier
    s_add_u32 m0, s25, 24576
    s_add_u32 s33, s33, 1
    buffer_load_dwordx4 v10, s[12:15], s24 offen lds
    s_cmp_eq_u32 s33, 40
    s_cselect_b32 s23, 2457600, 0
    s_cselect_b32 s33, 0, s33
    s_add_u32 s24, s24, 61440
    s_sub_u32 s24, s24, s23
    s_add_u32 m0, s25, 28672
    s_add_u32 s33, s33, 1
    buffer_load_dwordx4 v10, s[12:15], s24 offen lds
    s_cmp_eq_u32 s33, 40
    s_cselect_b32 s23, 2457600, 0
    s_cselect_b32 s33, 0, s33
    s_add_u32 s24, s24, 61440
    s_sub_u32 s24, s24, s23
    s_waitcnt vmcnt(6) lgkmcnt(0)
    s_barrier
    s_waitcnt vmcnt(2) lgkmcnt(0)
    s_barrier
    s_waitcnt vmcnt(0) lgkmcnt(0)
    s_barrier
z1_ld1:
    s_waitcnt vmcnt(0)
    s_barrier
    v_mov_b32_e64 v4, s84
    s_mov_b32 exec_hi, 0
    buffer_store_dword v4, v6, s[16:19], s45 offen sc1
    s_mov_b32 exec_hi, -1
    s_branch z_attn
z_attn:
    v_and_b32 v1, 63, v0
    v_mov_b32 v3, 1
    v_mov_b32 v2, 163776
    s_mov_b32 s48, 0
    s_and_b32 s3, s2, 7
    s_lshl_b32 s3, s3, 2
    s_lshr_b32 s27, s2, 3
    s_and_b32 s27, s27, 3
    s_add_u32 s21, s3, s27
    s_lshr_b32 s22, s2, 5
    v_lshlrev_b32 v14, 4, v1
    v_and_b32 v15, 31, v1
    v_lshrrev_b32 v17, 5, v1
    v_lshlrev_b32_e64 v6, 3, v15
    v_add_u32 v6, 1024, v6
    s_mov_b32 exec_lo, 0
    v_mov_b32 v6, 1936
    s_mov_b32 exec_lo, -1
    v_lshl_add_u32 v16, v15, 1, v17
    v_min_u32 v17, 21, v15
    v_add_u32 v17, 20, v17
    v_cmp_lt_u32 vcc, 19, v15
    s_and_b32 s53, s20, 3
    s_lshr_b32 s33, s20, 2
    v_cndmask_b32 v16, v16, v17, vcc
    v_lshlrev_b32_e64 v7, 4, v16
    v_add_u32 v7, 1280, v7
    s_mul_i32 s31, s53, 2624
    s_add_u32 s31, s31, 0
    s_mul_i32 s52, s33, 5248
    s_add_u32 s52, s52, 0
    s_mul_i32 s30, s21, 196608
    s_mul_i32 s23, s20, 3072
    s_add_u32 s23, s23, s30
    s_lshl_b32 s27, s22, 2
    s_add_u32 s27, s27, s53
    s_lshl_b32 s27, s27, 1
    s_lshl_b32 s28, s21, 6
    s_add_u32 s28, s28, s27
    s_mul_i32 s28, s28, 1280
    s_add_u32 s27, s27, s33
    s_lshr_b32 s46, s27, 1
    s_lshl_b32 s46, s46, 5
    s_add_u32 s46, s46, s21
    s_lshl_b32 s46, s46, 7
    s_add_u32 s46, s46, 33652736
    s_mul_i32 s32, s27, 40960
    s_lshl_b32 s27, s21, 10
    s_add_u32 s29, s32, s27
    s_lshl_b32 s27, s21, 8
    s_add_u32 s32, s32, s27
    s_add_u32 s32, s32, 31744
    s_mov_b32 s40, -1
    s_mov_b32 s41, 0x00ffffff
    s_mov_b32 s42, -1
    s_mov_b32 s43, 0xff
    s_mov_b32 s44, 0xfffff
    s_mov_b32 s45, 0xfffff
    s_waitcnt lgkmcnt(0)
    s_add_u32 s8, s34, 0x400000
    s_addc_u32 s9, s35, 0
    s_mov_b32 s10, 0x600000
    s_mov_b32 s11, 0x00020000
    s_mov_b32 s12, s34
    s_mov_b32 s13, s35
    s_mov_b32 s14, 0x280000
    s_mov_b32 s15, 0x00020000
    s_add_u32 s16, s34, 0xc00000
    s_addc_u32 s17, s35, 0
    s_mov_b32 s18, 0x2100000
    s_mov_b32 s19, 0x00020000
    v_lshrrev_b32_e64 v15, 2, v1
    v_mul_u32_u24 v15, 10496, v15
    v_bfe_u32 v16, v1, 1, 1
    v_mul_u32_u24 v16, 672, v16
    v_add3_u32 v15, v15, v16, s31
    v_and_b32_e64 v16, 1, v1
    v_lshl_add_u32 v15, v16, 4, v15
    v_sub_u32_e64 v16, 1, v16
    v_mul_u32_u24 v16, 0x3f80, v16
    v_lshl_or_b32 v44, v16, 16, v16
    v_mov_b32 v45, v44
    v_mov_b32 v46, v44
    v_mov_b32_e64 v47, v44
    s_mov_b64 exec, 0xffff
    ds_write_b128 v15, v[44:47] offset:1920
    s_mov_b64 exec, -1
    v_mov_b32 v28, 0
    v_mov_b32 v29, 0
    v_mov_b32 v30, 0
    v_mov_b32 v31, 0
    v_mov_b32 v108, 0
    v_mov_b32 v109, 0
    v_mov_b32 v110, 0
    v_mov_b32 v111, 0
    v_mov_b32 v112, 0
    v_mov_b32 v113, 0
    v_mov_b32 v114, 0
    v_mov_b32 v115, 0
    v_mov_b32 v116, 0
    v_mov_b32 v117, 0
    v_mov_b32 v118, 0
    v_mov_b32 v119, 0
    v_mov_b32 v120, 0
    v_mov_b32 v121, 0
    v_mov_b32 v122, 0
    v_mov_b32 v123, 0
    v_mov_b32 v32, 0
    v_mov_b32 v33, 0
    v_mov_b32 v34, 0
    v_mov_b32 v35, 0
    v_mov_b32 v124, 0
    v_mov_b32 v125, 0
    v_mov_b32 v126, 0
    v_mov_b32 v127, 0
    v_mov_b32 v128, 0
    v_mov_b32 v129, 0
    v_mov_b32 v130, 0
    v_mov_b32 v131, 0
    v_mov_b32 v132, 0
    v_mov_b32 v133, 0
    v_mov_b32 v134, 0
    v_mov_b32 v135, 0
    v_mov_b32 v136, 0
    v_mov_b32 v137, 0
    v_mov_b32 v138, 0
    v_mov_b32 v139, 0
    v_mov_b32 v42, 0
    v_mov_b32 v43, 0
    v_mov_b32 v52, 0
    v_mov_b32 v53, 0
    v_mov_b32 v54, 0
    v_mov_b32 v55, 0
    v_mov_b32 v56, 0
    v_mov_b32 v57, 0
    v_mov_b32 v58, 0
    v_mov_b32 v59, 0
    v_mov_b32 v48, 0
    v_mov_b32 v49, 0
    v_mov_b32 v50, 0
    v_mov_b32 v51, 0
    v_add_u32 v8, s52, v14
    v_add_u32 v9, s52, v6
    v_add_u32 v10, s52, v7
    v_add_u32_e64 v5, 0, v14
    s_mov_b32 s26, 0
    s_cmp_lg_u32 s33, 0
    s_cselect_b32 s54, 0, 16
    s_cselect_b32 s55, 0, 12
    s_add_u32 s24, s52, 20992
    s_mov_b32 s25, 31488
    s_cmp_lg_u32 s20, 0
    s_cbranch_scc1 gate_3
    v_lshrrev_b32 v16, 5, v1
    v_mul_u32_u24 v16, 19, v16
    s_mul_i32 s50, s21, 20
    v_add_u32 v16, s50, v16
    v_and_b32_e64 v17, 31, v1
    s_mov_b32 s51, 33554432
    v_add_u32 v15, 0, v16
    v_lshrrev_b32 v15, 8, v15
    v_and_b32 v4, 3, v1
    s_lshl_b32 s50, s22, 2
    v_add_u32_e64 v4, s50, v4
    v_lshl_add_u32 v15, v15, 5, v4
    v_lshlrev_b32_e64 v76, 7, v15
    v_add_u32 v15, 640, v16
    v_lshrrev_b32_e64 v15, 8, v15
    v_lshl_add_u32 v15, v15, 5, v17
    v_lshlrev_b32_e64 v77, 7, v15
    v_add_u32 v15, 1280, v16
    v_lshrrev_b32_e64 v15, 8, v15
    v_lshl_add_u32 v15, v15, 5, v17
    v_lshlrev_b32 v78, 7, v15
    s_mov_b32 s50, 0
    s_branch gp_4y
gp_4:
    s_sleep 8
gp_4y:
    buffer_load_dword v79, v76, s[16:19], s51 offen sc1
    buffer_load_dword v80, v77, s[16:19], s51 offen sc1
    buffer_load_dword v81, v78, s[16:19], s51 offen sc1
    s_waitcnt vmcnt(0)
    v_xor_b32 v79, s84, v79
    v_xor_b32 v80, s84, v80
    v_xor_b32 v81, s84, v81
    v_or3_b32 v4, v79, v80, v81
    v_cmp_ne_u32 vcc, 0, v4
    s_add_u32 s50, s50, 1
    s_nop 3
    s_cbranch_vccz gate_3
    s_cmp_lt_u32 s50, 0x40000
    s_cbranch_scc1 gp_4
gate_3:
    s_mov_b64 exec, 1
    ds_add_u32 v2, v3
    s_mov_b64 exec, -1
    s_add_u32 s48, s48, 8
poll_5:
    ds_read_b32 v4, v2
    s_waitcnt lgkmcnt(0)
    v_readfirstlane_b32 s49, v4
    s_cmp_ge_u32 s49, s48
    s_cbranch_scc1 polldone_6
    s_sleep 1
    s_branch poll_5
polldone_6:
    s_mul_i32 s27, s33, 10496
    s_add_u32 m0, s31, s27
    s_cmp_lg_u32 s33, 0
    s_cbranch_scc1 za_q0
    buffer_load_dwordx4 v14, s[8:11], s23 offen sc1 lds
    s_mov_b64 exec, s[40:41]
    buffer_load_dwordx4 v14, s[8:11], s23 offen offset:1024 sc1 lds
    s_add_u32 s47, s23, 96
    s_mov_b64 exec, s[42:43]
    buffer_load_dwordx4 v14, s[8:11], s47 offen offset:1952 sc1 lds
    s_mov_b64 exec, -1
    s_add_u32 s23, s23, 12288
    buffer_load_dwordx4 v[20:23], v14, s[12:15], s28 offen offset:0 sc1
    buffer_load_dwordx4 v[24:27], v14, s[12:15], s28 offen offset:1280 sc1
    s_mov_b32 exec_hi, 0
    buffer_load_dwordx2 v[28:29], v6, s[12:15], s28 offen offset:0 sc1
    buffer_load_dwordx2 v[32:33], v6, s[12:15], s28 offen offset:1280 sc1
    s_mov_b32 exec_hi, -1
    s_add_u32 m0, s31, 20992
    s_add_u32 s23, s23, 12288
    buffer_load_dwordx4 v14, s[8:11], s23 offen sc1 lds
    s_mov_b64 exec, s[40:41]
    buffer_load_dwordx4 v14, s[8:11], s23 offen offset:1024 sc1 lds
    s_add_u32 s47, s23, 96
    s_mov_b64 exec, s[42:43]
    buffer_load_dwordx4 v14, s[8:11], s47 offen offset:1952 sc1 lds
    s_mov_b64 exec, -1
    s_add_u32 s23, s23, 12288
    s_branch za_q1
za_q0:
    buffer_load_dwordx4 v[20:23], v14, s[12:15], s28 offen offset:0 sc1
    buffer_load_dwordx4 v[24:27], v14, s[12:15], s28 offen offset:1280 sc1
    s_mov_b32 exec_hi, 0
    buffer_load_dwordx2 v[28:29], v6, s[12:15], s28 offen offset:0 sc1
    buffer_load_dwordx2 v[32:33], v6, s[12:15], s28 offen offset:1280 sc1
    s_mov_b32 exec_hi, -1
    buffer_load_dwordx4 v14, s[8:11], s23 offen sc1 lds
    s_mov_b64 exec, s[40:41]
    buffer_load_dwordx4 v14, s[8:11], s23 offen offset:1024 sc1 lds
    s_add_u32 s47, s23, 96
    s_mov_b64 exec, s[42:43]
    buffer_load_dwordx4 v14, s[8:11], s47 offen offset:1952 sc1 lds
    s_mov_b64 exec, -1
    s_add_u32 s23, s23, 12288
za_q1:
    s_waitcnt vmcnt(3) lgkmcnt(0)
    s_mov_b64 exec, 1
    ds_add_u32 v2, v3
    s_mov_b64 exec, -1
    s_add_u32 s48, s48, 8
poll_7:
    ds_read_b32 v4, v2
    s_waitcnt lgkmcnt(0)
    v_readfirstlane_b32 s49, v4
    s_cmp_ge_u32 s49, s48
    s_cbranch_scc1 polldone_8
    s_sleep 1
    s_branch poll_7
polldone_8:
    v_add_u32 v17, 0, v6
    ds_read_b128 v[36:39], v5
    ds_read_b64 v[40:41], v17
    s_waitcnt lgkmcnt(0)
    v_mfma_f32_32x32x16_bf16 v[76:91], v[36:39], v[20:23], 0
    v_mfma_f32_32x32x16_bf16 v[76:91], v[40:43], v[28:31], v[76:91]
    v_mfma_f32_32x32x16_bf16 v[92:107], v[36:39], v[24:27], 0
    v_mfma_f32_32x32x16_bf16 v[92:107], v[40:43], v[32:35], v[92:107]
    ds_read_b128 v[36:39], v8
    ds_read_b64 v[40:41], v9
    ds_read_b128 v[44:47], v10
    s_nop 11
    v_max3_f32 v15, v76, v77, v78
    v_max3_f32 v15, v15, v79, v80
    v_max3_f32 v15, v15, v81, v82
    v_max3_f32 v15, v15, v83, v84
    v_max3_f32 v15, v15, v85, v86
    v_max3_f32 v15, v15, v87, v88
    v_max3_f32 v15, v15, v89, v90
    v_max_f32_e64 v15, v15, v91
    v_max3_f32 v15, v15, v92, v93
    v_max3_f32 v15, v15, v94, v95
    v_max3_f32 v15, v15, v96, v97
    v_max3_f32 v15, v15, v98, v99
    v_max3_f32 v15, v15, v100, v101
    v_max3_f32 v15, v15, v102, v103
    v_max3_f32 v15, v15, v104, v105
    v_max3_f32 v15, v15, v106, v107
    v_mov_b32 v16, v15
    s_nop 1
    v_permlane32_swap_b32 v15, v16
    s_nop 1
    v_max_f32 v15, v15, v16
    v_sub_f32 v60, 0, v15
    v_sub_f32 v61, 0, v15
    v_sub_f32 v62, 0, v15
    v_sub_f32 v63, 0, v15
    v_sub_f32 v64, 0, v15
    v_sub_f32 v65, 0, v15
    v_sub_f32 v66, 0, v15
    v_sub_f32 v67, 0, v15
    v_sub_f32 v68, 0, v15
    v_sub_f32 v69, 0, v15
    v_sub_f32 v70, 0, v15
    v_sub_f32 v71, 0, v15
    v_sub_f32 v72, 0, v15
    v_sub_f32 v73, 0, v15
    v_sub_f32 v74, 0, v15
    v_sub_f32_e64 v75, 0, v15
    s_nop 1
    s_waitcnt lgkmcnt(0)
    v_mfma_f32_32x32x16_bf16 v[76:91], v[36:39], v[20:23], v[60:75]
    v_mfma_f32_32x32x16_bf16 v[76:91], v[40:43], v[28:31], v[76:91]
    s_nop 9
    s_setprio 2
.p2align 6
za_loop:
    s_cmp_ge_i32 s26, s54
    s_cbranch_scc1 av_9
    s_waitcnt vmcnt(3)
    s_branch av_10
av_9:
    s_waitcnt vmcnt(0)
av_10:
    s_mov_b64 exec, 1
    ds_add_u32 v2, v3
    s_mov_b64 exec, -1
    s_add_u32 s48, s48, 8
    v_mfma_f32_32x32x16_bf16 v[92:107], v[36:39], v[24:27], v[60:75]
    ds_read_b128 v[36:39], v8 offset:2624
    v_exp_f32 v76, v76
    v_exp_f32 v77, v77
    v_exp_f32 v78, v78
    v_exp_f32 v79, v79
    v_cvt_pk_bf16_f32 v52, v76, v77
    v_cvt_pk_bf16_f32 v53, v78, v79
    v_mfma_f32_32x32x16_bf16 v[124:139], v[48:51], v[56:59], v[124:139]
    ds_read_b128 v[48:51], v10 offset:672
    v_exp_f32 v80, v80
    v_exp_f32 v81, v81
    v_exp_f32 v82, v82
    v_exp_f32 v83, v83
    v_cvt_pk_bf16_f32 v54, v80, v81
    v_cvt_pk_bf16_f32 v55, v82, v83
    v_mfma_f32_32x32x16_bf16 v[92:107], v[40:43], v[32:35], v[92:107]
    ds_read_b64 v[40:41], v9 offset:2624
    v_exp_f32 v84, v84
    v_exp_f32 v85, v85
    v_exp_f32 v86, v86
    v_exp_f32_e64 v87, v87
    s_waitcnt lgkmcnt(4)
    v_cvt_pk_bf16_f32 v56, v84, v85
    v_cvt_pk_bf16_f32 v57, v86, v87
    v_mfma_f32_32x32x16_bf16 v[108:123], v[44:47], v[52:55], v[108:123]
    v_exp_f32 v88, v88
    v_exp_f32 v89, v89
    v_exp_f32 v90, v90
    v_exp_f32 v91, v91
    s_setprio 1
    s_waitcnt lgkmcnt(2)
    v_cvt_pk_bf16_f32 v58, v88, v89
    v_cvt_pk_bf16_f32 v59, v90, v91
    v_mfma_f32_32x32x16_bf16 v[76:91], v[36:39], v[20:23], v[60:75]
    v_exp_f32 v92, v92
    v_exp_f32 v93, v93
    v_exp_f32 v94, v94
    v_exp_f32_e64 v95, v95
    s_waitcnt lgkmcnt(1)
    v_cvt_pk_bf16_f32 v52, v92, v93
    v_cvt_pk_bf16_f32 v53, v94, v95
    v_mfma_f32_32x32x16_bf16 v[108:123], v[48:51], v[56:59], v[108:123]
    v_exp_f32 v96, v96
    v_exp_f32 v97, v97
    v_exp_f32 v98, v98
    v_exp_f32_e64 v99, v99
    s_waitcnt lgkmcnt(0)
    v_cvt_pk_bf16_f32 v54, v96, v97
    v_cvt_pk_bf16_f32 v55, v98, v99
    v_mfma_f32_32x32x16_bf16 v[76:91], v[40:43], v[28:31], v[76:91]
    ds_read_b32 v4, v2
    v_exp_f32 v100, v100
    v_exp_f32 v101, v101
    v_exp_f32 v102, v102
    v_exp_f32 v103, v103
    v_cvt_pk_bf16_f32 v56, v100, v101
    v_cvt_pk_bf16_f32 v57, v102, v103
    v_mfma_f32_32x32x16_bf16 v[124:139], v[44:47], v[52:55], v[124:139]
    ds_read_b128 v[44:47], v10 offset:2624
    v_exp_f32 v104, v104
    v_exp_f32 v105, v105
    v_exp_f32 v106, v106
    v_exp_f32 v107, v107
    s_setprio 3
    s_waitcnt lgkmcnt(1)
    v_cvt_pk_bf16_f32 v58, v104, v105
    v_cvt_pk_bf16_f32 v59, v106, v107
    v_readfirstlane_b32 s49, v4
    s_cmp_ge_u32 s49, s48
    s_cbranch_scc1 chk_11
poll_12:
    ds_read_b32 v4, v2
    s_waitcnt lgkmcnt(0)
    v_readfirstlane_b32 s49, v4
    s_cmp_ge_u32 s49, s48
    s_cbranch_scc1 polldone_13
    s_sleep 1
    s_branch poll_12
polldone_13:
chk_11:
    s_cmp_lg_u32 s33, 0
    s_cbranch_scc1 anodma_14
    s_add_u32 m0, s31, 31488
    s_nop 0
    buffer_load_dwordx4 v14, s[8:11], s23 offen sc1 lds
    s_mov_b64 exec, s[40:41]
    buffer_load_dwordx4 v14, s[8:11], s23 offen offset:1024 sc1 lds
    s_add_u32 s47, s23, 96
    s_mov_b64 exec, s[42:43]
    buffer_load_dwordx4 v14, s[8:11], s47 offen offset:1952 sc1 lds
    s_mov_b64 exec, -1
    s_add_u32 s23, s23, 12288
anodma_14:
    v_mfma_f32_32x32x16_bf16 v[92:107], v[36:39], v[24:27], v[60:75]
    ds_read_b128 v[36:39], v8 offset:10496
    v_exp_f32 v76, v76
    v_exp_f32 v77, v77
    v_exp_f32 v78, v78
    v_exp_f32_e64 v79, v79
    v_cvt_pk_bf16_f32 v52, v76, v77
    v_cvt_pk_bf16_f32 v53, v78, v79
    v_mfma_f32_32x32x16_bf16 v[124:139], v[48:51], v[56:59], v[124:139]
    ds_read_b128 v[48:51], v10 offset:3296
    v_exp_f32 v80, v80
    v_exp_f32 v81, v81
    v_exp_f32 v82, v82
    v_exp_f32 v83, v83
    v_cvt_pk_bf16_f32 v54, v80, v81
    v_cvt_pk_bf16_f32 v55, v82, v83
    v_mfma_f32_32x32x16_bf16 v[92:107], v[40:43], v[32:35], v[92:107]
    ds_read_b64 v[40:41], v9 offset:10496
    v_exp_f32 v84, v84
    v_exp_f32 v85, v85
    v_exp_f32 v86, v86
    v_exp_f32_e64 v87, v87
    s_waitcnt lgkmcnt(3)
    v_cvt_pk_bf16_f32 v56, v84, v85
    v_cvt_pk_bf16_f32 v57, v86, v87
    v_mfma_f32_32x32x16_bf16 v[108:123], v[44:47], v[52:55], v[108:123]
    v_exp_f32 v88, v88
    v_exp_f32 v89, v89
    v_exp_f32 v90, v90
    v_exp_f32 v91, v91
    s_setprio 3
    s_waitcnt lgkmcnt(2)
    v_cvt_pk_bf16_f32 v58, v88, v89
    v_cvt_pk_bf16_f32 v59, v90, v91
    v_mfma_f32_32x32x16_bf16 v[76:91], v[36:39], v[20:23], v[60:75]
    v_exp_f32 v92, v92
    v_exp_f32 v93, v93
    v_exp_f32 v94, v94
    v_exp_f32_e64 v95, v95
    s_waitcnt lgkmcnt(1)
    v_cvt_pk_bf16_f32 v52, v92, v93
    v_cvt_pk_bf16_f32 v53, v94, v95
    v_mfma_f32_32x32x16_bf16 v[108:123], v[48:51], v[56:59], v[108:123]
    v_exp_f32 v96, v96
    v_exp_f32 v97, v97
    v_exp_f32 v98, v98
    v_exp_f32_e64 v99, v99
    s_waitcnt lgkmcnt(0)
    v_cvt_pk_bf16_f32 v54, v96, v97
    v_cvt_pk_bf16_f32 v55, v98, v99
    v_mfma_f32_32x32x16_bf16 v[76:91], v[40:43], v[28:31], v[76:91]
    v_exp_f32 v100, v100
    v_exp_f32 v101, v101
    v_exp_f32 v102, v102
    v_exp_f32 v103, v103
    v_cvt_pk_bf16_f32 v56, v100, v101
    v_cvt_pk_bf16_f32 v57, v102, v103
    v_mfma_f32_32x32x16_bf16 v[124:139], v[44:47], v[52:55], v[124:139]
    ds_read_b128 v[44:47], v10 offset:10496
    v_exp_f32 v104, v104
    v_exp_f32 v105, v105
    v_exp_f32 v106, v106
    v_exp_f32_e64 v107, v107
    s_setprio 2
    v_cvt_pk_bf16_f32 v58, v104, v105
    v_cvt_pk_bf16_f32 v59, v106, v107
    s_cmp_ge_i32 s26, s54
    s_cbranch_scc1 av_15
    s_waitcnt vmcnt(3)
    s_branch av_16
av_15:
    s_waitcnt vmcnt(0)
av_16:
    s_mov_b64 exec, 1
    ds_add_u32 v2, v3
    s_mov_b64 exec, -1
    s_add_u32 s48, s48, 8
    v_mfma_f32_32x32x16_bf16 v[92:107], v[36:39], v[24:27], v[60:75]
    ds_read_b128 v[36:39], v8 offset:13120
    v_exp_f32 v76, v76
    v_exp_f32 v77, v77
    v_exp_f32 v78, v78
    v_exp_f32 v79, v79
    v_cvt_pk_bf16_f32 v52, v76, v77
    v_cvt_pk_bf16_f32 v53, v78, v79
    v_mfma_f32_32x32x16_bf16 v[124:139], v[48:51], v[56:59], v[124:139]
    ds_read_b128 v[48:51], v10 offset:11168
    v_exp_f32 v80, v80
    v_exp_f32 v81, v81
    v_exp_f32 v82, v82
    v_exp_f32 v83, v83
    v_cvt_pk_bf16_f32 v54, v80, v81
    v_cvt_pk_bf16_f32 v55, v82, v83
    v_mfma_f32_32x32x16_bf16 v[92:107], v[40:43], v[32:35], v[92:107]
    ds_read_b64 v[40:41], v9 offset:13120
    v_exp_f32 v84, v84
    v_exp_f32 v85, v85
    v_exp_f32 v86, v86
    v_exp_f32_e64 v87, v87
    s_waitcnt lgkmcnt(4)
    v_cvt_pk_bf16_f32 v56, v84, v85
    v_cvt_pk_bf16_f32 v57, v86, v87
    v_mfma_f32_32x32x16_bf16 v[108:123], v[44:47], v[52:55], v[108:123]
    v_exp_f32 v88, v88
    v_exp_f32 v89, v89
    v_exp_f32 v90, v90
    v_exp_f32 v91, v91
    s_setprio 1
    s_waitcnt lgkmcnt(2)
    v_cvt_pk_bf16_f32 v58, v88, v89
    v_cvt_pk_bf16_f32 v59, v90, v91
    v_mfma_f32_32x32x16_bf16 v[76:91], v[36:39], v[20:23], v[60:75]
    v_exp_f32 v92, v92
    v_exp_f32 v93, v93
    v_exp_f32 v94, v94
    v_exp_f32_e64 v95, v95
    s_waitcnt lgkmcnt(1)
    v_cvt_pk_bf16_f32 v52, v92, v93
    v_cvt_pk_bf16_f32 v53, v94, v95
    v_mfma_f32_32x32x16_bf16 v[108:123], v[48:51], v[56:59], v[108:123]
    v_exp_f32 v96, v96
    v_exp_f32 v97, v97
    v_exp_f32 v98, v98
    v_exp_f32_e64 v99, v99
    s_waitcnt lgkmcnt(0)
    v_cvt_pk_bf16_f32 v54, v96, v97
    v_cvt_pk_bf16_f32 v55, v98, v99
    v_mfma_f32_32x32x16_bf16 v[76:91], v[40:43], v[28:31], v[76:91]
    ds_read_b32 v4, v2
    v_exp_f32 v100, v100
    v_exp_f32 v101, v101
    v_exp_f32 v102, v102
    v_exp_f32 v103, v103
    v_cvt_pk_bf16_f32 v56, v100, v101
    v_cvt_pk_bf16_f32 v57, v102, v103
    v_mfma_f32_32x32x16_bf16 v[124:139], v[44:47], v[52:55], v[124:139]
    ds_read_b128 v[44:47], v10 offset:13120
    v_exp_f32 v104, v104
    v_exp_f32 v105, v105
    v_exp_f32 v106, v106
    v_exp_f32 v107, v107
    s_setprio 3
    s_waitcnt lgkmcnt(1)
    v_cvt_pk_bf16_f32 v58, v104, v105
    v_cvt_pk_bf16_f32 v59, v106, v107
    v_readfirstlane_b32 s49, v4
    s_cmp_ge_u32 s49, s48
    s_cbranch_scc1 chk_17
poll_18:
    ds_read_b32 v4, v2
    s_waitcnt lgkmcnt(0)
    v_readfirstlane_b32 s49, v4
    s_cmp_ge_u32 s49, s48
    s_cbranch_scc1 polldone_19
    s_sleep 1
    s_branch poll_18
polldone_19:
chk_17:
    s_cmp_ge_u32 s26, 12
    s_cbranch_scc1 anodma_20
    s_cmp_lg_u32 s33, 0
    s_cbranch_scc1 anodma_20
    s_add_u32 m0, s31, 0
    s_nop 0
    buffer_load_dwordx4 v14, s[8:11], s23 offen sc1 lds
    s_mov_b64 exec, s[40:41]
    buffer_load_dwordx4 v14, s[8:11], s23 offen offset:1024 sc1 lds
    s_add_u32 s47, s23, 96
    s_mov_b64 exec, s[42:43]
    buffer_load_dwordx4 v14, s[8:11], s47 offen offset:1952 sc1 lds
    s_mov_b64 exec, -1
    s_add_u32 s23, s23, 12288
anodma_20:
    v_mfma_f32_32x32x16_bf16 v[92:107], v[36:39], v[24:27], v[60:75]
    ds_read_b128 v[36:39], v8 offset:20992
    v_exp_f32 v76, v76
    v_exp_f32 v77, v77
    v_exp_f32 v78, v78
    v_exp_f32 v79, v79
    v_cvt_pk_bf16_f32 v52, v76, v77
    v_cvt_pk_bf16_f32 v53, v78, v79
    v_mfma_f32_32x32x16_bf16 v[124:139], v[48:51], v[56:59], v[124:139]
    ds_read_b128 v[48:51], v10 offset:13792
    v_exp_f32 v80, v80
    v_exp_f32 v81, v81
    v_exp_f32 v82, v82
    v_exp_f32 v83, v83
    v_cvt_pk_bf16_f32 v54, v80, v81
    v_cvt_pk_bf16_f32 v55, v82, v83
    v_mfma_f32_32x32x16_bf16 v[92:107], v[40:43], v[32:35], v[92:107]
    ds_read_b64 v[40:41], v9 offset:20992
    v_exp_f32 v84, v84
    v_exp_f32 v85, v85
    v_exp_f32 v86, v86
    v_exp_f32_e64 v87, v87
    s_waitcnt lgkmcnt(3)
    v_cvt_pk_bf16_f32 v56, v84, v85
    v_cvt_pk_bf16_f32 v57, v86, v87
    v_mfma_f32_32x32x16_bf16 v[108:123], v[44:47], v[52:55], v[108:123]
    v_exp_f32 v88, v88
    v_exp_f32 v89, v89
    v_exp_f32 v90, v90
    v_exp_f32 v91, v91
    s_setprio 3
    s_waitcnt lgkmcnt(2)
    v_cvt_pk_bf16_f32 v58, v88, v89
    v_cvt_pk_bf16_f32 v59, v90, v91
    v_mfma_f32_32x32x16_bf16 v[76:91], v[36:39], v[20:23], v[60:75]
    v_exp_f32 v92, v92
    v_exp_f32 v93, v93
    v_exp_f32 v94, v94
    v_exp_f32_e64 v95, v95
    s_waitcnt lgkmcnt(1)
    v_cvt_pk_bf16_f32 v52, v92, v93
    v_cvt_pk_bf16_f32 v53, v94, v95
    v_mfma_f32_32x32x16_bf16 v[108:123], v[48:51], v[56:59], v[108:123]
    v_exp_f32 v96, v96
    v_exp_f32 v97, v97
    v_exp_f32 v98, v98
    v_exp_f32_e64 v99, v99
    s_waitcnt lgkmcnt(0)
    v_cvt_pk_bf16_f32 v54, v96, v97
    v_cvt_pk_bf16_f32 v55, v98, v99
    v_mfma_f32_32x32x16_bf16 v[76:91], v[40:43], v[28:31], v[76:91]
    v_exp_f32 v100, v100
    v_exp_f32 v101, v101
    v_exp_f32 v102, v102
    v_exp_f32 v103, v103
    v_cvt_pk_bf16_f32 v56, v100, v101
    v_cvt_pk_bf16_f32 v57, v102, v103
    v_mfma_f32_32x32x16_bf16 v[124:139], v[44:47], v[52:55], v[124:139]
    ds_read_b128 v[44:47], v10 offset:20992
    v_exp_f32 v104, v104
    v_exp_f32 v105, v105
    v_exp_f32 v106, v106
    v_exp_f32_e64 v107, v107
    s_setprio 2
    v_cvt_pk_bf16_f32 v58, v104, v105
    v_cvt_pk_bf16_f32 v59, v106, v107
    s_cmp_ge_i32 s26, s55
    s_cbranch_scc1 av_21
    s_waitcnt vmcnt(3)
    s_branch av_22
av_21:
    s_waitcnt vmcnt(0)
av_22:
    s_mov_b64 exec, 1
    ds_add_u32 v2, v3
    s_mov_b64 exec, -1
    s_add_u32 s48, s48, 8
    v_mfma_f32_32x32x16_bf16 v[92:107], v[36:39], v[24:27], v[60:75]
    ds_read_b128 v[36:39], v8 offset:23616
    v_exp_f32 v76, v76
    v_exp_f32 v77, v77
    v_exp_f32 v78, v78
    v_exp_f32 v79, v79
    v_cvt_pk_bf16_f32 v52, v76, v77
    v_cvt_pk_bf16_f32 v53, v78, v79
    v_mfma_f32_32x32x16_bf16 v[124:139], v[48:51], v[56:59], v[124:139]
    ds_read_b128 v[48:51], v10 offset:21664
    v_exp_f32 v80, v80
    v_exp_f32 v81, v81
    v_exp_f32 v82, v82
    v_exp_f32 v83, v83
    v_cvt_pk_bf16_f32 v54, v80, v81
    v_cvt_pk_bf16_f32 v55, v82, v83
    v_mfma_f32_32x32x16_bf16 v[92:107], v[40:43], v[32:35], v[92:107]
    ds_read_b64 v[40:41], v9 offset:23616
    v_exp_f32 v84, v84
    v_exp_f32 v85, v85
    v_exp_f32 v86, v86
    v_exp_f32_e64 v87, v87
    s_waitcnt lgkmcnt(4)
    v_cvt_pk_bf16_f32 v56, v84, v85
    v_cvt_pk_bf16_f32 v57, v86, v87
    v_mfma_f32_32x32x16_bf16 v[108:123], v[44:47], v[52:55], v[108:123]
    v_exp_f32 v88, v88
    v_exp_f32 v89, v89
    v_exp_f32 v90, v90
    v_exp_f32 v91, v91
    s_setprio 1
    s_waitcnt lgkmcnt(2)
    v_cvt_pk_bf16_f32 v58, v88, v89
    v_cvt_pk_bf16_f32 v59, v90, v91
    v_mfma_f32_32x32x16_bf16 v[76:91], v[36:39], v[20:23], v[60:75]
    v_exp_f32 v92, v92
    v_exp_f32 v93, v93
    v_exp_f32 v94, v94
    v_exp_f32_e64 v95, v95
    s_waitcnt lgkmcnt(1)
    v_cvt_pk_bf16_f32 v52, v92, v93
    v_cvt_pk_bf16_f32 v53, v94, v95
    v_mfma_f32_32x32x16_bf16 v[108:123], v[48:51], v[56:59], v[108:123]
    v_exp_f32 v96, v96
    v_exp_f32 v97, v97
    v_exp_f32 v98, v98
    v_exp_f32_e64 v99, v99
    s_waitcnt lgkmcnt(0)
    v_cvt_pk_bf16_f32 v54, v96, v97
    v_cvt_pk_bf16_f32 v55, v98, v99
    v_mfma_f32_32x32x16_bf16 v[76:91], v[40:43], v[28:31], v[76:91]
    ds_read_b32 v4, v2
    v_exp_f32 v100, v100
    v_exp_f32 v101, v101
    v_exp_f32 v102, v102
    v_exp_f32 v103, v103
    v_cvt_pk_bf16_f32 v56, v100, v101
    v_cvt_pk_bf16_f32 v57, v102, v103
    v_mfma_f32_32x32x16_bf16 v[124:139], v[44:47], v[52:55], v[124:139]
    ds_read_b128 v[44:47], v10 offset:23616
    v_exp_f32 v104, v104
    v_exp_f32 v105, v105
    v_exp_f32 v106, v106
    v_exp_f32 v107, v107
    s_setprio 3
    s_waitcnt lgkmcnt(1)
    v_cvt_pk_bf16_f32 v58, v104, v105
    v_cvt_pk_bf16_f32 v59, v106, v107
    v_readfirstlane_b32 s49, v4
    s_cmp_ge_u32 s49, s48
    s_cbranch_scc1 chk_23
poll_24:
    ds_read_b32 v4, v2
    s_waitcnt lgkmcnt(0)
    v_readfirstlane_b32 s49, v4
    s_cmp_ge_u32 s49, s48
    s_cbranch_scc1 polldone_25
    s_sleep 1
    s_branch poll_24
polldone_25:
chk_23:
    s_cmp_ge_u32 s26, 12
    s_cbranch_scc1 anodma_26
    s_cmp_lg_u32 s33, 0
    s_cbranch_scc1 anodma_26
    s_add_u32 m0, s31, 10496
    s_nop 0
    buffer_load_dwordx4 v14, s[8:11], s23 offen sc1 lds
    s_mov_b64 exec, s[40:41]
    buffer_load_dwordx4 v14, s[8:11], s23 offen offset:1024 sc1 lds
    s_add_u32 s47, s23, 96
    s_mov_b64 exec, s[42:43]
    buffer_load_dwordx4 v14, s[8:11], s47 offen offset:1952 sc1 lds
    s_mov_b64 exec, -1
    s_add_u32 s23, s23, 12288
anodma_26:
    v_mfma_f32_32x32x16_bf16 v[92:107], v[36:39], v[24:27], v[60:75]
    ds_read_b128 v[36:39], v8 offset:31488
    v_exp_f32 v76, v76
    v_exp_f32 v77, v77
    v_exp_f32 v78, v78
    v_exp_f32_e64 v79, v79
    v_cvt_pk_bf16_f32 v52, v76, v77
    v_cvt_pk_bf16_f32 v53, v78, v79
    v_mfma_f32_32x32x16_bf16 v[124:139], v[48:51], v[56:59], v[124:139]
    ds_read_b128 v[48:51], v10 offset:24288
    v_exp_f32 v80, v80
    v_exp_f32 v81, v81
    v_exp_f32 v82, v82
    v_exp_f32 v83, v83
    v_cvt_pk_bf16_f32 v54, v80, v81
    v_cvt_pk_bf16_f32 v55, v82, v83
    v_mfma_f32_32x32x16_bf16 v[92:107], v[40:43], v[32:35], v[92:107]
    ds_read_b64 v[40:41], v9 offset:31488
    v_exp_f32 v84, v84
    v_exp_f32 v85, v85
    v_exp_f32 v86, v86
    v_exp_f32_e64 v87, v87
    s_waitcnt lgkmcnt(3)
    v_cvt_pk_bf16_f32 v56, v84, v85
    v_cvt_pk_bf16_f32 v57, v86, v87
    v_mfma_f32_32x32x16_bf16 v[108:123], v[44:47], v[52:55], v[108:123]
    v_exp_f32 v88, v88
    v_exp_f32 v89, v89
    v_exp_f32 v90, v90
    v_exp_f32 v91, v91
    s_setprio 3
    s_waitcnt lgkmcnt(2)
    v_cvt_pk_bf16_f32 v58, v88, v89
    v_cvt_pk_bf16_f32 v59, v90, v91
    v_mfma_f32_32x32x16_bf16 v[76:91], v[36:39], v[20:23], v[60:75]
    v_exp_f32 v92, v92
    v_exp_f32 v93, v93
    v_exp_f32 v94, v94
    v_exp_f32_e64 v95, v95
    s_waitcnt lgkmcnt(1)
    v_cvt_pk_bf16_f32 v52, v92, v93
    v_cvt_pk_bf16_f32 v53, v94, v95
    v_mfma_f32_32x32x16_bf16 v[108:123], v[48:51], v[56:59], v[108:123]
    v_exp_f32 v96, v96
    v_exp_f32 v97, v97
    v_exp_f32 v98, v98
    v_exp_f32_e64 v99, v99
    s_waitcnt lgkmcnt(0)
    v_cvt_pk_bf16_f32 v54, v96, v97
    v_cvt_pk_bf16_f32 v55, v98, v99
    v_mfma_f32_32x32x16_bf16 v[76:91], v[40:43], v[28:31], v[76:91]
    v_exp_f32 v100, v100
    v_exp_f32 v101, v101
    v_exp_f32 v102, v102
    v_exp_f32 v103, v103
    v_cvt_pk_bf16_f32 v56, v100, v101
    v_cvt_pk_bf16_f32 v57, v102, v103
    v_mfma_f32_32x32x16_bf16 v[124:139], v[44:47], v[52:55], v[124:139]
    ds_read_b128 v[44:47], v10 offset:31488
    v_exp_f32 v104, v104
    v_exp_f32 v105, v105
    v_exp_f32 v106, v106
    v_exp_f32_e64 v107, v107
    s_setprio 2
    v_cvt_pk_bf16_f32 v58, v104, v105
    v_cvt_pk_bf16_f32 v59, v106, v107
    s_cmp_ge_i32 s26, s55
    s_cbranch_scc1 av_27
    s_waitcnt vmcnt(3)
    s_branch av_28
av_27:
    s_waitcnt vmcnt(0)
av_28:
    s_mov_b64 exec, 1
    ds_add_u32 v2, v3
    s_mov_b64 exec, -1
    s_add_u32 s48, s48, 8
    v_mfma_f32_32x32x16_bf16 v[92:107], v[36:39], v[24:27], v[60:75]
    ds_read_b128 v[36:39], v8 offset:34112
    v_exp_f32 v76, v76
    v_exp_f32 v77, v77
    v_exp_f32 v78, v78
    v_exp_f32 v79, v79
    v_cvt_pk_bf16_f32 v52, v76, v77
    v_cvt_pk_bf16_f32 v53, v78, v79
    v_mfma_f32_32x32x16_bf16 v[124:139], v[48:51], v[56:59], v[124:139]
    ds_read_b128 v[48:51], v10 offset:32160
    v_exp_f32 v80, v80
    v_exp_f32 v81, v81
    v_exp_f32 v82, v82
    v_exp_f32 v83, v83
    v_cvt_pk_bf16_f32 v54, v80, v81
    v_cvt_pk_bf16_f32 v55, v82, v83
    v_mfma_f32_32x32x16_bf16 v[92:107], v[40:43], v[32:35], v[92:107]
    ds_read_b64 v[40:41], v9 offset:34112
    v_exp_f32 v84, v84
    v_exp_f32 v85, v85
    v_exp_f32 v86, v86
    v_exp_f32_e64 v87, v87
    s_waitcnt lgkmcnt(4)
    v_cvt_pk_bf16_f32 v56, v84, v85
    v_cvt_pk_bf16_f32 v57, v86, v87
    v_mfma_f32_32x32x16_bf16 v[108:123], v[44:47], v[52:55], v[108:123]
    v_exp_f32 v88, v88
    v_exp_f32 v89, v89
    v_exp_f32 v90, v90
    v_exp_f32 v91, v91
    s_setprio 1
    s_waitcnt lgkmcnt(2)
    v_cvt_pk_bf16_f32 v58, v88, v89
    v_cvt_pk_bf16_f32 v59, v90, v91
    v_mfma_f32_32x32x16_bf16 v[76:91], v[36:39], v[20:23], v[60:75]
    v_exp_f32 v92, v92
    v_exp_f32 v93, v93
    v_exp_f32 v94, v94
    v_exp_f32_e64 v95, v95
    s_waitcnt lgkmcnt(1)
    v_cvt_pk_bf16_f32 v52, v92, v93
    v_cvt_pk_bf16_f32 v53, v94, v95
    v_mfma_f32_32x32x16_bf16 v[108:123], v[48:51], v[56:59], v[108:123]
    v_exp_f32 v96, v96
    v_exp_f32 v97, v97
    v_exp_f32 v98, v98
    v_exp_f32_e64 v99, v99
    s_waitcnt lgkmcnt(0)
    v_cvt_pk_bf16_f32 v54, v96, v97
    v_cvt_pk_bf16_f32 v55, v98, v99
    v_mfma_f32_32x32x16_bf16 v[76:91], v[40:43], v[28:31], v[76:91]
    ds_read_b32 v4, v2
    v_exp_f32 v100, v100
    v_exp_f32 v101, v101
    v_exp_f32 v102, v102
    v_exp_f32 v103, v103
    v_cvt_pk_bf16_f32 v56, v100, v101
    v_cvt_pk_bf16_f32 v57, v102, v103
    v_mfma_f32_32x32x16_bf16 v[124:139], v[44:47], v[52:55], v[124:139]
    ds_read_b128 v[44:47], v10 offset:34112
    v_exp_f32 v104, v104
    v_exp_f32 v105, v105
    v_exp_f32 v106, v106
    v_exp_f32 v107, v107
    s_setprio 3
    s_waitcnt lgkmcnt(1)
    v_cvt_pk_bf16_f32 v58, v104, v105
    v_cvt_pk_bf16_f32 v59, v106, v107
    v_readfirstlane_b32 s49, v4
    s_cmp_ge_u32 s49, s48
    s_cbranch_scc1 chk_29
poll_30:
    ds_read_b32 v4, v2
    s_waitcnt lgkmcnt(0)
    v_readfirstlane_b32 s49, v4
    s_cmp_ge_u32 s49, s48
    s_cbranch_scc1 polldone_31
    s_sleep 1
    s_branch poll_30
polldone_31:
chk_29:
    s_cmp_ge_u32 s26, 12
    s_cbranch_scc1 anodma_32
    s_cmp_lg_u32 s33, 0
    s_cbranch_scc1 anodma_32
    s_add_u32 m0, s31, 20992
    s_nop 0
    buffer_load_dwordx4 v14, s[8:11], s23 offen sc1 lds
    s_mov_b64 exec, s[40:41]
    buffer_load_dwordx4 v14, s[8:11], s23 offen offset:1024 sc1 lds
    s_add_u32 s47, s23, 96
    s_mov_b64 exec, s[42:43]
    buffer_load_dwordx4 v14, s[8:11], s47 offen offset:1952 sc1 lds
    s_mov_b64 exec, -1
    s_add_u32 s23, s23, 12288
anodma_32:
    v_mfma_f32_32x32x16_bf16 v[92:107], v[36:39], v[24:27], v[60:75]
    ds_read_b128 v[36:39], v8 offset:0
    v_exp_f32 v76, v76
    v_exp_f32 v77, v77
    v_exp_f32 v78, v78
    v_exp_f32_e64 v79, v79
    v_cvt_pk_bf16_f32 v52, v76, v77
    v_cvt_pk_bf16_f32 v53, v78, v79
    v_mfma_f32_32x32x16_bf16 v[124:139], v[48:51], v[56:59], v[124:139]
    ds_read_b128 v[48:51], v10 offset:34784
    v_exp_f32 v80, v80
    v_exp_f32 v81, v81
    v_exp_f32 v82, v82
    v_exp_f32 v83, v83
    v_cvt_pk_bf16_f32 v54, v80, v81
    v_cvt_pk_bf16_f32 v55, v82, v83
    v_mfma_f32_32x32x16_bf16 v[92:107], v[40:43], v[32:35], v[92:107]
    ds_read_b64 v[40:41], v9 offset:0
    v_exp_f32 v84, v84
    v_exp_f32 v85, v85
    v_exp_f32 v86, v86
    v_exp_f32_e64 v87, v87
    s_waitcnt lgkmcnt(3)
    v_cvt_pk_bf16_f32 v56, v84, v85
    v_cvt_pk_bf16_f32 v57, v86, v87
    v_mfma_f32_32x32x16_bf16 v[108:123], v[44:47], v[52:55], v[108:123]
    v_exp_f32 v88, v88
    v_exp_f32 v89, v89
    v_exp_f32 v90, v90
    v_exp_f32 v91, v91
    s_setprio 3
    s_waitcnt lgkmcnt(2)
    v_cvt_pk_bf16_f32 v58, v88, v89
    v_cvt_pk_bf16_f32 v59, v90, v91
    v_mfma_f32_32x32x16_bf16 v[76:91], v[36:39], v[20:23], v[60:75]
    v_exp_f32 v92, v92
    v_exp_f32 v93, v93
    v_exp_f32 v94, v94
    v_exp_f32_e64 v95, v95
    s_waitcnt lgkmcnt(1)
    v_cvt_pk_bf16_f32 v52, v92, v93
    v_cvt_pk_bf16_f32 v53, v94, v95
    v_mfma_f32_32x32x16_bf16 v[108:123], v[48:51], v[56:59], v[108:123]
    v_exp_f32 v96, v96
    v_exp_f32 v97, v97
    v_exp_f32 v98, v98
    v_exp_f32_e64 v99, v99
    s_waitcnt lgkmcnt(0)
    v_cvt_pk_bf16_f32 v54, v96, v97
    v_cvt_pk_bf16_f32 v55, v98, v99
    v_mfma_f32_32x32x16_bf16 v[76:91], v[40:43], v[28:31], v[76:91]
    v_exp_f32 v100, v100
    v_exp_f32 v101, v101
    v_exp_f32 v102, v102
    v_exp_f32 v103, v103
    v_cvt_pk_bf16_f32 v56, v100, v101
    v_cvt_pk_bf16_f32 v57, v102, v103
    v_mfma_f32_32x32x16_bf16 v[124:139], v[44:47], v[52:55], v[124:139]
    ds_read_b128 v[44:47], v10 offset:0
    v_exp_f32 v104, v104
    v_exp_f32 v105, v105
    v_exp_f32 v106, v106
    v_exp_f32_e64 v107, v107
    s_setprio 2
    v_cvt_pk_bf16_f32 v58, v104, v105
    v_cvt_pk_bf16_f32 v59, v106, v107
    s_add_u32 s26, s26, 4
    s_cmp_lt_u32 s26, 16
    s_cbranch_scc1 za_loop
    v_mfma_f32_32x32x16_bf16 v[124:139], v[48:51], v[56:59], v[124:139]
    s_mov_b64 exec, 1
    ds_add_u32 v2, v3 offset:4
    s_mov_b64 exec, -1
    s_mul_i32 s27, s20, 3072
    v_add_u32_e64 v15, s27, v5
    s_xor_b32 s26, s20, 4
    s_mul_i32 s26, s26, 3072
    v_add_u32 v17, s26, v5
    s_lshl_b32 s27, s53, 2
    v_add_u32 v16, s27, v2
    s_nop 6
    s_cmp_lg_u32 s33, 0
    s_cbranch_scc1 za_h1
    ds_write_b128 v15, v[124:127] offset:0
    ds_write_b128 v15, v[128:131] offset:1024
    ds_write_b128 v15, v[132:135] offset:2048
    s_branch za_x
za_h1:
    ds_write_b128 v15, v[108:111] offset:0
    ds_write_b128 v15, v[112:115] offset:1024
    ds_write_b128 v15, v[116:119] offset:2048
    v_mov_b32 v108, v124
    v_mov_b32 v109, v125
    v_mov_b32 v110, v126
    v_mov_b32 v111, v127
    v_mov_b32 v112, v128
    v_mov_b32 v113, v129
    v_mov_b32 v114, v130
    v_mov_b32 v115, v131
    v_mov_b32 v116, v132
    v_mov_b32 v117, v133
    v_mov_b32 v118, v134
    v_mov_b32 v119, v135
    v_mov_b32 v20, v24
    v_mov_b32 v28, v32
    v_mov_b32 v21, v25
    v_mov_b32 v29, v33
    v_mov_b32 v22, v26
    v_mov_b32 v30, v34
    v_mov_b32 v23, v27
    v_mov_b32 v31, v35
za_x:
    s_mov_b64 exec, 1
    ds_add_u32 v16, v3 offset:8
    s_mov_b64 exec, -1
pw_33:
    ds_read_b32 v52, v16 offset:8
    s_waitcnt lgkmcnt(0)
    v_readfirstlane_b32 s27, v52
    s_cmp_ge_u32 s27, 2
    s_cbranch_scc1 pw_34
    s_sleep 1
    s_branch pw_33
pw_34:
    ds_read_b128 v[76:79], v17 offset:0
    ds_read_b128 v[80:83], v17 offset:1024
    ds_read_b128 v[84:87], v17 offset:2048
    s_waitcnt lgkmcnt(0)
    v_add_f32 v108, v108, v76
    v_add_f32 v109, v109, v77
    v_add_f32 v110, v110, v78
    v_add_f32 v111, v111, v79
    v_add_f32 v112, v112, v80
    v_add_f32 v113, v113, v81
    v_add_f32 v114, v114, v82
    v_add_f32 v115, v115, v83
    v_add_f32 v116, v116, v84
    v_add_f32 v117, v117, v85
    v_add_f32 v118, v118, v86
    v_add_f32 v119, v119, v87
    v_mov_b32 v15, v116
    v_mov_b32 v16, v116
    s_nop 1
    v_permlane32_swap_b32 v15, v16
    s_nop 1
    v_mul_f32 v17, 0, v108
    v_fma_f32 v17, v109, 0, v17
    v_fma_f32 v17, v110, 0, v17
    v_fma_f32 v17, v111, 0, v17
    v_fma_f32 v17, v112, 0, v17
    v_fma_f32 v17, v113, 0, v17
    v_fma_f32 v17, v114, 0, v17
    v_fma_f32 v17, v115, 0, v17
    v_fma_f32 v17, v116, 0, v17
    v_fma_f32 v17, v117, 0, v17
    v_fma_f32 v17, v118, 0, v17
    v_fma_f32 v17, v119, 0, v17
    v_add_f32_e64 v17, v17, v16
    s_mov_b32 s27, 0x71800000
    s_mov_b32 s26, 0x21800000
    v_cmp_ngt_f32 vcc, s27, v17
    v_cmp_nlt_f32 s[40:41], s26, v17
    s_nop 4
    s_or_b64 vcc, vcc, s[40:41]
    s_cbranch_scc1 za_slow
za_fin:
    v_rcp_f32 v16, v16
    s_nop 0
    v_mul_f32 v108, v108, v16
    v_mul_f32 v109, v109, v16
    v_mul_f32 v110, v110, v16
    v_mul_f32 v111, v111, v16
    v_mul_f32 v112, v112, v16
    v_mul_f32 v113, v113, v16
    v_mul_f32 v114, v114, v16
    v_mul_f32 v115, v115, v16
    v_mul_f32 v116, v116, v16
    v_mul_f32 v117, v117, v16
    v_mul_f32 v118, v118, v16
    v_mul_f32 v119, v119, v16
    v_cvt_pk_bf16_f32 v52, v108, v109
    v_cvt_pk_bf16_f32 v53, v110, v111
    v_cvt_pk_bf16_f32 v54, v112, v113
    v_cvt_pk_bf16_f32 v55, v114, v115
    v_cvt_pk_bf16_f32 v56, v116, v117
    v_cvt_pk_bf16_f32 v57, v118, v119
    buffer_store_dwordx4 v[52:55], v14, s[16:19], s29 offen sc1
    s_mov_b32 exec_hi, 0
    buffer_store_dwordx2 v[56:57], v6, s[16:19], s32 offen sc1
    v_mov_b32 v15, s84
    v_lshlrev_b32 v17, 2, v1
    s_lshl_b32 s27, s53, 2
    v_add_u32_e64 v16, s27, v2
    s_mov_b64 exec, 1
    s_waitcnt vmcnt(0)
    ds_add_rtn_u32 v52, v16, v3 offset:8
    s_waitcnt lgkmcnt(0)
    v_readfirstlane_b32 s27, v52
    s_mov_b32 exec_lo, -1
    s_cmp_lg_u32 s27, 3
    s_cbranch_scc1 za_nf
    buffer_store_dword v15, v17, s[16:19], s46 offen sc1
za_nf:
    s_endpgm
za_slow:
    v_mov_b32 v15, 0xff800000
    v_mov_b32 v40, 0
    v_mov_b32 v41, 0
    v_and_b32 v16, 31, v1
    v_cmp_eq_u32 vcc, 20, v16
    v_mov_b32 v17, 0x3f803f80
    s_nop 1
    v_cndmask_b32 v17, 0, v17, vcc
    v_mov_b32 v44, v17
    v_mov_b32 v48, v17
    v_mov_b32 v45, v17
    v_mov_b32 v49, v17
    v_mov_b32 v46, v17
    v_mov_b32 v50, v17
    v_mov_b32 v47, v17
    v_mov_b32 v51, v17
    s_mov_b32 s23, s30
    s_mov_b32 s26, 0
za_slow1:
    buffer_load_dwordx4 v[36:39], v14, s[8:11], s23 offen sc1
    s_mov_b32 exec_hi, 0
    buffer_load_dwordx2 v[40:41], v6, s[8:11], s23 offen sc1
    s_mov_b32 exec_hi, -1
    s_waitcnt vmcnt(0)
    v_mfma_f32_32x32x16_bf16 v[76:91], v[36:39], v[20:23], 0
    v_mfma_f32_32x32x16_bf16 v[76:91], v[40:43], v[28:31], v[76:91]
    s_nop 15
    v_max3_f32 v15, v15, v76, v77
    v_max3_f32 v15, v15, v78, v79
    v_max3_f32 v15, v15, v80, v81
    v_max3_f32 v15, v15, v82, v83
    v_max3_f32 v15, v15, v84, v85
    v_max3_f32 v15, v15, v86, v87
    v_max3_f32 v15, v15, v88, v89
    v_max3_f32 v15, v15, v90, v91
    s_add_u32 s23, s23, 3072
    s_add_u32 s26, s26, 1
    s_cmp_lt_u32 s26, 64
    s_cbranch_scc1 za_slow1
    v_mov_b32 v16, v15
    s_nop 1
    v_permlane32_swap_b32 v15, v16
    s_nop 1
    v_max_f32 v15, v15, v16
    v_sub_f32 v60, 0, v15
    v_sub_f32 v61, 0, v15
    v_sub_f32 v62, 0, v15
    v_sub_f32 v63, 0, v15
    v_sub_f32 v64, 0, v15
    v_sub_f32 v65, 0, v15
    v_sub_f32 v66, 0, v15
    v_sub_f32 v67, 0, v15
    v_sub_f32 v68, 0, v15
    v_sub_f32 v69, 0, v15
    v_sub_f32 v70, 0, v15
    v_sub_f32 v71, 0, v15
    v_sub_f32 v72, 0, v15
    v_sub_f32 v73, 0, v15
    v_sub_f32 v74, 0, v15
    v_sub_f32 v75, 0, v15
    s_nop 1
    v_mov_b32 v108, 0
    v_mov_b32 v109, 0
    v_mov_b32 v110, 0
    v_mov_b32 v111, 0
    v_mov_b32 v112, 0
    v_mov_b32 v113, 0
    v_mov_b32 v114, 0
    v_mov_b32 v115, 0
    v_mov_b32 v116, 0
    v_mov_b32 v117, 0
    v_mov_b32 v118, 0
    v_mov_b32 v119, 0
    v_mov_b32 v120, 0
    v_mov_b32 v121, 0
    v_mov_b32 v122, 0
    v_mov_b32_e64 v123, 0
    s_mov_b32 s23, s30
    s_mov_b32 s26, 0
za_slow2:
    buffer_load_dwordx4 v[36:39], v14, s[8:11], s23 offen sc1
    s_mov_b32 exec_hi, 0
    buffer_load_dwordx2 v[40:41], v6, s[8:11], s23 offen sc1
    s_mov_b32 exec_hi, -1
    s_mov_b64 exec, s[44:45]
    buffer_load_dwordx4 v[44:47], v7, s[8:11], s23 offen sc1
    buffer_load_dwordx4 v[48:51], v7, s[8:11], s23 offen offset:768 sc1
    s_mov_b64 exec, -1
    s_waitcnt vmcnt(0)
    v_mfma_f32_32x32x16_bf16 v[76:91], v[36:39], v[20:23], v[60:75]
    v_mfma_f32_32x32x16_bf16 v[76:91], v[40:43], v[28:31], v[76:91]
    s_nop 15
    v_exp_f32 v76, v76
    v_exp_f32 v77, v77
    v_exp_f32 v78, v78
    v_exp_f32 v79, v79
    v_cvt_pk_bf16_f32 v52, v76, v77
    v_cvt_pk_bf16_f32 v53, v78, v79
    v_exp_f32 v80, v80
    v_exp_f32 v81, v81
    v_exp_f32 v82, v82
    v_exp_f32 v83, v83
    v_cvt_pk_bf16_f32 v54, v80, v81
    v_cvt_pk_bf16_f32 v55, v82, v83
    v_exp_f32 v84, v84
    v_exp_f32 v85, v85
    v_exp_f32 v86, v86
    v_exp_f32 v87, v87
    v_cvt_pk_bf16_f32 v56, v84, v85
    v_cvt_pk_bf16_f32 v57, v86, v87
    v_exp_f32 v88, v88
    v_exp_f32 v89, v89
    v_exp_f32 v90, v90
    v_exp_f32 v91, v91
    v_cvt_pk_bf16_f32 v58, v88, v89
    v_cvt_pk_bf16_f32 v59, v90, v91
    s_nop 1
    v_mfma_f32_32x32x16_bf16 v[108:123], v[44:47], v[52:55], v[108:123]
    v_mfma_f32_32x32x16_bf16 v[108:123], v[48:51], v[56:59], v[108:123]
    s_add_u32 s23, s23, 3072
    s_add_u32 s26, s26, 1
    s_cmp_lt_u32 s26, 64
    s_cbranch_scc1 za_slow2
    s_nop 15
    v_mov_b32 v15, v116
    v_mov_b32_e64 v16, v116
    s_nop 1
    v_permlane32_swap_b32 v15, v16
    s_nop 1
    s_branch za_fin
z_ffn:
    s_load_dwordx4 s[40:43], s[0:1], 32
    s_load_dwordx4 s[36:39], s[0:1], 48
    s_load_dwordx2 s[82:83], s[0:1], 16
    v_and_b32 v1, 63, v0
    v_mov_b32 v3, 1
    v_mov_b32 v4, 0
    v_lshlrev_b32 v2, 2, v1
    v_add_u32 v2, 163776, v2
    s_mov_b64 exec, 0xffff
    ds_write_b32 v2, v4
    s_mov_b64 exec, -1
    v_mov_b32 v2, 163808
    s_mov_b32 s48, 0
    s_sub_u32 s50, s20, 8
    s_and_b32 s3, s2, 7
    s_lshr_b32 s23, s2, 3
    s_lshr_b32 s21, s3, 2
    s_lshl_b32 s21, s21, 3
    s_lshr_b32 s24, s23, 2
    s_add_u32 s21, s21, s24
    s_and_b32 s22, s3, 3
    s_lshl_b32 s22, s22, 2
    s_and_b32 s24, s23, 3
    s_add_u32 s22, s22, s24
    s_and_b32 s3, s2, 7
    s_lshr_b32 s23, s2, 3
    s_lshr_b32 s61, s3, 1
    s_lshl_b32 s61, s61, 3
    s_lshr_b32 s24, s23, 2
    s_add_u32 s61, s61, s24
    s_and_b32 s62, s3, 1
    s_lshl_b32 s62, s62, 2
    s_and_b32 s24, s23, 3
    s_add_u32 s62, s62, s24
    s_waitcnt lgkmcnt(0)
    s_mov_b32 s85, 46366720
    s_load_dword s84, s[34:35], s85
    s_cmp_ge_u32 s50, 2
    s_cselect_b32 s40, s42, s40
    s_cselect_b32 s41, s43, s41
    s_mov_b32 s8, s34
    s_mov_b32 s9, s35
    s_mov_b32 s10, 0x2d00000
    s_mov_b32 s11, 0x00020000
    s_mov_b32 s12, s40
    s_mov_b32 s13, s41
    s_mov_b32 s14, 0x1e0000
    s_mov_b32 s15, 0x00020000
    s_mov_b32 s16, s4
    s_mov_b32 s17, s5
    s_mov_b32 s18, 0x280000
    s_mov_b32 s19, 0x00020000
    s_mov_b32 s64, s36
    s_mov_b32 s65, s37
    s_mov_b32 s66, 0x1e0000
    s_mov_b32 s67, 0x00020000
    s_mov_b32 s24, s82
    s_mov_b32 s25, s83
    s_mov_b32 s26, 0xc8000
    s_mov_b32 s27, 0x00020000
    s_mov_b32 s28, s38
    s_mov_b32 s29, s39
    s_mov_b32 s30, 0x280000
    s_mov_b32 s31, 0x00020000
    s_waitcnt lgkmcnt(0)
    s_mul_i32 s84, s84, 0x9e3779b1
    s_add_u32 s84, s84, 0x7f4a7c15
    v_lshlrev_b32 v5, 7, v1
    v_add_u32 v100, 0, v1
    v_mul_u32_u24 v101, 5462, v100
    v_lshrrev_b32 v101, 16, v101
    v_mul_u32_u24 v102, 12, v101
    v_sub_u32_e64 v100, v100, v102
    v_mul_u32_u24 v6, 1280, v101
    v_lshl_add_u32 v6, v100, 4, v6
    v_add_u32_e64 v100, 64, v1
    v_mul_u32_u24 v101, 5462, v100
    v_lshrrev_b32 v101, 16, v101
    v_mul_u32_u24 v102, 12, v101
    v_sub_u32_e64 v100, v100, v102
    v_mul_u32_u24 v7, 1280, v101
    v_lshl_add_u32 v7, v100, 4, v7
    v_subrev_u32 v7, 1024, v7
    v_add_u32 v100, 128, v1
    v_mul_u32_u24 v101, 5462, v100
    v_lshrrev_b32 v101, 16, v101
    v_mul_u32_u24 v102, 12, v101
    v_sub_u32_e64 v100, v100, v102
    v_mul_u32_u24 v8, 1280, v101
    v_lshl_add_u32 v8, v100, 4, v8
    v_subrev_u32 v8, 2048, v8
    v_lshrrev_b32_e64 v9, 1, v1
    v_mul_u32_u24 v9, 1280, v9
    v_and_b32_e64 v100, 1, v1
    v_lshl_add_u32 v9, v100, 7, v9
    s_and_b32 s40, s61, 7
    s_lshl_b32 s40, s40, 2
    s_add_u32 s40, s40, s50
    s_mul_i32 s41, s62, 160
    s_mul_i32 s78, s40, 61440
    s_add_u32 s78, s78, s41
    s_mul_i32 s79, s40, 25600
    s_add_u32 s79, s79, s41
    v_lshlrev_b32 v11, 4, v1
    v_add_u32_e64 v60, 0, v1
    v_mul_u32_u24 v61, 5462, v60
    v_lshrrev_b32 v61, 16, v61
    v_mul_u32_u24 v62, 12, v61
    v_sub_u32_e64 v60, v60, v62
    v_mul_u32_u24 v14, 3072, v61
    v_lshl_add_u32 v14, v60, 4, v14
    v_add_u32_e64 v60, 64, v1
    v_mul_u32_u24 v61, 5462, v60
    v_lshrrev_b32 v61, 16, v61
    v_mul_u32_u24 v62, 12, v61
    v_sub_u32_e64 v60, v60, v62
    v_mul_u32_u24 v15, 3072, v61
    v_lshl_add_u32 v15, v60, 4, v15
    v_subrev_u32 v15, 1024, v15
    v_add_u32 v60, 128, v1
    v_mul_u32_u24 v61, 5462, v60
    v_lshrrev_b32 v61, 16, v61
    v_mul_u32_u24 v62, 12, v61
    v_sub_u32_e64 v60, v60, v62
    v_mul_u32_u24 v16, 3072, v61
    v_lshl_add_u32 v16, v60, 4, v16
    v_subrev_u32 v16, 2048, v16
    s_lshl_b32 s58, s21, 2
    s_add_u32 s58, s58, s50
    s_mul_i32 s51, s58, 40960
    s_add_u32 s51, s51, 16777216
    s_and_b32 s58, s50, 1
    s_mul_i32 s52, s58, 49152
    s_mul_i32 s59, s22, 192
    s_add_u32 s52, s52, s59
    s_lshl_b32 s53, s50, 11
    s_add_u32 s53, s53, 41984
    s_mul_i32 s54, s58, 3072
    s_cmp_ge_u32 s50, 2
    s_cselect_b32 s59, 6176, 0
    s_add_u32 s54, s54, s59
    s_add_u32 s54, s54, 50176
    s_and_b32 s60, s21, 7
    s_and_b32 s59, s22, 3
    s_lshl_b32 s59, s59, 1
    s_add_u32 s60, s60, s59
    s_mul_i32 s60, s60, 5
    s_lshr_b32 s60, s60, 1
    s_cmp_ge_u32 s60, 20
    s_cselect_b32 s59, 20, 0
    s_sub_u32 s60, s60, s59
    s_mov_b32 s60, 0
    s_lshl_b32 s59, s60, 11
    s_add_u32 s51, s51, s59
    s_mul_i32 s59, s60, 98304
    s_add_u32 s52, s52, s59
    v_and_b32 v63, 31, v1
    v_lshlrev_b32_e64 v63, 2, v63
    s_lshl_b32 s56, s21, 9
    s_lshl_b32 s58, s58, 8
    s_add_u32 s56, s56, s58
    s_add_u32 s56, s56, 19922944
    s_and_b32 s58, s50, 1
    s_lshl_b32 s58, s58, 12
    s_add_u32 s58, s58, 41984
    v_add_u32_e64 v17, s58, v11
    v_bfe_u32 v60, v1, 2, 2
    v_lshrrev_b32_e64 v61, 5, v1
    v_lshl_add_u32 v60, v61, 3, v60
    v_mul_u32_u24 v18, 192, v60
    v_and_b32_e64 v60, 3, v1
    v_lshl_add_u32 v18, v60, 3, v18
    v_bfe_u32 v60, v1, 4, 1
    v_mul_u32_u24 v60, 6176, v60
    s_lshr_b32 s58, s50, 1
    s_mul_i32 s58, s58, 96
    s_add_u32 s58, s58, 50176
    v_add3_u32 v18, v18, v60, s58
    v_add_u32 v19, 61632, v17
    v_add_u32 v20, 61632, v18
    v_mov_b32 v64, 0
    v_mov_b32 v65, 0
    v_mov_b32 v66, 0
    v_mov_b32 v67, 0
    v_mov_b32 v68, 0
    v_mov_b32 v69, 0
    v_mov_b32 v70, 0
    v_mov_b32 v71, 0
    v_mov_b32 v72, 0
    v_mov_b32 v73, 0
    v_mov_b32 v74, 0
    v_mov_b32 v75, 0
    v_mov_b32 v76, 0
    v_mov_b32 v77, 0
    v_mov_b32 v78, 0
    v_mov_b32 v79, 0
    v_mov_b32 v80, 0
    v_mov_b32 v81, 0
    v_mov_b32 v82, 0
    v_mov_b32 v83, 0
    v_mov_b32 v84, 0
    v_mov_b32 v85, 0
    v_mov_b32 v86, 0
    v_mov_b32 v87, 0
    v_mov_b32 v88, 0
    v_mov_b32 v89, 0
    v_mov_b32 v90, 0
    v_mov_b32 v91, 0
    v_mov_b32 v92, 0
    v_mov_b32 v93, 0
    v_mov_b32 v94, 0
    v_mov_b32 v95, 0
    v_mov_b32 v96, 0
    v_mov_b32 v97, 0
    v_mov_b32 v98, 0
    v_mov_b32 v99, 0
    v_mov_b32 v100, 0
    v_mov_b32 v101, 0
    v_mov_b32 v102, 0
    v_mov_b32 v103, 0
    v_mov_b32 v104, 0
    v_mov_b32 v105, 0
    v_mov_b32 v106, 0
    v_mov_b32 v107, 0
    v_mov_b32 v108, 0
    v_mov_b32 v109, 0
    v_mov_b32 v110, 0
    v_mov_b32 v111, 0
    v_mov_b32 v112, 0
    v_mov_b32 v113, 0
    v_mov_b32 v114, 0
    v_mov_b32 v115, 0
    v_mov_b32 v116, 0
    v_mov_b32 v117, 0
    v_mov_b32 v118, 0
    v_mov_b32 v119, 0
    v_mov_b32 v120, 0
    v_mov_b32 v121, 0
    v_mov_b32 v122, 0
    v_mov_b32 v123, 0
    v_mov_b32 v124, 0
    v_mov_b32 v125, 0
    v_mov_b32 v126, 0
    v_mov_b32 v127, 0
    v_mov_b32 v128, 0
    v_mov_b32 v129, 0
    v_mov_b32 v130, 0
    v_mov_b32 v131, 0
    v_mov_b32 v132, 0
    v_mov_b32 v133, 0
    v_mov_b32 v134, 0
    v_mov_b32 v135, 0
    v_mov_b32 v136, 0
    v_mov_b32 v137, 0
    v_mov_b32 v138, 0
    v_mov_b32 v139, 0
    v_mov_b32 v140, 0
    v_mov_b32 v141, 0
    v_mov_b32 v142, 0
    v_mov_b32 v143, 0
    v_mov_b32 v144, 0
    v_mov_b32 v145, 0
    v_mov_b32 v146, 0
    v_mov_b32 v147, 0
    v_mov_b32 v148, 0
    v_mov_b32 v149, 0
    v_mov_b32 v150, 0
    v_mov_b32 v151, 0
    v_mov_b32 v152, 0
    v_mov_b32 v153, 0
    v_mov_b32 v154, 0
    v_mov_b32 v155, 0
    v_mov_b32 v156, 0
    v_mov_b32 v157, 0
    v_mov_b32 v158, 0
    v_mov_b32_e64 v159, 0
    s_mov_b32 s55, 0
    s_cmp_eq_u32 s62, 7
    s_cselect_b32 s41, 10, 20
bar_35:
    s_barrier
    s_sub_u32 s41, s41, 1
    s_cmp_lg_u32 s41, 0
    s_cbranch_scc1 bar_35
    s_lshl_b32 s40, s21, 11
    s_add_u32 s40, s40, 46170112
    s_mov_b32 s41, 0
    s_mov_b64 exec, 0xffff
    buffer_load_dword v4, v5, s[8:11], s40 offen sc1
    s_mov_b64 exec, -1
    s_barrier
    s_mov_b64 exec, 0xffff
    s_waitcnt vmcnt(0)
    s_branch fchk_38
fpoll_36:
    buffer_load_dword v4, v5, s[8:11], s40 offen sc1
    s_waitcnt vmcnt(0)
fchk_38:
    v_cmp_ne_u32 vcc, s84, v4
    s_add_u32 s41, s41, 1
    s_nop 3
    s_cbranch_vccz fdone_37
    s_sleep 16
    s_cmp_lt_u32 s41, 0x40000
    s_cbranch_scc1 fpoll_36
fdone_37:
    s_mov_b64 exec, -1
    s_setprio 0
    buffer_load_dword v12, v63, s[8:11], s56 offen sc1
    buffer_load_dword v13, v63, s[8:11], s56 offen offset:128 sc1
    s_add_u32 m0, s53, 0
    s_add_u32 s60, s60, 1
    buffer_load_dwordx4 v11, s[8:11], s51 offen sc1 lds
    buffer_load_dwordx4 v11, s[8:11], s51 offen offset:1024 sc1 lds
    s_add_u32 m0, s54, 0
    s_add_u32 s51, s51, 2048
    buffer_load_dwordx4 v14, s[12:15], s52 offen offset:0 lds
    buffer_load_dwordx4 v15, s[12:15], s52 offen offset:1024 lds
    buffer_load_dwordx4 v16, s[12:15], s52 offen offset:2048 lds
    s_add_u32 s52, s52, 98304
    s_cmp_eq_u32 s60, 20
    s_cselect_b32 s59, 40960, 0
    s_cselect_b32 s58, 1966080, 0
    s_sub_u32 s51, s51, s59
    s_sub_u32 s52, s52, s58
    s_add_u32 m0, s53, 20544
    s_add_u32 s60, s60, 1
    buffer_load_dwordx4 v11, s[8:11], s51 offen sc1 lds
    buffer_load_dwordx4 v11, s[8:11], s51 offen offset:1024 sc1 lds
    s_add_u32 m0, s54, 20544
    s_add_u32 s51, s51, 2048
    buffer_load_dwordx4 v14, s[12:15], s52 offen offset:0 lds
    buffer_load_dwordx4 v15, s[12:15], s52 offen offset:1024 lds
    buffer_load_dwordx4 v16, s[12:15], s52 offen offset:2048 lds
    s_add_u32 s52, s52, 98304
    s_cmp_eq_u32 s60, 20
    s_cselect_b32 s59, 40960, 0
    s_cselect_b32 s58, 1966080, 0
    s_sub_u32 s51, s51, s59
    s_sub_u32 s52, s52, s58
    s_waitcnt vmcnt(5)
    s_mov_b64 exec, 1
    ds_add_u32 v2, v3
    s_mov_b64 exec, -1
    s_add_u32 s48, s48, 4
    s_add_u32 m0, s53, 41088
    s_add_u32 s60, s60, 1
    buffer_load_dwordx4 v11, s[8:11], s51 offen sc1 lds
    buffer_load_dwordx4 v11, s[8:11], s51 offen offset:1024 sc1 lds
    s_add_u32 m0, s54, 41088
    s_add_u32 s51, s51, 2048
    buffer_load_dwordx4 v14, s[12:15], s52 offen offset:0 lds
    buffer_load_dwordx4 v15, s[12:15], s52 offen offset:1024 lds
    buffer_load_dwordx4 v16, s[12:15], s52 offen offset:2048 lds
    s_add_u32 s52, s52, 98304
    s_cmp_eq_u32 s60, 20
    s_cselect_b32 s59, 40960, 0
    s_cselect_b32 s58, 1966080, 0
    s_sub_u32 s51, s51, s59
    s_sub_u32 s52, s52, s58
poll_39:
    ds_read_b32 v4, v2
    s_waitcnt lgkmcnt(0)
    v_readfirstlane_b32 s49, v4
    s_cmp_ge_u32 s49, s48
    s_cbranch_scc1 polldone_40
    s_sleep 1
    s_branch poll_39
polldone_40:
    ds_read_b128 v[24:27], v17 offset:0
    ds_read_b64_tr_b16 v[32:33], v18 offset:0
    ds_read_b64_tr_b16 v[34:35], v18 offset:768
    ds_read_b128 v[28:31], v17 offset:2048
    ds_read_b64_tr_b16 v[36:37], v18 offset:32
    ds_read_b64_tr_b16 v[38:39], v18 offset:800
    ds_read_b64_tr_b16 v[40:41], v18 offset:64
    ds_read_b64_tr_b16 v[42:43], v18 offset:832
    s_waitcnt vmcnt(5)
    s_mov_b64 exec, 1
    ds_add_u32 v2, v3
    s_mov_b64 exec, -1
    s_add_u32 s48, s48, 4
    s_add_u32 m0, s53, 61632
    s_add_u32 s60, s60, 1
    buffer_load_dwordx4 v11, s[8:11], s51 offen sc1 lds
    buffer_load_dwordx4 v11, s[8:11], s51 offen offset:1024 sc1 lds
    s_add_u32 m0, s54, 61632
    s_add_u32 s51, s51, 2048
    buffer_load_dwordx4 v14, s[12:15], s52 offen offset:0 lds
    buffer_load_dwordx4 v15, s[12:15], s52 offen offset:1024 lds
    buffer_load_dwordx4 v16, s[12:15], s52 offen offset:2048 lds
    s_add_u32 s52, s52, 98304
    s_cmp_eq_u32 s60, 20
    s_cselect_b32 s59, 40960, 0
    s_cselect_b32 s58, 1966080, 0
    s_sub_u32 s51, s51, s59
    s_sub_u32 s52, s52, s58
zf1_top:
    s_waitcnt lgkmcnt(0)
    v_mfma_f32_32x32x16_bf16 v[64:79], v[32:35], v[24:27], v[64:79]
    ds_read_b128 v[44:47], v17 offset:1024
    ds_read_b64_tr_b16 v[52:53], v18 offset:3072
    ds_read_b64_tr_b16 v[54:55], v18 offset:3840
    ds_read_b32 v4, v2
    v_mfma_f32_32x32x16_bf16 v[112:127], v[32:35], v[28:31], v[112:127]
    ds_read_b128 v[48:51], v17 offset:3072
    ds_read_b64_tr_b16 v[56:57], v18 offset:3104
    ds_read_b64_tr_b16 v[58:59], v18 offset:3872
    v_mfma_f32_32x32x16_bf16 v[80:95], v[36:39], v[24:27], v[80:95]
    ds_read_b64_tr_b16 v[60:61], v18 offset:3136
    ds_read_b64_tr_b16 v[62:63], v18 offset:3904
    v_mfma_f32_32x32x16_bf16 v[128:143], v[36:39], v[28:31], v[128:143]
    v_mfma_f32_32x32x16_bf16 v[96:111], v[40:43], v[24:27], v[96:111]
    s_waitcnt lgkmcnt(5)
    s_setprio 3
    v_readfirstlane_b32 s49, v4
    s_setprio 0
    s_cmp_ge_u32 s49, s48
    s_cbranch_scc1 chk_41
poll_42:
    ds_read_b32 v4, v2
    s_waitcnt lgkmcnt(0)
    v_readfirstlane_b32 s49, v4
    s_cmp_ge_u32 s49, s48
    s_cbranch_scc1 polldone_43
    s_sleep 1
    s_branch poll_42
polldone_43:
chk_41:
    s_cmp_ge_u32 s55, 16
    s_cbranch_scc1 f1nd_44
    v_mfma_f32_32x32x16_bf16 v[144:159], v[40:43], v[28:31], v[144:159]
    s_waitcnt vmcnt(5)
    s_mov_b64 exec, 1
    ds_add_u32 v2, v3
    s_mov_b64 exec, -1
    s_add_u32 s48, s48, 4
    s_waitcnt lgkmcnt(1)
    v_mfma_f32_32x32x16_bf16 v[64:79], v[52:55], v[44:47], v[64:79]
    ds_read_b128 v[24:27], v17 offset:20544
    ds_read_b64_tr_b16 v[32:33], v18 offset:20544
    ds_read_b64_tr_b16 v[34:35], v18 offset:21312
    s_add_u32 m0, s53, 82176
    s_add_u32 s60, s60, 1
    buffer_load_dwordx4 v11, s[8:11], s51 offen sc1 lds
    v_mfma_f32_32x32x16_bf16 v[112:127], v[52:55], v[48:51], v[112:127]
    ds_read_b128 v[28:31], v17 offset:22592
    ds_read_b64_tr_b16 v[36:37], v18 offset:20576
    ds_read_b64_tr_b16 v[38:39], v18 offset:21344
    buffer_load_dwordx4 v11, s[8:11], s51 offen offset:1024 sc1 lds
    v_mfma_f32_32x32x16_bf16 v[80:95], v[56:59], v[44:47], v[80:95]
    ds_read_b64_tr_b16 v[40:41], v18 offset:20608
    ds_read_b64_tr_b16 v[42:43], v18 offset:21376
    s_add_u32 m0, s54, 82176
    s_add_u32 s51, s51, 2048
    buffer_load_dwordx4 v14, s[12:15], s52 offen offset:0 lds
    v_mfma_f32_32x32x16_bf16 v[128:143], v[56:59], v[48:51], v[128:143]
    buffer_load_dwordx4 v15, s[12:15], s52 offen offset:1024 lds
    v_mfma_f32_32x32x16_bf16 v[96:111], v[60:63], v[44:47], v[96:111]
    buffer_load_dwordx4 v16, s[12:15], s52 offen offset:2048 lds
    v_mfma_f32_32x32x16_bf16 v[144:159], v[60:63], v[48:51], v[144:159]
    s_add_u32 s52, s52, 98304
    s_cmp_eq_u32 s60, 20
    s_cselect_b32 s59, 40960, 0
    s_cselect_b32 s58, 1966080, 0
    s_sub_u32 s51, s51, s59
    s_sub_u32 s52, s52, s58
    s_branch f1jn_45
f1nd_44:
    v_mfma_f32_32x32x16_bf16 v[144:159], v[40:43], v[28:31], v[144:159]
    s_waitcnt vmcnt(0)
    s_mov_b64 exec, 1
    ds_add_u32 v2, v3
    s_mov_b64 exec, -1
    s_add_u32 s48, s48, 4
    s_waitcnt lgkmcnt(1)
    v_mfma_f32_32x32x16_bf16 v[64:79], v[52:55], v[44:47], v[64:79]
    ds_read_b128 v[24:27], v17 offset:20544
    ds_read_b64_tr_b16 v[32:33], v18 offset:20544
    ds_read_b64_tr_b16 v[34:35], v18 offset:21312
    v_mfma_f32_32x32x16_bf16 v[112:127], v[52:55], v[48:51], v[112:127]
    ds_read_b128 v[28:31], v17 offset:22592
    ds_read_b64_tr_b16 v[36:37], v18 offset:20576
    ds_read_b64_tr_b16 v[38:39], v18 offset:21344
    v_mfma_f32_32x32x16_bf16 v[80:95], v[56:59], v[44:47], v[80:95]
    ds_read_b64_tr_b16 v[40:41], v18 offset:20608
    ds_read_b64_tr_b16 v[42:43], v18 offset:21376
    v_mfma_f32_32x32x16_bf16 v[128:143], v[56:59], v[48:51], v[128:143]
    v_mfma_f32_32x32x16_bf16 v[96:111], v[60:63], v[44:47], v[96:111]
    v_mfma_f32_32x32x16_bf16 v[144:159], v[60:63], v[48:51], v[144:159]
f1jn_45:
    s_waitcnt lgkmcnt(0)
    v_mfma_f32_32x32x16_bf16 v[64:79], v[32:35], v[24:27], v[64:79]
    ds_read_b128 v[44:47], v17 offset:21568
    ds_read_b64_tr_b16 v[52:53], v18 offset:23616
    ds_read_b64_tr_b16 v[54:55], v18 offset:24384
    ds_read_b32 v4, v2
    v_mfma_f32_32x32x16_bf16 v[112:127], v[32:35], v[28:31], v[112:127]
    ds_read_b128 v[48:51], v17 offset:23616
    ds_read_b64_tr_b16 v[56:57], v18 offset:23648
    ds_read_b64_tr_b16 v[58:59], v18 offset:24416
    v_mfma_f32_32x32x16_bf16 v[80:95], v[36:39], v[24:27], v[80:95]
    ds_read_b64_tr_b16 v[60:61], v18 offset:23680
    ds_read_b64_tr_b16 v[62:63], v18 offset:24448
    v_mfma_f32_32x32x16_bf16 v[128:143], v[36:39], v[28:31], v[128:143]
    v_mfma_f32_32x32x16_bf16 v[96:111], v[40:43], v[24:27], v[96:111]
    s_waitcnt lgkmcnt(5)
    s_setprio 3
    v_readfirstlane_b32 s49, v4
    s_setprio 0
    s_cmp_ge_u32 s49, s48
    s_cbranch_scc1 chk_46
poll_47:
    ds_read_b32 v4, v2
    s_waitcnt lgkmcnt(0)
    v_readfirstlane_b32 s49, v4
    s_cmp_ge_u32 s49, s48
    s_cbranch_scc1 polldone_48
    s_sleep 1
    s_branch poll_47
polldone_48:
chk_46:
    s_cmp_ge_u32 s55, 15
    s_cbranch_scc1 f1nd_49
    v_mfma_f32_32x32x16_bf16 v[144:159], v[40:43], v[28:31], v[144:159]
    s_waitcnt vmcnt(5)
    s_mov_b64 exec, 1
    ds_add_u32 v2, v3
    s_mov_b64 exec, -1
    s_add_u32 s48, s48, 4
    s_waitcnt lgkmcnt(1)
    v_mfma_f32_32x32x16_bf16 v[64:79], v[52:55], v[44:47], v[64:79]
    ds_read_b128 v[24:27], v17 offset:41088
    ds_read_b64_tr_b16 v[32:33], v18 offset:41088
    ds_read_b64_tr_b16 v[34:35], v18 offset:41856
    s_add_u32 m0, s53, 0
    s_add_u32 s60, s60, 1
    buffer_load_dwordx4 v11, s[8:11], s51 offen sc1 lds
    v_mfma_f32_32x32x16_bf16 v[112:127], v[52:55], v[48:51], v[112:127]
    ds_read_b128 v[28:31], v17 offset:43136
    ds_read_b64_tr_b16 v[36:37], v18 offset:41120
    ds_read_b64_tr_b16 v[38:39], v18 offset:41888
    buffer_load_dwordx4 v11, s[8:11], s51 offen offset:1024 sc1 lds
    v_mfma_f32_32x32x16_bf16 v[80:95], v[56:59], v[44:47], v[80:95]
    ds_read_b64_tr_b16 v[40:41], v18 offset:41152
    ds_read_b64_tr_b16 v[42:43], v18 offset:41920
    s_add_u32 m0, s54, 0
    s_add_u32 s51, s51, 2048
    buffer_load_dwordx4 v14, s[12:15], s52 offen offset:0 lds
    v_mfma_f32_32x32x16_bf16 v[128:143], v[56:59], v[48:51], v[128:143]
    buffer_load_dwordx4 v15, s[12:15], s52 offen offset:1024 lds
    v_mfma_f32_32x32x16_bf16 v[96:111], v[60:63], v[44:47], v[96:111]
    buffer_load_dwordx4 v16, s[12:15], s52 offen offset:2048 lds
    v_mfma_f32_32x32x16_bf16 v[144:159], v[60:63], v[48:51], v[144:159]
    s_add_u32 s52, s52, 98304
    s_cmp_eq_u32 s60, 20
    s_cselect_b32 s59, 40960, 0
    s_cselect_b32 s58, 1966080, 0
    s_sub_u32 s51, s51, s59
    s_sub_u32 s52, s52, s58
    s_branch f1jn_50
f1nd_49:
    v_mfma_f32_32x32x16_bf16 v[144:159], v[40:43], v[28:31], v[144:159]
    s_waitcnt vmcnt(0)
    s_mov_b64 exec, 1
    ds_add_u32 v2, v3
    s_mov_b64 exec, -1
    s_add_u32 s48, s48, 4
    s_waitcnt lgkmcnt(1)
    v_mfma_f32_32x32x16_bf16 v[64:79], v[52:55], v[44:47], v[64:79]
    ds_read_b128 v[24:27], v17 offset:41088
    ds_read_b64_tr_b16 v[32:33], v18 offset:41088
    ds_read_b64_tr_b16 v[34:35], v18 offset:41856
    v_mfma_f32_32x32x16_bf16 v[112:127], v[52:55], v[48:51], v[112:127]
    ds_read_b128 v[28:31], v17 offset:43136
    ds_read_b64_tr_b16 v[36:37], v18 offset:41120
    ds_read_b64_tr_b16 v[38:39], v18 offset:41888
    v_mfma_f32_32x32x16_bf16 v[80:95], v[56:59], v[44:47], v[80:95]
    ds_read_b64_tr_b16 v[40:41], v18 offset:41152
    ds_read_b64_tr_b16 v[42:43], v18 offset:41920
    v_mfma_f32_32x32x16_bf16 v[128:143], v[56:59], v[48:51], v[128:143]
    v_mfma_f32_32x32x16_bf16 v[96:111], v[60:63], v[44:47], v[96:111]
    v_mfma_f32_32x32x16_bf16 v[144:159], v[60:63], v[48:51], v[144:159]
f1jn_50:
    s_waitcnt lgkmcnt(0)
    v_mfma_f32_32x32x16_bf16 v[64:79], v[32:35], v[24:27], v[64:79]
    ds_read_b128 v[44:47], v17 offset:42112
    ds_read_b64_tr_b16 v[52:53], v18 offset:44160
    ds_read_b64_tr_b16 v[54:55], v18 offset:44928
    ds_read_b32 v4, v2
    v_mfma_f32_32x32x16_bf16 v[112:127], v[32:35], v[28:31], v[112:127]
    ds_read_b128 v[48:51], v17 offset:44160
    ds_read_b64_tr_b16 v[56:57], v18 offset:44192
    ds_read_b64_tr_b16 v[58:59], v18 offset:44960
    v_mfma_f32_32x32x16_bf16 v[80:95], v[36:39], v[24:27], v[80:95]
    ds_read_b64_tr_b16 v[60:61], v18 offset:44224
    ds_read_b64_tr_b16 v[62:63], v18 offset:44992
    v_mfma_f32_32x32x16_bf16 v[128:143], v[36:39], v[28:31], v[128:143]
    v_mfma_f32_32x32x16_bf16 v[96:111], v[40:43], v[24:27], v[96:111]
    s_waitcnt lgkmcnt(5)
    s_setprio 3
    v_readfirstlane_b32 s49, v4
    s_setprio 0
    s_cmp_ge_u32 s49, s48
    s_cbranch_scc1 chk_51
poll_52:
    ds_read_b32 v4, v2
    s_waitcnt lgkmcnt(0)
    v_readfirstlane_b32 s49, v4
    s_cmp_ge_u32 s49, s48
    s_cbranch_scc1 polldone_53
    s_sleep 1
    s_branch poll_52
polldone_53:
chk_51:
    s_cmp_ge_u32 s55, 14
    s_cbranch_scc1 f1nd_54
    v_mfma_f32_32x32x16_bf16 v[144:159], v[40:43], v[28:31], v[144:159]
    s_waitcnt vmcnt(5)
    s_mov_b64 exec, 1
    ds_add_u32 v2, v3
    s_mov_b64 exec, -1
    s_add_u32 s48, s48, 4
    s_waitcnt lgkmcnt(1)
    v_mfma_f32_32x32x16_bf16 v[64:79], v[52:55], v[44:47], v[64:79]
    ds_read_b128 v[24:27], v19 offset:0
    ds_read_b64_tr_b16 v[32:33], v20 offset:0
    ds_read_b64_tr_b16 v[34:35], v20 offset:768
    s_add_u32 m0, s53, 20544
    s_add_u32 s60, s60, 1
    buffer_load_dwordx4 v11, s[8:11], s51 offen sc1 lds
    v_mfma_f32_32x32x16_bf16 v[112:127], v[52:55], v[48:51], v[112:127]
    ds_read_b128 v[28:31], v19 offset:2048
    ds_read_b64_tr_b16 v[36:37], v20 offset:32
    ds_read_b64_tr_b16 v[38:39], v20 offset:800
    buffer_load_dwordx4 v11, s[8:11], s51 offen offset:1024 sc1 lds
    v_mfma_f32_32x32x16_bf16 v[80:95], v[56:59], v[44:47], v[80:95]
    ds_read_b64_tr_b16 v[40:41], v20 offset:64
    ds_read_b64_tr_b16 v[42:43], v20 offset:832
    s_add_u32 m0, s54, 20544
    s_add_u32 s51, s51, 2048
    buffer_load_dwordx4 v14, s[12:15], s52 offen offset:0 lds
    v_mfma_f32_32x32x16_bf16 v[128:143], v[56:59], v[48:51], v[128:143]
    buffer_load_dwordx4 v15, s[12:15], s52 offen offset:1024 lds
    v_mfma_f32_32x32x16_bf16 v[96:111], v[60:63], v[44:47], v[96:111]
    buffer_load_dwordx4 v16, s[12:15], s52 offen offset:2048 lds
    v_mfma_f32_32x32x16_bf16 v[144:159], v[60:63], v[48:51], v[144:159]
    s_add_u32 s52, s52, 98304
    s_cmp_eq_u32 s60, 20
    s_cselect_b32 s59, 40960, 0
    s_cselect_b32 s58, 1966080, 0
    s_sub_u32 s51, s51, s59
    s_sub_u32 s52, s52, s58
    s_branch f1jn_55
f1nd_54:
    v_mfma_f32_32x32x16_bf16 v[144:159], v[40:43], v[28:31], v[144:159]
    s_waitcnt vmcnt(0)
    s_mov_b64 exec, 1
    ds_add_u32 v2, v3
    s_mov_b64 exec, -1
    s_add_u32 s48, s48, 4
    s_waitcnt lgkmcnt(1)
    v_mfma_f32_32x32x16_bf16 v[64:79], v[52:55], v[44:47], v[64:79]
    ds_read_b128 v[24:27], v19 offset:0
    ds_read_b64_tr_b16 v[32:33], v20 offset:0
    ds_read_b64_tr_b16 v[34:35], v20 offset:768
    v_mfma_f32_32x32x16_bf16 v[112:127], v[52:55], v[48:51], v[112:127]
    ds_read_b128 v[28:31], v19 offset:2048
    ds_read_b64_tr_b16 v[36:37], v20 offset:32
    ds_read_b64_tr_b16 v[38:39], v20 offset:800
    v_mfma_f32_32x32x16_bf16 v[80:95], v[56:59], v[44:47], v[80:95]
    ds_read_b64_tr_b16 v[40:41], v20 offset:64
    ds_read_b64_tr_b16 v[42:43], v20 offset:832
    v_mfma_f32_32x32x16_bf16 v[128:143], v[56:59], v[48:51], v[128:143]
    v_mfma_f32_32x32x16_bf16 v[96:111], v[60:63], v[44:47], v[96:111]
    v_mfma_f32_32x32x16_bf16 v[144:159], v[60:63], v[48:51], v[144:159]
f1jn_55:
    s_waitcnt lgkmcnt(0)
    v_mfma_f32_32x32x16_bf16 v[64:79], v[32:35], v[24:27], v[64:79]
    ds_read_b128 v[44:47], v19 offset:1024
    ds_read_b64_tr_b16 v[52:53], v20 offset:3072
    ds_read_b64_tr_b16 v[54:55], v20 offset:3840
    ds_read_b32 v4, v2
    v_mfma_f32_32x32x16_bf16 v[112:127], v[32:35], v[28:31], v[112:127]
    ds_read_b128 v[48:51], v19 offset:3072
    ds_read_b64_tr_b16 v[56:57], v20 offset:3104
    ds_read_b64_tr_b16 v[58:59], v20 offset:3872
    v_mfma_f32_32x32x16_bf16 v[80:95], v[36:39], v[24:27], v[80:95]
    ds_read_b64_tr_b16 v[60:61], v20 offset:3136
    ds_read_b64_tr_b16 v[62:63], v20 offset:3904
    v_mfma_f32_32x32x16_bf16 v[128:143], v[36:39], v[28:31], v[128:143]
    v_mfma_f32_32x32x16_bf16 v[96:111], v[40:43], v[24:27], v[96:111]
    s_waitcnt lgkmcnt(5)
    s_setprio 3
    v_readfirstlane_b32 s49, v4
    s_setprio 0
    s_cmp_ge_u32 s49, s48
    s_cbranch_scc1 chk_56
poll_57:
    ds_read_b32 v4, v2
    s_waitcnt lgkmcnt(0)
    v_readfirstlane_b32 s49, v4
    s_cmp_ge_u32 s49, s48
    s_cbranch_scc1 polldone_58
    s_sleep 1
    s_branch poll_57
polldone_58:
chk_56:
    s_cmp_ge_u32 s55, 13
    s_cbranch_scc1 f1nd_59
    v_mfma_f32_32x32x16_bf16 v[144:159], v[40:43], v[28:31], v[144:159]
    s_waitcnt vmcnt(5)
    s_mov_b64 exec, 1
    ds_add_u32 v2, v3
    s_mov_b64 exec, -1
    s_add_u32 s48, s48, 4
    s_waitcnt lgkmcnt(1)
    v_mfma_f32_32x32x16_bf16 v[64:79], v[52:55], v[44:47], v[64:79]
    ds_read_b128 v[24:27], v19 offset:20544
    ds_read_b64_tr_b16 v[32:33], v20 offset:20544
    ds_read_b64_tr_b16 v[34:35], v20 offset:21312
    s_add_u32 m0, s53, 41088
    s_add_u32 s60, s60, 1
    buffer_load_dwordx4 v11, s[8:11], s51 offen sc1 lds
    v_mfma_f32_32x32x16_bf16 v[112:127], v[52:55], v[48:51], v[112:127]
    ds_read_b128 v[28:31], v19 offset:22592
    ds_read_b64_tr_b16 v[36:37], v20 offset:20576
    ds_read_b64_tr_b16 v[38:39], v20 offset:21344
    buffer_load_dwordx4 v11, s[8:11], s51 offen offset:1024 sc1 lds
    v_mfma_f32_32x32x16_bf16 v[80:95], v[56:59], v[44:47], v[80:95]
    ds_read_b64_tr_b16 v[40:41], v20 offset:20608
    ds_read_b64_tr_b16 v[42:43], v20 offset:21376
    s_add_u32 m0, s54, 41088
    s_add_u32 s51, s51, 2048
    buffer_load_dwordx4 v14, s[12:15], s52 offen offset:0 lds
    v_mfma_f32_32x32x16_bf16 v[128:143], v[56:59], v[48:51], v[128:143]
    buffer_load_dwordx4 v15, s[12:15], s52 offen offset:1024 lds
    v_mfma_f32_32x32x16_bf16 v[96:111], v[60:63], v[44:47], v[96:111]
    buffer_load_dwordx4 v16, s[12:15], s52 offen offset:2048 lds
    v_mfma_f32_32x32x16_bf16 v[144:159], v[60:63], v[48:51], v[144:159]
    s_add_u32 s52, s52, 98304
    s_cmp_eq_u32 s60, 20
    s_cselect_b32 s59, 40960, 0
    s_cselect_b32 s58, 1966080, 0
    s_sub_u32 s51, s51, s59
    s_sub_u32 s52, s52, s58
    s_branch f1jn_60
f1nd_59:
    v_mfma_f32_32x32x16_bf16 v[144:159], v[40:43], v[28:31], v[144:159]
    s_waitcnt vmcnt(0)
    s_mov_b64 exec, 1
    ds_add_u32 v2, v3
    s_mov_b64 exec, -1
    s_add_u32 s48, s48, 4
    s_waitcnt lgkmcnt(1)
    v_mfma_f32_32x32x16_bf16 v[64:79], v[52:55], v[44:47], v[64:79]
    ds_read_b128 v[24:27], v19 offset:20544
    ds_read_b64_tr_b16 v[32:33], v20 offset:20544
    ds_read_b64_tr_b16 v[34:35], v20 offset:21312
    v_mfma_f32_32x32x16_bf16 v[112:127], v[52:55], v[48:51], v[112:127]
    ds_read_b128 v[28:31], v19 offset:22592
    ds_read_b64_tr_b16 v[36:37], v20 offset:20576
    ds_read_b64_tr_b16 v[38:39], v20 offset:21344
    v_mfma_f32_32x32x16_bf16 v[80:95], v[56:59], v[44:47], v[80:95]
    ds_read_b64_tr_b16 v[40:41], v20 offset:20608
    ds_read_b64_tr_b16 v[42:43], v20 offset:21376
    v_mfma_f32_32x32x16_bf16 v[128:143], v[56:59], v[48:51], v[128:143]
    v_mfma_f32_32x32x16_bf16 v[96:111], v[60:63], v[44:47], v[96:111]
    v_mfma_f32_32x32x16_bf16 v[144:159], v[60:63], v[48:51], v[144:159]
f1jn_60:
    s_waitcnt lgkmcnt(0)
    v_mfma_f32_32x32x16_bf16 v[64:79], v[32:35], v[24:27], v[64:79]
    ds_read_b128 v[44:47], v19 offset:21568
    ds_read_b64_tr_b16 v[52:53], v20 offset:23616
    ds_read_b64_tr_b16 v[54:55], v20 offset:24384
    ds_read_b32 v4, v2
    v_mfma_f32_32x32x16_bf16 v[112:127], v[32:35], v[28:31], v[112:127]
    ds_read_b128 v[48:51], v19 offset:23616
    ds_read_b64_tr_b16 v[56:57], v20 offset:23648
    ds_read_b64_tr_b16 v[58:59], v20 offset:24416
    v_mfma_f32_32x32x16_bf16 v[80:95], v[36:39], v[24:27], v[80:95]
    ds_read_b64_tr_b16 v[60:61], v20 offset:23680
    ds_read_b64_tr_b16 v[62:63], v20 offset:24448
    v_mfma_f32_32x32x16_bf16 v[128:143], v[36:39], v[28:31], v[128:143]
    v_mfma_f32_32x32x16_bf16 v[96:111], v[40:43], v[24:27], v[96:111]
    s_waitcnt lgkmcnt(5)
    s_setprio 3
    v_readfirstlane_b32 s49, v4
    s_setprio 0
    s_cmp_ge_u32 s49, s48
    s_cbranch_scc1 chk_61
poll_62:
    ds_read_b32 v4, v2
    s_waitcnt lgkmcnt(0)
    v_readfirstlane_b32 s49, v4
    s_cmp_ge_u32 s49, s48
    s_cbranch_scc1 polldone_63
    s_sleep 1
    s_branch poll_62
polldone_63:
chk_61:
    s_cmp_ge_u32 s55, 12
    s_cbranch_scc1 f1nd_64
    v_mfma_f32_32x32x16_bf16 v[144:159], v[40:43], v[28:31], v[144:159]
    s_waitcnt vmcnt(5)
    s_mov_b64 exec, 1
    ds_add_u32 v2, v3
    s_mov_b64 exec, -1
    s_add_u32 s48, s48, 4
    s_waitcnt lgkmcnt(1)
    v_mfma_f32_32x32x16_bf16 v[64:79], v[52:55], v[44:47], v[64:79]
    ds_read_b128 v[24:27], v17 offset:0
    ds_read_b64_tr_b16 v[32:33], v18 offset:0
    ds_read_b64_tr_b16 v[34:35], v18 offset:768
    s_add_u32 m0, s53, 61632
    s_add_u32 s60, s60, 1
    buffer_load_dwordx4 v11, s[8:11], s51 offen sc1 lds
    v_mfma_f32_32x32x16_bf16 v[112:127], v[52:55], v[48:51], v[112:127]
    ds_read_b128 v[28:31], v17 offset:2048
    ds_read_b64_tr_b16 v[36:37], v18 offset:32
    ds_read_b64_tr_b16 v[38:39], v18 offset:800
    buffer_load_dwordx4 v11, s[8:11], s51 offen offset:1024 sc1 lds
    v_mfma_f32_32x32x16_bf16 v[80:95], v[56:59], v[44:47], v[80:95]
    ds_read_b64_tr_b16 v[40:41], v18 offset:64
    ds_read_b64_tr_b16 v[42:43], v18 offset:832
    s_add_u32 m0, s54, 61632
    s_add_u32 s51, s51, 2048
    buffer_load_dwordx4 v14, s[12:15], s52 offen offset:0 lds
    v_mfma_f32_32x32x16_bf16 v[128:143], v[56:59], v[48:51], v[128:143]
    buffer_load_dwordx4 v15, s[12:15], s52 offen offset:1024 lds
    v_mfma_f32_32x32x16_bf16 v[96:111], v[60:63], v[44:47], v[96:111]
    buffer_load_dwordx4 v16, s[12:15], s52 offen offset:2048 lds
    v_mfma_f32_32x32x16_bf16 v[144:159], v[60:63], v[48:51], v[144:159]
    s_add_u32 s52, s52, 98304
    s_cmp_eq_u32 s60, 20
    s_cselect_b32 s59, 40960, 0
    s_cselect_b32 s58, 1966080, 0
    s_sub_u32 s51, s51, s59
    s_sub_u32 s52, s52, s58
    s_branch f1jn_65
f1nd_64:
    v_mfma_f32_32x32x16_bf16 v[144:159], v[40:43], v[28:31], v[144:159]
    s_waitcnt vmcnt(0)
    s_mov_b64 exec, 1
    ds_add_u32 v2, v3
    s_mov_b64 exec, -1
    s_add_u32 s48, s48, 4
    s_waitcnt lgkmcnt(1)
    v_mfma_f32_32x32x16_bf16 v[64:79], v[52:55], v[44:47], v[64:79]
    ds_read_b128 v[24:27], v17 offset:0
    ds_read_b64_tr_b16 v[32:33], v18 offset:0
    ds_read_b64_tr_b16 v[34:35], v18 offset:768
    v_mfma_f32_32x32x16_bf16 v[112:127], v[52:55], v[48:51], v[112:127]
    ds_read_b128 v[28:31], v17 offset:2048
    ds_read_b64_tr_b16 v[36:37], v18 offset:32
    ds_read_b64_tr_b16 v[38:39], v18 offset:800
    v_mfma_f32_32x32x16_bf16 v[80:95], v[56:59], v[44:47], v[80:95]
    ds_read_b64_tr_b16 v[40:41], v18 offset:64
    ds_read_b64_tr_b16 v[42:43], v18 offset:832
    v_mfma_f32_32x32x16_bf16 v[128:143], v[56:59], v[48:51], v[128:143]
    v_mfma_f32_32x32x16_bf16 v[96:111], v[60:63], v[44:47], v[96:111]
    v_mfma_f32_32x32x16_bf16 v[144:159], v[60:63], v[48:51], v[144:159]
f1jn_65:
    s_add_u32 s55, s55, 5
    s_cmp_lt_u32 s55, 20
    s_cbranch_scc1 zf1_top
    s_setprio 3
    v_mul_f32 v12, v12, v12
    v_mul_f32 v13, v13, v13
    s_lshl_b32 s58, s21, 2
    s_and_b32 s59, s50, 1
    s_lshl_b32 s59, s59, 1
    s_add_u32 s58, s58, s59
    s_mul_i32 s51, s58, 98304
    s_mul_i32 s58, s22, 6
    s_lshr_b32 s59, s50, 1
    s_mul_i32 s59, s59, 3
    s_add_u32 s58, s58, s59
    s_lshl_b32 s58, s58, 10
    s_add_u32 s51, s51, s58
    s_add_u32 s51, s51, 20971520
    s_add_u32 s52, s51, 98304
    s_waitcnt lgkmcnt(0)
    s_nop 4
    v_mul_f32 v64, v64, v12
    v_mul_f32 v65, v65, v12
    v_mul_f32 v66, v66, v12
    v_mul_f32 v67, v67, v12
    v_mul_f32 v68, v68, v12
    v_mul_f32 v69, v69, v12
    v_mul_f32 v70, v70, v12
    v_mul_f32 v71, v71, v12
    v_mul_f32 v64, v64, v72
    v_mul_f32 v65, v65, v73
    v_mul_f32 v66, v66, v74
    v_mul_f32 v67, v67, v75
    v_mul_f32 v68, v68, v76
    v_mul_f32 v69, v69, v77
    v_mul_f32 v70, v70, v78
    v_mul_f32 v71, v71, v79
    v_cvt_pk_bf16_f32 v64, v64, v65
    v_cvt_pk_bf16_f32 v65, v66, v67
    v_cvt_pk_bf16_f32 v66, v68, v69
    v_cvt_pk_bf16_f32 v67, v70, v71
    buffer_store_dwordx4 v[64:67], v11, s[8:11], s51 offen offset:0 sc1
    v_mul_f32 v112, v112, v13
    v_mul_f32 v113, v113, v13
    v_mul_f32 v114, v114, v13
    v_mul_f32 v115, v115, v13
    v_mul_f32 v116, v116, v13
    v_mul_f32 v117, v117, v13
    v_mul_f32 v118, v118, v13
    v_mul_f32 v119, v119, v13
    v_mul_f32 v112, v112, v120
    v_mul_f32 v113, v113, v121
    v_mul_f32 v114, v114, v122
    v_mul_f32 v115, v115, v123
    v_mul_f32 v116, v116, v124
    v_mul_f32 v117, v117, v125
    v_mul_f32 v118, v118, v126
    v_mul_f32 v119, v119, v127
    v_cvt_pk_bf16_f32 v112, v112, v113
    v_cvt_pk_bf16_f32 v113, v114, v115
    v_cvt_pk_bf16_f32 v114, v116, v117
    v_cvt_pk_bf16_f32 v115, v118, v119
    buffer_store_dwordx4 v[112:115], v11, s[8:11], s52 offen offset:0 sc1
    v_mul_f32 v80, v80, v12
    v_mul_f32 v81, v81, v12
    v_mul_f32 v82, v82, v12
    v_mul_f32 v83, v83, v12
    v_mul_f32 v84, v84, v12
    v_mul_f32 v85, v85, v12
    v_mul_f32 v86, v86, v12
    v_mul_f32 v87, v87, v12
    v_mul_f32 v80, v80, v88
    v_mul_f32 v81, v81, v89
    v_mul_f32 v82, v82, v90
    v_mul_f32 v83, v83, v91
    v_mul_f32 v84, v84, v92
    v_mul_f32 v85, v85, v93
    v_mul_f32 v86, v86, v94
    v_mul_f32 v87, v87, v95
    v_cvt_pk_bf16_f32 v80, v80, v81
    v_cvt_pk_bf16_f32 v81, v82, v83
    v_cvt_pk_bf16_f32 v82, v84, v85
    v_cvt_pk_bf16_f32 v83, v86, v87
    buffer_store_dwordx4 v[80:83], v11, s[8:11], s51 offen offset:1024 sc1
    v_mul_f32 v128, v128, v13
    v_mul_f32 v129, v129, v13
    v_mul_f32 v130, v130, v13
    v_mul_f32 v131, v131, v13
    v_mul_f32 v132, v132, v13
    v_mul_f32 v133, v133, v13
    v_mul_f32 v134, v134, v13
    v_mul_f32 v135, v135, v13
    v_mul_f32 v128, v128, v136
    v_mul_f32 v129, v129, v137
    v_mul_f32 v130, v130, v138
    v_mul_f32 v131, v131, v139
    v_mul_f32 v132, v132, v140
    v_mul_f32 v133, v133, v141
    v_mul_f32 v134, v134, v142
    v_mul_f32 v135, v135, v143
    v_cvt_pk_bf16_f32 v128, v128, v129
    v_cvt_pk_bf16_f32 v129, v130, v131
    v_cvt_pk_bf16_f32 v130, v132, v133
    v_cvt_pk_bf16_f32 v131, v134, v135
    buffer_store_dwordx4 v[128:131], v11, s[8:11], s52 offen offset:1024 sc1
    v_mul_f32 v96, v96, v12
    v_mul_f32 v97, v97, v12
    v_mul_f32 v98, v98, v12
    v_mul_f32 v99, v99, v12
    v_mul_f32 v100, v100, v12
    v_mul_f32 v101, v101, v12
    v_mul_f32 v102, v102, v12
    v_mul_f32 v103, v103, v12
    v_mul_f32 v96, v96, v104
    v_mul_f32 v97, v97, v105
    v_mul_f32 v98, v98, v106
    v_mul_f32 v99, v99, v107
    v_mul_f32 v100, v100, v108
    v_mul_f32 v101, v101, v109
    v_mul_f32 v102, v102, v110
    v_mul_f32 v103, v103, v111
    v_cvt_pk_bf16_f32 v96, v96, v97
    v_cvt_pk_bf16_f32 v97, v98, v99
    v_cvt_pk_bf16_f32 v98, v100, v101
    v_cvt_pk_bf16_f32 v99, v102, v103
    buffer_store_dwordx4 v[96:99], v11, s[8:11], s51 offen offset:2048 sc1
    v_mul_f32 v144, v144, v13
    v_mul_f32 v145, v145, v13
    v_mul_f32 v146, v146, v13
    v_mul_f32 v147, v147, v13
    v_mul_f32 v148, v148, v13
    v_mul_f32 v149, v149, v13
    v_mul_f32 v150, v150, v13
    v_mul_f32 v151, v151, v13
    v_mul_f32 v144, v144, v152
    v_mul_f32 v145, v145, v153
    v_mul_f32 v146, v146, v154
    v_mul_f32 v147, v147, v155
    v_mul_f32 v148, v148, v156
    v_mul_f32 v149, v149, v157
    v_mul_f32 v150, v150, v158
    v_mul_f32 v151, v151, v159
    v_cvt_pk_bf16_f32 v144, v144, v145
    v_cvt_pk_bf16_f32 v145, v146, v147
    v_cvt_pk_bf16_f32 v146, v148, v149
    v_cvt_pk_bf16_f32 v147, v150, v151
    buffer_store_dwordx4 v[144:147], v11, s[8:11], s52 offen offset:2048 sc1
    s_mul_i32 s68, s61, 196608
    s_mul_i32 s72, s50, 24576
    s_add_u32 s68, s68, s72
    s_add_u32 s68, s68, 20971520
    s_mul_i32 s70, s50, 491520
    s_mul_i32 s72, s62, 160
    s_add_u32 s70, s70, s72
    s_mul_i32 s71, s50, 30432
    s_add_u32 s71, s71, 41984
    s_and_b32 s74, s61, 7
    s_and_b32 s73, s62, 3
    s_lshl_b32 s73, s73, 1
    s_add_u32 s74, s74, s73
    s_mul_i32 s74, s74, 3
    s_cmp_ge_u32 s74, 24
    s_cselect_b32 s73, 24, 0
    s_sub_u32 s74, s74, s73
    s_mov_b32 s75, s74
    s_lshl_b32 s73, s74, 10
    s_add_u32 s68, s68, s73
    s_add_u32 s69, s68, 98304
    s_mul_i32 s73, s74, 20480
    s_add_u32 s70, s70, s73
    v_lshlrev_b32_e64 v9, 4, v1
    v_bfe_u32 v132, v1, 2, 2
    v_mul_u32_u24 v134, 192, v132
    v_and_b32_e64 v132, 3, v1
    v_lshl_add_u32 v134, v132, 3, v134
    v_bfe_u32 v132, v1, 4, 1
    v_lshl_add_u32 v134, v132, 5, v134
    v_add_u32 v134, s71, v134
    v_lshrrev_b32 v133, 5, v1
    v_mul_u32_u24 v132, 768, v133
    v_add_u32_e64 v10, v134, v132
    v_mul_u32_u24 v132, 7680, v133
    v_add_u32_e64 v11, v134, v132
    v_mul_u32_u24 v132, 27648, v133
    v_subrev_u32 v15, 27648, v10
    v_sub_u32 v164, v11, v132
    v_sub_u32 v165, v10, v132
    v_and_b32 v132, 31, v1
    v_lshlrev_b32 v132, 3, v132
    v_lshl_add_u32 v14, v133, 9, v132
    v_lshrrev_b32 v132, 2, v1
    s_lshl_b32 s72, s50, 4
    v_add_u32 v132, s72, v132
    v_and_b32 v133, 3, v1
    v_mul_u32_u24 v12, 336, v132
    v_lshl_add_u32 v12, v133, 4, v12
    v_add_u32 v12, 41984, v12
    v_mul_u32_u24 v13, 1280, v132
    v_lshl_add_u32 v13, v133, 3, v13
    s_mul_i32 s77, s50, 204800
    s_mul_i32 s72, s62, 160
    s_add_u32 s77, s77, s72
    s_lshl_b32 s40, s21, 4
    s_add_u32 s40, s40, s22
    s_lshl_b32 s40, s40, 7
    s_add_u32 s40, s40, 46202880
    v_mov_b32 v150, s84
    v_lshlrev_b32 v151, 2, v1
    s_waitcnt vmcnt(0)
    s_mov_b64 exec, 1
    ds_add_u32 v2, v3
    s_mov_b64 exec, -1
    s_add_u32 s48, s48, 4
poll_66:
    ds_read_b32 v4, v2
    s_waitcnt lgkmcnt(0)
    v_readfirstlane_b32 s49, v4
    s_cmp_ge_u32 s49, s48
    s_cbranch_scc1 polldone_67
    s_sleep 1
    s_branch poll_66
polldone_67:
    s_cmp_lg_u32 s50, 0
    s_cbranch_scc1 hp_68
    s_mov_b32 exec_hi, 0
    buffer_store_dword v150, v151, s[8:11], s40 offen sc1
    s_mov_b32 exec_hi, -1
    s_lshr_b32 s40, s61, 1
    s_lshl_b32 s40, s40, 11
    s_add_u32 s40, s40, 46202880
    s_add_u32 m0, s71, 9216
    s_add_u32 s74, s74, 1
    buffer_load_dwordx4 v6, s[64:67], s70 offen offset:0 lds
    buffer_load_dwordx4 v7, s[64:67], s70 offen offset:1024 lds
    buffer_load_dwordx4 v8, s[64:67], s70 offen offset:2048 lds
    s_cmp_eq_u32 s74, 24
    s_cselect_b32 s73, 491520, 0
    s_add_u32 s70, s70, 20480
    s_sub_u32 s70, s70, s73
    s_add_u32 m0, s71, 12288
    s_add_u32 s74, s74, 1
    buffer_load_dwordx4 v6, s[64:67], s70 offen offset:0 lds
    buffer_load_dwordx4 v7, s[64:67], s70 offen offset:1024 lds
    buffer_load_dwordx4 v8, s[64:67], s70 offen offset:2048 lds
    s_cmp_eq_u32 s74, 24
    s_cselect_b32 s73, 491520, 0
    s_add_u32 s70, s70, 20480
    s_sub_u32 s70, s70, s73
    s_add_u32 m0, s71, 15360
    s_add_u32 s74, s74, 1
    buffer_load_dwordx4 v6, s[64:67], s70 offen offset:0 lds
    buffer_load_dwordx4 v7, s[64:67], s70 offen offset:1024 lds
    buffer_load_dwordx4 v8, s[64:67], s70 offen offset:2048 lds
    s_cmp_eq_u32 s74, 24
    s_cselect_b32 s73, 491520, 0
    s_add_u32 s70, s70, 20480
    s_sub_u32 s70, s70, s73
    s_add_u32 m0, s71, 18432
    s_add_u32 s74, s74, 1
    buffer_load_dwordx4 v6, s[64:67], s70 offen offset:0 lds
    buffer_load_dwordx4 v7, s[64:67], s70 offen offset:1024 lds
    buffer_load_dwordx4 v8, s[64:67], s70 offen offset:2048 lds
    s_cmp_eq_u32 s74, 24
    s_cselect_b32 s73, 491520, 0
    s_add_u32 s70, s70, 20480
    s_sub_u32 s70, s70, s73
    s_add_u32 m0, s71, 21504
    s_add_u32 s74, s74, 1
    buffer_load_dwordx4 v6, s[64:67], s70 offen offset:0 lds
    buffer_load_dwordx4 v7, s[64:67], s70 offen offset:1024 lds
    buffer_load_dwordx4 v8, s[64:67], s70 offen offset:2048 lds
    s_cmp_eq_u32 s74, 24
    s_cselect_b32 s73, 491520, 0
    s_add_u32 s70, s70, 20480
    s_sub_u32 s70, s70, s73
    s_add_u32 m0, s71, 24576
    s_add_u32 s74, s74, 1
    buffer_load_dwordx4 v6, s[64:67], s70 offen offset:0 lds
    buffer_load_dwordx4 v7, s[64:67], s70 offen offset:1024 lds
    buffer_load_dwordx4 v8, s[64:67], s70 offen offset:2048 lds
    s_cmp_eq_u32 s74, 24
    s_cselect_b32 s73, 491520, 0
    s_add_u32 s70, s70, 20480
    s_sub_u32 s70, s70, s73
    s_add_u32 m0, s71, 0
    s_add_u32 s74, s74, 1
    buffer_load_dwordx4 v6, s[64:67], s70 offen offset:0 lds
    buffer_load_dwordx4 v7, s[64:67], s70 offen offset:1024 lds
    buffer_load_dwordx4 v8, s[64:67], s70 offen offset:2048 lds
    s_cmp_eq_u32 s74, 24
    s_cselect_b32 s73, 491520, 0
    s_add_u32 s70, s70, 20480
    s_sub_u32 s70, s70, s73
    s_add_u32 m0, s71, 3072
    s_add_u32 s74, s74, 1
    buffer_load_dwordx4 v6, s[64:67], s70 offen offset:0 lds
    buffer_load_dwordx4 v7, s[64:67], s70 offen offset:1024 lds
    buffer_load_dwordx4 v8, s[64:67], s70 offen offset:2048 lds
    s_cmp_eq_u32 s74, 24
    s_cselect_b32 s73, 491520, 0
    s_add_u32 s70, s70, 20480
    s_sub_u32 s70, s70, s73
    s_add_u32 m0, s71, 6144
    s_add_u32 s74, s74, 1
    buffer_load_dwordx4 v6, s[64:67], s70 offen offset:0 lds
    buffer_load_dwordx4 v7, s[64:67], s70 offen offset:1024 lds
    buffer_load_dwordx4 v8, s[64:67], s70 offen offset:2048 lds
    s_cmp_eq_u32 s74, 24
    s_cselect_b32 s73, 491520, 0
    s_add_u32 s70, s70, 20480
    s_sub_u32 s70, s70, s73
    s_mov_b32 s41, 0
    s_mov_b64 exec, 0xffff
fpoll_70:
    buffer_load_dword v4, v5, s[8:11], s40 offen sc1
    s_waitcnt vmcnt(0)
fchk_72:
    v_cmp_ne_u32 vcc, s84, v4
    s_add_u32 s41, s41, 1
    s_nop 3
    s_cbranch_vccz fdone_71
    s_sleep 8
    s_cmp_lt_u32 s41, 0x40000
    s_cbranch_scc1 fpoll_70
fdone_71:
    s_mov_b64 exec, -1
    s_branch hp_69
hp_68:
    s_add_u32 m0, s71, 9216
    s_add_u32 s74, s74, 1
    buffer_load_dwordx4 v6, s[64:67], s70 offen offset:0 lds
    buffer_load_dwordx4 v7, s[64:67], s70 offen offset:1024 lds
    buffer_load_dwordx4 v8, s[64:67], s70 offen offset:2048 lds
    s_cmp_eq_u32 s74, 24
    s_cselect_b32 s73, 491520, 0
    s_add_u32 s70, s70, 20480
    s_sub_u32 s70, s70, s73
    s_add_u32 m0, s71, 12288
    s_add_u32 s74, s74, 1
    buffer_load_dwordx4 v6, s[64:67], s70 offen offset:0 lds
    buffer_load_dwordx4 v7, s[64:67], s70 offen offset:1024 lds
    buffer_load_dwordx4 v8, s[64:67], s70 offen offset:2048 lds
    s_cmp_eq_u32 s74, 24
    s_cselect_b32 s73, 491520, 0
    s_add_u32 s70, s70, 20480
    s_sub_u32 s70, s70, s73
    s_add_u32 m0, s71, 15360
    s_add_u32 s74, s74, 1
    buffer_load_dwordx4 v6, s[64:67], s70 offen offset:0 lds
    buffer_load_dwordx4 v7, s[64:67], s70 offen offset:1024 lds
    buffer_load_dwordx4 v8, s[64:67], s70 offen offset:2048 lds
    s_cmp_eq_u32 s74, 24
    s_cselect_b32 s73, 491520, 0
    s_add_u32 s70, s70, 20480
    s_sub_u32 s70, s70, s73
    s_add_u32 m0, s71, 18432
    s_add_u32 s74, s74, 1
    buffer_load_dwordx4 v6, s[64:67], s70 offen offset:0 lds
    buffer_load_dwordx4 v7, s[64:67], s70 offen offset:1024 lds
    buffer_load_dwordx4 v8, s[64:67], s70 offen offset:2048 lds
    s_cmp_eq_u32 s74, 24
    s_cselect_b32 s73, 491520, 0
    s_add_u32 s70, s70, 20480
    s_sub_u32 s70, s70, s73
    s_add_u32 m0, s71, 21504
    s_add_u32 s74, s74, 1
    buffer_load_dwordx4 v6, s[64:67], s70 offen offset:0 lds
    buffer_load_dwordx4 v7, s[64:67], s70 offen offset:1024 lds
    buffer_load_dwordx4 v8, s[64:67], s70 offen offset:2048 lds
    s_cmp_eq_u32 s74, 24
    s_cselect_b32 s73, 491520, 0
    s_add_u32 s70, s70, 20480
    s_sub_u32 s70, s70, s73
    s_add_u32 m0, s71, 24576
    s_add_u32 s74, s74, 1
    buffer_load_dwordx4 v6, s[64:67], s70 offen offset:0 lds
    buffer_load_dwordx4 v7, s[64:67], s70 offen offset:1024 lds
    buffer_load_dwordx4 v8, s[64:67], s70 offen offset:2048 lds
    s_cmp_eq_u32 s74, 24
    s_cselect_b32 s73, 491520, 0
    s_add_u32 s70, s70, 20480
    s_sub_u32 s70, s70, s73
    s_add_u32 m0, s71, 0
    s_add_u32 s74, s74, 1
    buffer_load_dwordx4 v6, s[64:67], s70 offen offset:0 lds
    buffer_load_dwordx4 v7, s[64:67], s70 offen offset:1024 lds
    buffer_load_dwordx4 v8, s[64:67], s70 offen offset:2048 lds
    s_cmp_eq_u32 s74, 24
    s_cselect_b32 s73, 491520, 0
    s_add_u32 s70, s70, 20480
    s_sub_u32 s70, s70, s73
    s_add_u32 m0, s71, 3072
    s_add_u32 s74, s74, 1
    buffer_load_dwordx4 v6, s[64:67], s70 offen offset:0 lds
    buffer_load_dwordx4 v7, s[64:67], s70 offen offset:1024 lds
    buffer_load_dwordx4 v8, s[64:67], s70 offen offset:2048 lds
    s_cmp_eq_u32 s74, 24
    s_cselect_b32 s73, 491520, 0
    s_add_u32 s70, s70, 20480
    s_sub_u32 s70, s70, s73
    s_add_u32 m0, s71, 6144
    s_add_u32 s74, s74, 1
    buffer_load_dwordx4 v6, s[64:67], s70 offen offset:0 lds
    buffer_load_dwordx4 v7, s[64:67], s70 offen offset:1024 lds
    buffer_load_dwordx4 v8, s[64:67], s70 offen offset:2048 lds
    s_cmp_eq_u32 s74, 24
    s_cselect_b32 s73, 491520, 0
    s_add_u32 s70, s70, 20480
    s_sub_u32 s70, s70, s73
hp_69:
    s_mov_b64 exec, 1
    ds_add_u32 v2, v3
    s_mov_b64 exec, -1
    s_add_u32 s48, s48, 4
poll_73:
    ds_read_b32 v4, v2
    s_waitcnt lgkmcnt(0)
    v_readfirstlane_b32 s49, v4
    s_cmp_ge_u32 s49, s48
    s_cbranch_scc1 polldone_74
    s_sleep 1
    s_branch poll_73
polldone_74:
    buffer_load_dwordx4 v[112:115], v9, s[8:11], s68 offen sc1
    buffer_load_dwordx4 v[116:119], v9, s[8:11], s69 offen sc1
    s_add_u32 s75, s75, 1
    s_cmp_eq_u32 s75, 24
    s_cselect_b32 s73, 24576, 0
    s_sub_u32 s73, 1024, s73
    s_add_u32 s68, s68, s73
    s_add_u32 s69, s69, s73
    buffer_load_dwordx4 v[120:123], v9, s[8:11], s68 offen sc1
    buffer_load_dwordx4 v[124:127], v9, s[8:11], s69 offen sc1
    s_add_u32 s75, s75, 1
    s_cmp_eq_u32 s75, 24
    s_cselect_b32 s73, 24576, 0
    s_sub_u32 s73, 1024, s73
    s_add_u32 s68, s68, s73
    s_add_u32 s69, s69, s73
    buffer_load_dwordx4 v[128:131], v9, s[8:11], s68 offen sc1
    buffer_load_dwordx4 v[132:135], v9, s[8:11], s69 offen sc1
    s_add_u32 s75, s75, 1
    s_cmp_eq_u32 s75, 24
    s_cselect_b32 s73, 24576, 0
    s_sub_u32 s73, 1024, s73
    s_add_u32 s68, s68, s73
    s_add_u32 s69, s69, s73
    buffer_load_dwordx4 v[136:139], v9, s[8:11], s68 offen sc1
    buffer_load_dwordx4 v[140:143], v9, s[8:11], s69 offen sc1
    s_add_u32 s75, s75, 1
    s_cmp_eq_u32 s75, 24
    s_cselect_b32 s73, 24576, 0
    s_sub_u32 s73, 1024, s73
    s_add_u32 s68, s68, s73
    s_add_u32 s69, s69, s73
    buffer_load_dwordx4 v[144:147], v9, s[8:11], s68 offen sc1
    buffer_load_dwordx4 v[148:151], v9, s[8:11], s69 offen sc1
    s_add_u32 s75, s75, 1
    s_cmp_eq_u32 s75, 24
    s_cselect_b32 s73, 24576, 0
    s_sub_u32 s73, 1024, s73
    s_add_u32 s68, s68, s73
    s_add_u32 s69, s69, s73
    s_setprio 0
    s_waitcnt vmcnt(34)
    ds_read_b64_tr_b16 v[152:153], v10 offset:9216
    ds_read_b64_tr_b16 v[154:155], v10 offset:10752
    ds_read_b64_tr_b16 v[156:157], v10 offset:9280
    ds_read_b64_tr_b16 v[158:159], v10 offset:10816
    ds_read_b64_tr_b16 v[160:161], v10 offset:9344
    ds_read_b64_tr_b16 v[162:163], v10 offset:10880
    s_waitcnt vmcnt(8)
    s_waitcnt lgkmcnt(4)
    v_mfma_f32_32x32x16_bf16 v[16:31], v[152:155], v[112:115], 0
    v_mfma_f32_32x32x16_bf16 v[64:79], v[152:155], v[116:119], 0
    s_waitcnt vmcnt(31)
    ds_read_b64_tr_b16 v[152:153], v10 offset:12288
    ds_read_b64_tr_b16 v[154:155], v10 offset:13824
    s_waitcnt lgkmcnt(4)
    v_mfma_f32_32x32x16_bf16 v[32:47], v[156:159], v[112:115], 0
    v_mfma_f32_32x32x16_bf16 v[80:95], v[156:159], v[116:119], 0
    ds_read_b64_tr_b16 v[156:157], v10 offset:12352
    ds_read_b64_tr_b16 v[158:159], v10 offset:13888
    s_waitcnt lgkmcnt(4)
    v_mfma_f32_32x32x16_bf16 v[48:63], v[160:163], v[112:115], 0
    v_mfma_f32_32x32x16_bf16 v[96:111], v[160:163], v[116:119], 0
    ds_read_b64_tr_b16 v[160:161], v10 offset:12416
    ds_read_b64_tr_b16 v[162:163], v10 offset:13952
    s_waitcnt vmcnt(6)
    s_waitcnt lgkmcnt(4)
    v_mfma_f32_32x32x16_bf16 v[16:31], v[152:155], v[120:123], v[16:31]
    buffer_load_dwordx4 v[112:115], v9, s[8:11], s68 offen sc1
    v_mfma_f32_32x32x16_bf16 v[64:79], v[152:155], v[124:127], v[64:79]
    buffer_load_dwordx4 v[116:119], v9, s[8:11], s69 offen sc1
    s_add_u32 s75, s75, 1
    s_cmp_eq_u32 s75, 24
    s_cselect_b32 s73, 24576, 0
    s_sub_u32 s73, 1024, s73
    s_add_u32 s68, s68, s73
    s_add_u32 s69, s69, s73
    s_waitcnt vmcnt(30)
    ds_read_b64_tr_b16 v[152:153], v10 offset:15360
    ds_read_b64_tr_b16 v[154:155], v10 offset:16896
    s_waitcnt lgkmcnt(4)
    v_mfma_f32_32x32x16_bf16 v[32:47], v[156:159], v[120:123], v[32:47]
    s_add_u32 m0, s71, 9216
    s_add_u32 s74, s74, 1
    buffer_load_dwordx4 v6, s[64:67], s70 offen offset:0 lds
    v_mfma_f32_32x32x16_bf16 v[80:95], v[156:159], v[124:127], v[80:95]
    buffer_load_dwordx4 v7, s[64:67], s70 offen offset:1024 lds
    ds_read_b64_tr_b16 v[156:157], v10 offset:15424
    ds_read_b64_tr_b16 v[158:159], v10 offset:16960
    s_waitcnt lgkmcnt(4)
    v_mfma_f32_32x32x16_bf16 v[48:63], v[160:163], v[120:123], v[48:63]
    buffer_load_dwordx4 v8, s[64:67], s70 offen offset:2048 lds
    s_cmp_eq_u32 s74, 24
    s_cselect_b32 s73, 491520, 0
    s_add_u32 s70, s70, 20480
    s_sub_u32 s70, s70, s73
    v_mfma_f32_32x32x16_bf16 v[96:111], v[160:163], v[124:127], v[96:111]
    ds_read_b64_tr_b16 v[160:161], v10 offset:15488
    ds_read_b64_tr_b16 v[162:163], v10 offset:17024
    s_waitcnt vmcnt(9)
    s_waitcnt lgkmcnt(4)
    v_mfma_f32_32x32x16_bf16 v[16:31], v[152:155], v[128:131], v[16:31]
    buffer_load_dwordx4 v[120:123], v9, s[8:11], s68 offen sc1
    v_mfma_f32_32x32x16_bf16 v[64:79], v[152:155], v[132:135], v[64:79]
    buffer_load_dwordx4 v[124:127], v9, s[8:11], s69 offen sc1
    s_add_u32 s75, s75, 1
    s_cmp_eq_u32 s75, 24
    s_cselect_b32 s73, 24576, 0
    s_sub_u32 s73, 1024, s73
    s_add_u32 s68, s68, s73
    s_add_u32 s69, s69, s73
    s_waitcnt vmcnt(32)
    ds_read_b64_tr_b16 v[152:153], v10 offset:18432
    ds_read_b64_tr_b16 v[154:155], v10 offset:19968
    s_waitcnt lgkmcnt(4)
    v_mfma_f32_32x32x16_bf16 v[32:47], v[156:159], v[128:131], v[32:47]
    s_add_u32 m0, s71, 12288
    s_add_u32 s74, s74, 1
    buffer_load_dwordx4 v6, s[64:67], s70 offen offset:0 lds
    v_mfma_f32_32x32x16_bf16 v[80:95], v[156:159], v[132:135], v[80:95]
    buffer_load_dwordx4 v7, s[64:67], s70 offen offset:1024 lds
    ds_read_b64_tr_b16 v[156:157], v10 offset:18496
    ds_read_b64_tr_b16 v[158:159], v10 offset:20032
    s_waitcnt lgkmcnt(4)
    v_mfma_f32_32x32x16_bf16 v[48:63], v[160:163], v[128:131], v[48:63]
    buffer_load_dwordx4 v8, s[64:67], s70 offen offset:2048 lds
    s_cmp_eq_u32 s74, 24
    s_cselect_b32 s73, 491520, 0
    s_add_u32 s70, s70, 20480
    s_sub_u32 s70, s70, s73
    v_mfma_f32_32x32x16_bf16 v[96:111], v[160:163], v[132:135], v[96:111]
    ds_read_b64_tr_b16 v[160:161], v10 offset:18560
    ds_read_b64_tr_b16 v[162:163], v10 offset:20096
    s_waitcnt vmcnt(12)
    s_waitcnt lgkmcnt(4)
    v_mfma_f32_32x32x16_bf16 v[16:31], v[152:155], v[136:139], v[16:31]
    buffer_load_dwordx4 v[128:131], v9, s[8:11], s68 offen sc1
    v_mfma_f32_32x32x16_bf16 v[64:79], v[152:155], v[140:143], v[64:79]
    buffer_load_dwordx4 v[132:135], v9, s[8:11], s69 offen sc1
    s_add_u32 s75, s75, 1
    s_cmp_eq_u32 s75, 24
    s_cselect_b32 s73, 24576, 0
    s_sub_u32 s73, 1024, s73
    s_add_u32 s68, s68, s73
    s_add_u32 s69, s69, s73
    s_waitcnt vmcnt(34)
    ds_read_b64_tr_b16 v[152:153], v10 offset:21504
    ds_read_b64_tr_b16 v[154:155], v10 offset:23040
    s_waitcnt lgkmcnt(4)
    v_mfma_f32_32x32x16_bf16 v[32:47], v[156:159], v[136:139], v[32:47]
    s_add_u32 m0, s71, 15360
    s_add_u32 s74, s74, 1
    buffer_load_dwordx4 v6, s[64:67], s70 offen offset:0 lds
    v_mfma_f32_32x32x16_bf16 v[80:95], v[156:159], v[140:143], v[80:95]
    buffer_load_dwordx4 v7, s[64:67], s70 offen offset:1024 lds
    ds_read_b64_tr_b16 v[156:157], v10 offset:21568
    ds_read_b64_tr_b16 v[158:159], v10 offset:23104
    s_waitcnt lgkmcnt(4)
    v_mfma_f32_32x32x16_bf16 v[48:63], v[160:163], v[136:139], v[48:63]
    buffer_load_dwordx4 v8, s[64:67], s70 offen offset:2048 lds
    s_cmp_eq_u32 s74, 24
    s_cselect_b32 s73, 491520, 0
    s_add_u32 s70, s70, 20480
    s_sub_u32 s70, s70, s73
    v_mfma_f32_32x32x16_bf16 v[96:111], v[160:163], v[140:143], v[96:111]
    ds_read_b64_tr_b16 v[160:161], v10 offset:21632
    ds_read_b64_tr_b16 v[162:163], v10 offset:23168
    s_waitcnt vmcnt(15)
    s_waitcnt lgkmcnt(4)
    v_mfma_f32_32x32x16_bf16 v[16:31], v[152:155], v[144:147], v[16:31]
    buffer_load_dwordx4 v[136:139], v9, s[8:11], s68 offen sc1
    v_mfma_f32_32x32x16_bf16 v[64:79], v[152:155], v[148:151], v[64:79]
    buffer_load_dwordx4 v[140:143], v9, s[8:11], s69 offen sc1
    s_add_u32 s75, s75, 1
    s_cmp_eq_u32 s75, 24
    s_cselect_b32 s73, 24576, 0
    s_sub_u32 s73, 1024, s73
    s_add_u32 s68, s68, s73
    s_add_u32 s69, s69, s73
    s_waitcnt vmcnt(36)
    ds_read_b64_tr_b16 v[152:153], v10 offset:24576
    ds_read_b64_tr_b16 v[154:155], v10 offset:26112
    s_waitcnt lgkmcnt(4)
    v_mfma_f32_32x32x16_bf16 v[32:47], v[156:159], v[144:147], v[32:47]
    s_add_u32 m0, s71, 18432
    s_add_u32 s74, s74, 1
    buffer_load_dwordx4 v6, s[64:67], s70 offen offset:0 lds
    v_mfma_f32_32x32x16_bf16 v[80:95], v[156:159], v[148:151], v[80:95]
    buffer_load_dwordx4 v7, s[64:67], s70 offen offset:1024 lds
    ds_read_b64_tr_b16 v[156:157], v10 offset:24640
    ds_read_b64_tr_b16 v[158:159], v10 offset:26176
    s_waitcnt lgkmcnt(4)
    v_mfma_f32_32x32x16_bf16 v[48:63], v[160:163], v[144:147], v[48:63]
    buffer_load_dwordx4 v8, s[64:67], s70 offen offset:2048 lds
    s_cmp_eq_u32 s74, 24
    s_cselect_b32 s73, 491520, 0
    s_add_u32 s70, s70, 20480
    s_sub_u32 s70, s70, s73
    v_mfma_f32_32x32x16_bf16 v[96:111], v[160:163], v[148:151], v[96:111]
    ds_read_b64_tr_b16 v[160:161], v10 offset:24704
    ds_read_b64_tr_b16 v[162:163], v10 offset:26240
    s_waitcnt vmcnt(18)
    s_waitcnt lgkmcnt(4)
    v_mfma_f32_32x32x16_bf16 v[16:31], v[152:155], v[112:115], v[16:31]
    buffer_load_dwordx4 v[144:147], v9, s[8:11], s68 offen sc1
    v_mfma_f32_32x32x16_bf16 v[64:79], v[152:155], v[116:119], v[64:79]
    buffer_load_dwordx4 v[148:151], v9, s[8:11], s69 offen sc1
    s_add_u32 s75, s75, 1
    s_cmp_eq_u32 s75, 24
    s_cselect_b32 s73, 24576, 0
    s_sub_u32 s73, 1024, s73
    s_add_u32 s68, s68, s73
    s_add_u32 s69, s69, s73
    s_waitcnt vmcnt(38)
    ds_read_b64_tr_b16 v[152:153], v10 offset:0
    ds_read_b64_tr_b16 v[154:155], v10 offset:1536
    s_waitcnt lgkmcnt(4)
    v_mfma_f32_32x32x16_bf16 v[32:47], v[156:159], v[112:115], v[32:47]
    s_add_u32 m0, s71, 21504
    s_add_u32 s74, s74, 1
    buffer_load_dwordx4 v6, s[64:67], s70 offen offset:0 lds
    v_mfma_f32_32x32x16_bf16 v[80:95], v[156:159], v[116:119], v[80:95]
    buffer_load_dwordx4 v7, s[64:67], s70 offen offset:1024 lds
    ds_read_b64_tr_b16 v[156:157], v10 offset:64
    ds_read_b64_tr_b16 v[158:159], v10 offset:1600
    s_waitcnt lgkmcnt(4)
    v_mfma_f32_32x32x16_bf16 v[48:63], v[160:163], v[112:115], v[48:63]
    buffer_load_dwordx4 v8, s[64:67], s70 offen offset:2048 lds
    s_cmp_eq_u32 s74, 24
    s_cselect_b32 s73, 491520, 0
    s_add_u32 s70, s70, 20480
    s_sub_u32 s70, s70, s73
    v_mfma_f32_32x32x16_bf16 v[96:111], v[160:163], v[116:119], v[96:111]
    ds_read_b64_tr_b16 v[160:161], v10 offset:128
    ds_read_b64_tr_b16 v[162:163], v10 offset:1664
    s_waitcnt vmcnt(18)
    s_waitcnt lgkmcnt(4)
    v_mfma_f32_32x32x16_bf16 v[16:31], v[152:155], v[120:123], v[16:31]
    buffer_load_dwordx4 v[112:115], v9, s[8:11], s68 offen sc1
    v_mfma_f32_32x32x16_bf16 v[64:79], v[152:155], v[124:127], v[64:79]
    buffer_load_dwordx4 v[116:119], v9, s[8:11], s69 offen sc1
    s_add_u32 s75, s75, 1
    s_cmp_eq_u32 s75, 24
    s_cselect_b32 s73, 24576, 0
    s_sub_u32 s73, 1024, s73
    s_add_u32 s68, s68, s73
    s_add_u32 s69, s69, s73
    s_waitcnt vmcnt(40)
    ds_read_b64_tr_b16 v[152:153], v10 offset:3072
    ds_read_b64_tr_b16 v[154:155], v10 offset:4608
    s_waitcnt lgkmcnt(4)
    v_mfma_f32_32x32x16_bf16 v[32:47], v[156:159], v[120:123], v[32:47]
    s_add_u32 m0, s71, 24576
    s_add_u32 s74, s74, 1
    buffer_load_dwordx4 v6, s[64:67], s70 offen offset:0 lds
    v_mfma_f32_32x32x16_bf16 v[80:95], v[156:159], v[124:127], v[80:95]
    buffer_load_dwordx4 v7, s[64:67], s70 offen offset:1024 lds
    ds_read_b64_tr_b16 v[156:157], v10 offset:3136
    ds_read_b64_tr_b16 v[158:159], v10 offset:4672
    s_waitcnt lgkmcnt(4)
    v_mfma_f32_32x32x16_bf16 v[48:63], v[160:163], v[120:123], v[48:63]
    buffer_load_dwordx4 v8, s[64:67], s70 offen offset:2048 lds
    s_cmp_eq_u32 s74, 24
    s_cselect_b32 s73, 491520, 0
    s_add_u32 s70, s70, 20480
    s_sub_u32 s70, s70, s73
    v_mfma_f32_32x32x16_bf16 v[96:111], v[160:163], v[124:127], v[96:111]
    ds_read_b64_tr_b16 v[160:161], v10 offset:3200
    ds_read_b64_tr_b16 v[162:163], v10 offset:4736
    s_waitcnt vmcnt(18)
    s_waitcnt lgkmcnt(4)
    v_mfma_f32_32x32x16_bf16 v[16:31], v[152:155], v[128:131], v[16:31]
    buffer_load_dwordx4 v[120:123], v9, s[8:11], s68 offen sc1
    v_mfma_f32_32x32x16_bf16 v[64:79], v[152:155], v[132:135], v[64:79]
    buffer_load_dwordx4 v[124:127], v9, s[8:11], s69 offen sc1
    s_add_u32 s75, s75, 1
    s_cmp_eq_u32 s75, 24
    s_cselect_b32 s73, 24576, 0
    s_sub_u32 s73, 1024, s73
    s_add_u32 s68, s68, s73
    s_add_u32 s69, s69, s73
    s_waitcnt vmcnt(42)
    ds_read_b64_tr_b16 v[152:153], v10 offset:6144
    ds_read_b64_tr_b16 v[154:155], v10 offset:7680
    s_waitcnt lgkmcnt(4)
    v_mfma_f32_32x32x16_bf16 v[32:47], v[156:159], v[128:131], v[32:47]
    s_add_u32 m0, s71, 0
    s_add_u32 s74, s74, 1
    buffer_load_dwordx4 v6, s[64:67], s70 offen offset:0 lds
    v_mfma_f32_32x32x16_bf16 v[80:95], v[156:159], v[132:135], v[80:95]
    buffer_load_dwordx4 v7, s[64:67], s70 offen offset:1024 lds
    ds_read_b64_tr_b16 v[156:157], v10 offset:6208
    ds_read_b64_tr_b16 v[158:159], v10 offset:7744
    s_waitcnt lgkmcnt(4)
    v_mfma_f32_32x32x16_bf16 v[48:63], v[160:163], v[128:131], v[48:63]
    buffer_load_dwordx4 v8, s[64:67], s70 offen offset:2048 lds
    s_cmp_eq_u32 s74, 24
    s_cselect_b32 s73, 491520, 0
    s_add_u32 s70, s70, 20480
    s_sub_u32 s70, s70, s73
    v_mfma_f32_32x32x16_bf16 v[96:111], v[160:163], v[132:135], v[96:111]
    ds_read_b64_tr_b16 v[160:161], v10 offset:6272
    ds_read_b64_tr_b16 v[162:163], v10 offset:7808
    s_waitcnt vmcnt(18)
    s_waitcnt lgkmcnt(4)
    v_mfma_f32_32x32x16_bf16 v[16:31], v[152:155], v[136:139], v[16:31]
    buffer_load_dwordx4 v[128:131], v9, s[8:11], s68 offen sc1
    v_mfma_f32_32x32x16_bf16 v[64:79], v[152:155], v[140:143], v[64:79]
    buffer_load_dwordx4 v[132:135], v9, s[8:11], s69 offen sc1
    s_add_u32 s75, s75, 1
    s_cmp_eq_u32 s75, 24
    s_cselect_b32 s73, 24576, 0
    s_sub_u32 s73, 1024, s73
    s_add_u32 s68, s68, s73
    s_add_u32 s69, s69, s73
    s_waitcnt vmcnt(32)
    ds_read_b64_tr_b16 v[152:153], v10 offset:9216
    ds_read_b64_tr_b16 v[154:155], v10 offset:10752
    s_waitcnt lgkmcnt(4)
    v_mfma_f32_32x32x16_bf16 v[32:47], v[156:159], v[136:139], v[32:47]
    s_add_u32 m0, s71, 3072
    s_add_u32 s74, s74, 1
    buffer_load_dwordx4 v6, s[64:67], s70 offen offset:0 lds
    v_mfma_f32_32x32x16_bf16 v[80:95], v[156:159], v[140:143], v[80:95]
    buffer_load_dwordx4 v7, s[64:67], s70 offen offset:1024 lds
    ds_read_b64_tr_b16 v[156:157], v10 offset:9280
    ds_read_b64_tr_b16 v[158:159], v10 offset:10816
    s_waitcnt lgkmcnt(4)
    v_mfma_f32_32x32x16_bf16 v[48:63], v[160:163], v[136:139], v[48:63]
    buffer_load_dwordx4 v8, s[64:67], s70 offen offset:2048 lds
    s_cmp_eq_u32 s74, 24
    s_cselect_b32 s73, 491520, 0
    s_add_u32 s70, s70, 20480
    s_sub_u32 s70, s70, s73
    v_mfma_f32_32x32x16_bf16 v[96:111], v[160:163], v[140:143], v[96:111]
    ds_read_b64_tr_b16 v[160:161], v10 offset:9344
    ds_read_b64_tr_b16 v[162:163], v10 offset:10880
    s_waitcnt vmcnt(18)
    s_waitcnt lgkmcnt(4)
    v_mfma_f32_32x32x16_bf16 v[16:31], v[152:155], v[144:147], v[16:31]
    buffer_load_dwordx4 v[136:139], v9, s[8:11], s68 offen sc1
    v_mfma_f32_32x32x16_bf16 v[64:79], v[152:155], v[148:151], v[64:79]
    buffer_load_dwordx4 v[140:143], v9, s[8:11], s69 offen sc1
    s_add_u32 s75, s75, 1
    s_cmp_eq_u32 s75, 24
    s_cselect_b32 s73, 24576, 0
    s_sub_u32 s73, 1024, s73
    s_add_u32 s68, s68, s73
    s_add_u32 s69, s69, s73
    s_waitcnt vmcnt(32)
    ds_read_b64_tr_b16 v[152:153], v10 offset:12288
    ds_read_b64_tr_b16 v[154:155], v10 offset:13824
    s_waitcnt lgkmcnt(4)
    v_mfma_f32_32x32x16_bf16 v[32:47], v[156:159], v[144:147], v[32:47]
    s_add_u32 m0, s71, 6144
    s_add_u32 s74, s74, 1
    buffer_load_dwordx4 v6, s[64:67], s70 offen offset:0 lds
    v_mfma_f32_32x32x16_bf16 v[80:95], v[156:159], v[148:151], v[80:95]
    buffer_load_dwordx4 v7, s[64:67], s70 offen offset:1024 lds
    ds_read_b64_tr_b16 v[156:157], v10 offset:12352
    ds_read_b64_tr_b16 v[158:159], v10 offset:13888
    s_waitcnt lgkmcnt(4)
    v_mfma_f32_32x32x16_bf16 v[48:63], v[160:163], v[144:147], v[48:63]
    buffer_load_dwordx4 v8, s[64:67], s70 offen offset:2048 lds
    s_cmp_eq_u32 s74, 24
    s_cselect_b32 s73, 491520, 0
    s_add_u32 s70, s70, 20480
    s_sub_u32 s70, s70, s73
    v_mfma_f32_32x32x16_bf16 v[96:111], v[160:163], v[148:151], v[96:111]
    ds_read_b64_tr_b16 v[160:161], v10 offset:12416
    ds_read_b64_tr_b16 v[162:163], v10 offset:13952
    s_waitcnt vmcnt(18)
    s_waitcnt lgkmcnt(4)
    v_mfma_f32_32x32x16_bf16 v[16:31], v[152:155], v[112:115], v[16:31]
    buffer_load_dwordx4 v[144:147], v9, s[8:11], s68 offen sc1
    v_mfma_f32_32x32x16_bf16 v[64:79], v[152:155], v[116:119], v[64:79]
    buffer_load_dwordx4 v[148:151], v9, s[8:11], s69 offen sc1
    s_add_u32 s75, s75, 1
    s_cmp_eq_u32 s75, 24
    s_cselect_b32 s73, 24576, 0
    s_sub_u32 s73, 1024, s73
    s_add_u32 s68, s68, s73
    s_add_u32 s69, s69, s73
    s_waitcnt vmcnt(32)
    ds_read_b64_tr_b16 v[152:153], v10 offset:15360
    ds_read_b64_tr_b16 v[154:155], v10 offset:16896
    s_waitcnt lgkmcnt(4)
    v_mfma_f32_32x32x16_bf16 v[32:47], v[156:159], v[112:115], v[32:47]
    s_add_u32 m0, s71, 9216
    s_add_u32 s74, s74, 1
    buffer_load_dwordx4 v6, s[64:67], s70 offen offset:0 lds
    v_mfma_f32_32x32x16_bf16 v[80:95], v[156:159], v[116:119], v[80:95]
    buffer_load_dwordx4 v7, s[64:67], s70 offen offset:1024 lds
    ds_read_b64_tr_b16 v[156:157], v10 offset:15424
    ds_read_b64_tr_b16 v[158:159], v10 offset:16960
    s_waitcnt lgkmcnt(4)
    v_mfma_f32_32x32x16_bf16 v[48:63], v[160:163], v[112:115], v[48:63]
    buffer_load_dwordx4 v8, s[64:67], s70 offen offset:2048 lds
    s_cmp_eq_u32 s74, 24
    s_cselect_b32 s73, 491520, 0
    s_add_u32 s70, s70, 20480
    s_sub_u32 s70, s70, s73
    v_mfma_f32_32x32x16_bf16 v[96:111], v[160:163], v[116:119], v[96:111]
    ds_read_b64_tr_b16 v[160:161], v10 offset:15488
    ds_read_b64_tr_b16 v[162:163], v10 offset:17024
    s_waitcnt vmcnt(18)
    s_waitcnt lgkmcnt(4)
    v_mfma_f32_32x32x16_bf16 v[16:31], v[152:155], v[120:123], v[16:31]
    buffer_load_dwordx4 v[112:115], v9, s[8:11], s68 offen sc1
    v_mfma_f32_32x32x16_bf16 v[64:79], v[152:155], v[124:127], v[64:79]
    buffer_load_dwordx4 v[116:119], v9, s[8:11], s69 offen sc1
    s_add_u32 s75, s75, 1
    s_cmp_eq_u32 s75, 24
    s_cselect_b32 s73, 24576, 0
    s_sub_u32 s73, 1024, s73
    s_add_u32 s68, s68, s73
    s_add_u32 s69, s69, s73
    s_waitcnt vmcnt(32)
    ds_read_b64_tr_b16 v[152:153], v10 offset:18432
    ds_read_b64_tr_b16 v[154:155], v10 offset:19968
    s_waitcnt lgkmcnt(4)
    v_mfma_f32_32x32x16_bf16 v[32:47], v[156:159], v[120:123], v[32:47]
    s_add_u32 m0, s71, 12288
    s_add_u32 s74, s74, 1
    buffer_load_dwordx4 v6, s[64:67], s70 offen offset:0 lds
    v_mfma_f32_32x32x16_bf16 v[80:95], v[156:159], v[124:127], v[80:95]
    buffer_load_dwordx4 v7, s[64:67], s70 offen offset:1024 lds
    ds_read_b64_tr_b16 v[156:157], v10 offset:18496
    ds_read_b64_tr_b16 v[158:159], v10 offset:20032
    s_waitcnt lgkmcnt(4)
    v_mfma_f32_32x32x16_bf16 v[48:63], v[160:163], v[120:123], v[48:63]
    buffer_load_dwordx4 v8, s[64:67], s70 offen offset:2048 lds
    s_cmp_eq_u32 s74, 24
    s_cselect_b32 s73, 491520, 0
    s_add_u32 s70, s70, 20480
    s_sub_u32 s70, s70, s73
    v_mfma_f32_32x32x16_bf16 v[96:111], v[160:163], v[124:127], v[96:111]
    ds_read_b64_tr_b16 v[160:161], v10 offset:18560
    ds_read_b64_tr_b16 v[162:163], v10 offset:20096
    s_waitcnt vmcnt(18)
    s_waitcnt lgkmcnt(4)
    v_mfma_f32_32x32x16_bf16 v[16:31], v[152:155], v[128:131], v[16:31]
    buffer_load_dwordx4 v[120:123], v9, s[8:11], s68 offen sc1
    v_mfma_f32_32x32x16_bf16 v[64:79], v[152:155], v[132:135], v[64:79]
    buffer_load_dwordx4 v[124:127], v9, s[8:11], s69 offen sc1
    s_add_u32 s75, s75, 1
    s_cmp_eq_u32 s75, 24
    s_cselect_b32 s73, 24576, 0
    s_sub_u32 s73, 1024, s73
    s_add_u32 s68, s68, s73
    s_add_u32 s69, s69, s73
    s_waitcnt vmcnt(32)
    ds_read_b64_tr_b16 v[152:153], v10 offset:21504
    ds_read_b64_tr_b16 v[154:155], v10 offset:23040
    s_waitcnt lgkmcnt(4)
    v_mfma_f32_32x32x16_bf16 v[32:47], v[156:159], v[128:131], v[32:47]
    s_add_u32 m0, s71, 15360
    s_add_u32 s74, s74, 1
    buffer_load_dwordx4 v6, s[64:67], s70 offen offset:0 lds
    v_mfma_f32_32x32x16_bf16 v[80:95], v[156:159], v[132:135], v[80:95]
    buffer_load_dwordx4 v7, s[64:67], s70 offen offset:1024 lds
    ds_read_b64_tr_b16 v[156:157], v10 offset:21568
    ds_read_b64_tr_b16 v[158:159], v10 offset:23104
    s_waitcnt lgkmcnt(4)
    v_mfma_f32_32x32x16_bf16 v[48:63], v[160:163], v[128:131], v[48:63]
    buffer_load_dwordx4 v8, s[64:67], s70 offen offset:2048 lds
    s_cmp_eq_u32 s74, 24
    s_cselect_b32 s73, 491520, 0
    s_add_u32 s70, s70, 20480
    s_sub_u32 s70, s70, s73
    v_mfma_f32_32x32x16_bf16 v[96:111], v[160:163], v[132:135], v[96:111]
    ds_read_b64_tr_b16 v[160:161], v10 offset:21632
    ds_read_b64_tr_b16 v[162:163], v10 offset:23168
    s_waitcnt vmcnt(18)
    s_waitcnt lgkmcnt(4)
    v_mfma_f32_32x32x16_bf16 v[16:31], v[152:155], v[136:139], v[16:31]
    buffer_load_dwordx4 v[128:131], v9, s[8:11], s68 offen sc1
    v_mfma_f32_32x32x16_bf16 v[64:79], v[152:155], v[140:143], v[64:79]
    buffer_load_dwordx4 v[132:135], v9, s[8:11], s69 offen sc1
    s_add_u32 s75, s75, 1
    s_cmp_eq_u32 s75, 24
    s_cselect_b32 s73, 24576, 0
    s_sub_u32 s73, 1024, s73
    s_add_u32 s68, s68, s73
    s_add_u32 s69, s69, s73
    s_waitcnt vmcnt(32)
    ds_read_b64_tr_b16 v[152:153], v10 offset:24576
    ds_read_b64_tr_b16 v[154:155], v10 offset:26112
    s_waitcnt lgkmcnt(4)
    v_mfma_f32_32x32x16_bf16 v[32:47], v[156:159], v[136:139], v[32:47]
    s_add_u32 m0, s71, 18432
    s_add_u32 s74, s74, 1
    buffer_load_dwordx4 v6, s[64:67], s70 offen offset:0 lds
    v_mfma_f32_32x32x16_bf16 v[80:95], v[156:159], v[140:143], v[80:95]
    buffer_load_dwordx4 v7, s[64:67], s70 offen offset:1024 lds
    ds_read_b64_tr_b16 v[156:157], v10 offset:24640
    ds_read_b64_tr_b16 v[158:159], v10 offset:26176
    s_waitcnt lgkmcnt(4)
    v_mfma_f32_32x32x16_bf16 v[48:63], v[160:163], v[136:139], v[48:63]
    buffer_load_dwordx4 v8, s[64:67], s70 offen offset:2048 lds
    s_cmp_eq_u32 s74, 24
    s_cselect_b32 s73, 491520, 0
    s_add_u32 s70, s70, 20480
    s_sub_u32 s70, s70, s73
    v_mfma_f32_32x32x16_bf16 v[96:111], v[160:163], v[140:143], v[96:111]
    ds_read_b64_tr_b16 v[160:161], v10 offset:24704
    ds_read_b64_tr_b16 v[162:163], v10 offset:26240
    s_waitcnt vmcnt(18)
    s_waitcnt lgkmcnt(4)
    v_mfma_f32_32x32x16_bf16 v[16:31], v[152:155], v[144:147], v[16:31]
    buffer_load_dwordx4 v[136:139], v9, s[8:11], s68 offen sc1
    v_mfma_f32_32x32x16_bf16 v[64:79], v[152:155], v[148:151], v[64:79]
    buffer_load_dwordx4 v[140:143], v9, s[8:11], s69 offen sc1
    s_add_u32 s75, s75, 1
    s_cmp_eq_u32 s75, 24
    s_cselect_b32 s73, 24576, 0
    s_sub_u32 s73, 1024, s73
    s_add_u32 s68, s68, s73
    s_add_u32 s69, s69, s73
    s_waitcnt vmcnt(32)
    ds_read_b64_tr_b16 v[152:153], v10 offset:0
    ds_read_b64_tr_b16 v[154:155], v10 offset:1536
    s_waitcnt lgkmcnt(4)
    v_mfma_f32_32x32x16_bf16 v[32:47], v[156:159], v[144:147], v[32:47]
    s_add_u32 m0, s71, 21504
    s_add_u32 s74, s74, 1
    buffer_load_dwordx4 v6, s[64:67], s70 offen offset:0 lds
    v_mfma_f32_32x32x16_bf16 v[80:95], v[156:159], v[148:151], v[80:95]
    buffer_load_dwordx4 v7, s[64:67], s70 offen offset:1024 lds
    ds_read_b64_tr_b16 v[156:157], v10 offset:64
    ds_read_b64_tr_b16 v[158:159], v10 offset:1600
    s_waitcnt lgkmcnt(4)
    v_mfma_f32_32x32x16_bf16 v[48:63], v[160:163], v[144:147], v[48:63]
    buffer_load_dwordx4 v8, s[64:67], s70 offen offset:2048 lds
    s_cmp_eq_u32 s74, 24
    s_cselect_b32 s73, 491520, 0
    s_add_u32 s70, s70, 20480
    s_sub_u32 s70, s70, s73
    v_mfma_f32_32x32x16_bf16 v[96:111], v[160:163], v[148:151], v[96:111]
    ds_read_b64_tr_b16 v[160:161], v10 offset:128
    ds_read_b64_tr_b16 v[162:163], v10 offset:1664
    s_waitcnt vmcnt(18)
    s_waitcnt lgkmcnt(4)
    v_mfma_f32_32x32x16_bf16 v[16:31], v[152:155], v[112:115], v[16:31]
    buffer_load_dwordx4 v[144:147], v9, s[8:11], s68 offen sc1
    v_mfma_f32_32x32x16_bf16 v[64:79], v[152:155], v[116:119], v[64:79]
    buffer_load_dwordx4 v[148:151], v9, s[8:11], s69 offen sc1
    s_add_u32 s75, s75, 1
    s_cmp_eq_u32 s75, 24
    s_cselect_b32 s73, 24576, 0
    s_sub_u32 s73, 1024, s73
    s_add_u32 s68, s68, s73
    s_add_u32 s69, s69, s73
    s_waitcnt vmcnt(32)
    ds_read_b64_tr_b16 v[152:153], v10 offset:3072
    ds_read_b64_tr_b16 v[154:155], v10 offset:4608
    s_waitcnt lgkmcnt(4)
    v_mfma_f32_32x32x16_bf16 v[32:47], v[156:159], v[112:115], v[32:47]
    s_add_u32 m0, s71, 24576
    s_add_u32 s74, s74, 1
    buffer_load_dwordx4 v6, s[64:67], s70 offen offset:0 lds
    v_mfma_f32_32x32x16_bf16 v[80:95], v[156:159], v[116:119], v[80:95]
    buffer_load_dwordx4 v7, s[64:67], s70 offen offset:1024 lds
    ds_read_b64_tr_b16 v[156:157], v10 offset:3136
    ds_read_b64_tr_b16 v[158:159], v10 offset:4672
    s_waitcnt lgkmcnt(4)
    v_mfma_f32_32x32x16_bf16 v[48:63], v[160:163], v[112:115], v[48:63]
    buffer_load_dwordx4 v8, s[64:67], s70 offen offset:2048 lds
    s_cmp_eq_u32 s74, 24
    s_cselect_b32 s73, 491520, 0
    s_add_u32 s70, s70, 20480
    s_sub_u32 s70, s70, s73
    v_mfma_f32_32x32x16_bf16 v[96:111], v[160:163], v[116:119], v[96:111]
    ds_read_b64_tr_b16 v[160:161], v10 offset:3200
    ds_read_b64_tr_b16 v[162:163], v10 offset:4736
    s_waitcnt vmcnt(18)
    s_waitcnt lgkmcnt(4)
    v_mfma_f32_32x32x16_bf16 v[16:31], v[152:155], v[120:123], v[16:31]
    buffer_load_dwordx4 v[112:115], v9, s[8:11], s68 offen sc1
    v_mfma_f32_32x32x16_bf16 v[64:79], v[152:155], v[124:127], v[64:79]
    buffer_load_dwordx4 v[116:119], v9, s[8:11], s69 offen sc1
    s_add_u32 s75, s75, 1
    s_cmp_eq_u32 s75, 24
    s_cselect_b32 s73, 24576, 0
    s_sub_u32 s73, 1024, s73
    s_add_u32 s68, s68, s73
    s_add_u32 s69, s69, s73
    s_waitcnt vmcnt(32)
    ds_read_b64_tr_b16 v[152:153], v10 offset:6144
    ds_read_b64_tr_b16 v[154:155], v10 offset:7680
    s_waitcnt lgkmcnt(4)
    v_mfma_f32_32x32x16_bf16 v[32:47], v[156:159], v[120:123], v[32:47]
    s_add_u32 m0, s71, 0
    s_add_u32 s73, s77, 0
    buffer_load_dwordx4 v6, s[24:27], s73 offen offset:0 lds
    v_mfma_f32_32x32x16_bf16 v[80:95], v[156:159], v[124:127], v[80:95]
    buffer_load_dwordx4 v7, s[24:27], s73 offen offset:1024 lds
    ds_read_b64_tr_b16 v[156:157], v10 offset:6208
    ds_read_b64_tr_b16 v[158:159], v10 offset:7744
    s_waitcnt lgkmcnt(4)
    v_mfma_f32_32x32x16_bf16 v[48:63], v[160:163], v[120:123], v[48:63]
    buffer_load_dwordx4 v8, s[24:27], s73 offen offset:2048 lds
    v_mfma_f32_32x32x16_bf16 v[96:111], v[160:163], v[124:127], v[96:111]
    ds_read_b64_tr_b16 v[160:161], v10 offset:6272
    ds_read_b64_tr_b16 v[162:163], v10 offset:7808
    s_waitcnt vmcnt(18)
    s_waitcnt lgkmcnt(4)
    v_mfma_f32_32x32x16_bf16 v[16:31], v[152:155], v[128:131], v[16:31]
    buffer_load_dwordx4 v[120:123], v9, s[8:11], s68 offen sc1
    v_mfma_f32_32x32x16_bf16 v[64:79], v[152:155], v[132:135], v[64:79]
    buffer_load_dwordx4 v[124:127], v9, s[8:11], s69 offen sc1
    s_add_u32 s75, s75, 1
    s_cmp_eq_u32 s75, 24
    s_cselect_b32 s73, 24576, 0
    s_sub_u32 s73, 1024, s73
    s_add_u32 s68, s68, s73
    s_add_u32 s69, s69, s73
    s_waitcnt vmcnt(32)
    ds_read_b64_tr_b16 v[152:153], v10 offset:9216
    ds_read_b64_tr_b16 v[154:155], v10 offset:10752
    s_waitcnt lgkmcnt(4)
    v_mfma_f32_32x32x16_bf16 v[32:47], v[156:159], v[128:131], v[32:47]
    s_add_u32 m0, s71, 3072
    s_add_u32 s73, s77, 20480
    buffer_load_dwordx4 v6, s[24:27], s73 offen offset:0 lds
    v_mfma_f32_32x32x16_bf16 v[80:95], v[156:159], v[132:135], v[80:95]
    buffer_load_dwordx4 v7, s[24:27], s73 offen offset:1024 lds
    ds_read_b64_tr_b16 v[156:157], v10 offset:9280
    ds_read_b64_tr_b16 v[158:159], v10 offset:10816
    s_waitcnt lgkmcnt(4)
    v_mfma_f32_32x32x16_bf16 v[48:63], v[160:163], v[128:131], v[48:63]
    buffer_load_dwordx4 v8, s[24:27], s73 offen offset:2048 lds
    v_mfma_f32_32x32x16_bf16 v[96:111], v[160:163], v[132:135], v[96:111]
    ds_read_b64_tr_b16 v[160:161], v10 offset:9344
    ds_read_b64_tr_b16 v[162:163], v10 offset:10880
    s_waitcnt vmcnt(18)
    s_waitcnt lgkmcnt(4)
    v_mfma_f32_32x32x16_bf16 v[16:31], v[152:155], v[136:139], v[16:31]
    buffer_load_dwordx4 v[128:131], v9, s[8:11], s68 offen sc1
    v_mfma_f32_32x32x16_bf16 v[64:79], v[152:155], v[140:143], v[64:79]
    buffer_load_dwordx4 v[132:135], v9, s[8:11], s69 offen sc1
    s_add_u32 s75, s75, 1
    s_cmp_eq_u32 s75, 24
    s_cselect_b32 s73, 24576, 0
    s_sub_u32 s73, 1024, s73
    s_add_u32 s68, s68, s73
    s_add_u32 s69, s69, s73
    s_waitcnt vmcnt(32)
    ds_read_b64_tr_b16 v[152:153], v10 offset:12288
    ds_read_b64_tr_b16 v[154:155], v10 offset:13824
    s_waitcnt lgkmcnt(4)
    v_mfma_f32_32x32x16_bf16 v[32:47], v[156:159], v[136:139], v[32:47]
    s_add_u32 m0, s71, 6144
    s_add_u32 s73, s77, 40960
    buffer_load_dwordx4 v6, s[24:27], s73 offen offset:0 lds
    v_mfma_f32_32x32x16_bf16 v[80:95], v[156:159], v[140:143], v[80:95]
    buffer_load_dwordx4 v7, s[24:27], s73 offen offset:1024 lds
    ds_read_b64_tr_b16 v[156:157], v10 offset:12352
    ds_read_b64_tr_b16 v[158:159], v10 offset:13888
    s_waitcnt lgkmcnt(4)
    v_mfma_f32_32x32x16_bf16 v[48:63], v[160:163], v[136:139], v[48:63]
    buffer_load_dwordx4 v8, s[24:27], s73 offen offset:2048 lds
    v_mfma_f32_32x32x16_bf16 v[96:111], v[160:163], v[140:143], v[96:111]
    ds_read_b64_tr_b16 v[160:161], v10 offset:12416
    ds_read_b64_tr_b16 v[162:163], v10 offset:13952
    s_waitcnt vmcnt(18)
    s_waitcnt lgkmcnt(4)
    v_mfma_f32_32x32x16_bf16 v[16:31], v[152:155], v[144:147], v[16:31]
    buffer_load_dwordx4 v[136:139], v9, s[8:11], s68 offen sc1
    v_mfma_f32_32x32x16_bf16 v[64:79], v[152:155], v[148:151], v[64:79]
    buffer_load_dwordx4 v[140:143], v9, s[8:11], s69 offen sc1
    s_add_u32 s75, s75, 1
    s_cmp_eq_u32 s75, 24
    s_cselect_b32 s73, 24576, 0
    s_sub_u32 s73, 1024, s73
    s_add_u32 s68, s68, s73
    s_add_u32 s69, s69, s73
    s_waitcnt vmcnt(32)
    ds_read_b64_tr_b16 v[152:153], v10 offset:15360
    ds_read_b64_tr_b16 v[154:155], v10 offset:16896
    s_waitcnt lgkmcnt(4)
    v_mfma_f32_32x32x16_bf16 v[32:47], v[156:159], v[144:147], v[32:47]
    s_add_u32 m0, s71, 9216
    s_add_u32 s73, s77, 61440
    buffer_load_dwordx4 v6, s[24:27], s73 offen offset:0 lds
    v_mfma_f32_32x32x16_bf16 v[80:95], v[156:159], v[148:151], v[80:95]
    buffer_load_dwordx4 v7, s[24:27], s73 offen offset:1024 lds
    ds_read_b64_tr_b16 v[156:157], v10 offset:15424
    ds_read_b64_tr_b16 v[158:159], v10 offset:16960
    s_waitcnt lgkmcnt(4)
    v_mfma_f32_32x32x16_bf16 v[48:63], v[160:163], v[144:147], v[48:63]
    buffer_load_dwordx4 v8, s[24:27], s73 offen offset:2048 lds
    v_mfma_f32_32x32x16_bf16 v[96:111], v[160:163], v[148:151], v[96:111]
    ds_read_b64_tr_b16 v[160:161], v10 offset:15488
    ds_read_b64_tr_b16 v[162:163], v10 offset:17024
    s_waitcnt vmcnt(18)
    s_waitcnt lgkmcnt(4)
    v_mfma_f32_32x32x16_bf16 v[16:31], v[152:155], v[112:115], v[16:31]
    s_add_u32 m0, s71, 12288
    s_add_u32 s73, s77, 81920
    buffer_load_dwordx4 v6, s[24:27], s73 offen offset:0 lds
    v_mfma_f32_32x32x16_bf16 v[64:79], v[152:155], v[116:119], v[64:79]
    buffer_load_dwordx4 v7, s[24:27], s73 offen offset:1024 lds
    s_waitcnt vmcnt(32)
    ds_read_b64_tr_b16 v[152:153], v10 offset:18432
    ds_read_b64_tr_b16 v[154:155], v10 offset:19968
    s_waitcnt lgkmcnt(4)
    v_mfma_f32_32x32x16_bf16 v[32:47], v[156:159], v[112:115], v[32:47]
    buffer_load_dwordx4 v8, s[24:27], s73 offen offset:2048 lds
    v_mfma_f32_32x32x16_bf16 v[80:95], v[156:159], v[116:119], v[80:95]
    ds_read_b64_tr_b16 v[156:157], v10 offset:18496
    ds_read_b64_tr_b16 v[158:159], v10 offset:20032
    s_waitcnt lgkmcnt(4)
    v_mfma_f32_32x32x16_bf16 v[48:63], v[160:163], v[112:115], v[48:63]
    v_mfma_f32_32x32x16_bf16 v[96:111], v[160:163], v[116:119], v[96:111]
    ds_read_b64_tr_b16 v[160:161], v10 offset:18560
    ds_read_b64_tr_b16 v[162:163], v10 offset:20096
    s_waitcnt vmcnt(16)
    s_waitcnt lgkmcnt(4)
    v_mfma_f32_32x32x16_bf16 v[16:31], v[152:155], v[120:123], v[16:31]
    s_add_u32 m0, s71, 15360
    s_add_u32 s73, s77, 102400
    buffer_load_dwordx4 v6, s[24:27], s73 offen offset:0 lds
    v_mfma_f32_32x32x16_bf16 v[64:79], v[152:155], v[124:127], v[64:79]
    buffer_load_dwordx4 v7, s[24:27], s73 offen offset:1024 lds
    s_waitcnt vmcnt(30)
    ds_read_b64_tr_b16 v[152:153], v10 offset:21504
    ds_read_b64_tr_b16 v[154:155], v10 offset:23040
    s_waitcnt lgkmcnt(4)
    v_mfma_f32_32x32x16_bf16 v[32:47], v[156:159], v[120:123], v[32:47]
    buffer_load_dwordx4 v8, s[24:27], s73 offen offset:2048 lds
    v_mfma_f32_32x32x16_bf16 v[80:95], v[156:159], v[124:127], v[80:95]
    ds_read_b64_tr_b16 v[156:157], v10 offset:21568
    ds_read_b64_tr_b16 v[158:159], v10 offset:23104
    s_waitcnt lgkmcnt(4)
    v_mfma_f32_32x32x16_bf16 v[48:63], v[160:163], v[120:123], v[48:63]
    v_mfma_f32_32x32x16_bf16 v[96:111], v[160:163], v[124:127], v[96:111]
    ds_read_b64_tr_b16 v[160:161], v10 offset:21632
    ds_read_b64_tr_b16 v[162:163], v10 offset:23168
    s_waitcnt vmcnt(14)
    s_waitcnt lgkmcnt(4)
    v_mfma_f32_32x32x16_bf16 v[16:31], v[152:155], v[128:131], v[16:31]
    s_add_u32 m0, s71, 18432
    s_add_u32 s73, s77, 122880
    buffer_load_dwordx4 v6, s[24:27], s73 offen offset:0 lds
    v_mfma_f32_32x32x16_bf16 v[64:79], v[152:155], v[132:135], v[64:79]
    buffer_load_dwordx4 v7, s[24:27], s73 offen offset:1024 lds
    s_waitcnt vmcnt(28)
    ds_read_b64_tr_b16 v[152:153], v10 offset:24576
    ds_read_b64_tr_b16 v[154:155], v10 offset:26112
    s_waitcnt lgkmcnt(4)
    v_mfma_f32_32x32x16_bf16 v[32:47], v[156:159], v[128:131], v[32:47]
    buffer_load_dwordx4 v8, s[24:27], s73 offen offset:2048 lds
    v_mfma_f32_32x32x16_bf16 v[80:95], v[156:159], v[132:135], v[80:95]
    ds_read_b64_tr_b16 v[156:157], v10 offset:24640
    ds_read_b64_tr_b16 v[158:159], v10 offset:26176
    s_waitcnt lgkmcnt(4)
    v_mfma_f32_32x32x16_bf16 v[48:63], v[160:163], v[128:131], v[48:63]
    v_mfma_f32_32x32x16_bf16 v[96:111], v[160:163], v[132:135], v[96:111]
    ds_read_b64_tr_b16 v[160:161], v10 offset:24704
    ds_read_b64_tr_b16 v[162:163], v10 offset:26240
    s_waitcnt vmcnt(12)
    s_waitcnt lgkmcnt(4)
    v_mfma_f32_32x32x16_bf16 v[16:31], v[152:155], v[136:139], v[16:31]
    s_add_u32 m0, s71, 21504
    s_add_u32 s73, s77, 143360
    buffer_load_dwordx4 v6, s[24:27], s73 offen offset:0 lds
    v_mfma_f32_32x32x16_bf16 v[64:79], v[152:155], v[140:143], v[64:79]
    buffer_load_dwordx4 v7, s[24:27], s73 offen offset:1024 lds
    s_waitcnt lgkmcnt(2)
    v_mfma_f32_32x32x16_bf16 v[32:47], v[156:159], v[136:139], v[32:47]
    buffer_load_dwordx4 v8, s[24:27], s73 offen offset:2048 lds
    v_mfma_f32_32x32x16_bf16 v[80:95], v[156:159], v[140:143], v[80:95]
    s_waitcnt lgkmcnt(0)
    v_mfma_f32_32x32x16_bf16 v[48:63], v[160:163], v[136:139], v[48:63]
    v_mfma_f32_32x32x16_bf16 v[96:111], v[160:163], v[140:143], v[96:111]
    s_add_u32 m0, s71, 24576
    s_add_u32 s73, s77, 163840
    buffer_load_dwordx4 v6, s[24:27], s73 offen offset:0 lds
    buffer_load_dwordx4 v7, s[24:27], s73 offen offset:1024 lds
    buffer_load_dwordx4 v8, s[24:27], s73 offen offset:2048 lds
    s_mul_i32 s76, s61, 81920
    s_add_u32 s76, s76, 12582912
    s_lshl_b32 s72, s50, 11
    s_add_u32 s69, s76, s72
    s_add_u32 s69, s69, 32768
    s_lshl_b32 s72, s50, 13
    s_add_u32 s68, s76, s72
    s_add_u32 s74, s68, 40960
    s_add_u32 s75, s69, 40960
    s_setprio 3
    s_cmp_lg_u32 s50, 0
    s_cbranch_scc1 op_75
    v_mov_b32 v152, 163780
lw_76:
    ds_read_b32 v4, v152
    s_waitcnt lgkmcnt(0)
    v_readfirstlane_b32 s41, v4
    s_cmp_ge_u32 s41, 8
    s_cbranch_scc1 lw_77
    s_sleep 8
    s_branch lw_76
lw_77:
    s_lshl_b32 s40, s61, 12
    s_add_u32 s40, s40, 46235648
    s_mov_b32 s41, 0
    s_mov_b32 exec_hi, 0
fpoll_78:
    buffer_load_dword v4, v5, s[8:11], s40 offen sc1
    s_waitcnt vmcnt(0)
fchk_80:
    v_cmp_ne_u32 vcc, s84, v4
    s_add_u32 s41, s41, 1
    s_nop 3
    s_cbranch_vccz fdone_79
    s_sleep 8
    s_cmp_lt_u32 s41, 0x40000
    s_cbranch_scc1 fpoll_78
fdone_79:
    s_mov_b64 exec, -1
    s_cmp_lg_u32 s2, 0
    s_cbranch_scc1 gen_81
    v_mov_b32_e64 v4, s84
    s_mov_b32 s40, 46366720
    s_mov_b64 exec, 1
    buffer_store_dword v4, v5, s[8:11], s40 offen
    s_mov_b64 exec, -1
gen_81:
op_75:
    s_waitcnt vmcnt(0)
    s_mov_b64 exec, 1
    ds_add_u32 v2, v3
    s_mov_b64 exec, -1
    s_add_u32 s48, s48, 4
poll_82:
    ds_read_b32 v4, v2
    s_waitcnt lgkmcnt(0)
    v_readfirstlane_b32 s49, v4
    s_cmp_ge_u32 s49, s48
    s_cbranch_scc1 polldone_83
    s_sleep 1
    s_branch poll_82
polldone_83:
    buffer_load_dwordx4 v[112:115], v9, s[8:11], s68 offen offset:0 sc1
    buffer_load_dwordx4 v[116:119], v9, s[8:11], s74 offen offset:0 sc1
    buffer_load_dwordx4 v[120:123], v9, s[8:11], s68 offen offset:1024 sc1
    buffer_load_dwordx4 v[124:127], v9, s[8:11], s74 offen offset:1024 sc1
    buffer_load_dwordx4 v[128:131], v9, s[8:11], s68 offen offset:2048 sc1
    buffer_load_dwordx4 v[132:135], v9, s[8:11], s74 offen offset:2048 sc1
    buffer_load_dwordx4 v[136:139], v9, s[8:11], s68 offen offset:3072 sc1
    buffer_load_dwordx4 v[140:143], v9, s[8:11], s74 offen offset:3072 sc1
    buffer_load_dwordx2 v[144:145], v14, s[8:11], s69 offen offset:0 sc1
    buffer_load_dwordx2 v[146:147], v14, s[8:11], s69 offen offset:256 sc1
    buffer_load_dwordx2 v[148:149], v14, s[8:11], s75 offen offset:0 sc1
    buffer_load_dwordx2 v[150:151], v14, s[8:11], s75 offen offset:256 sc1
    s_add_u32 s68, s68, 4096
    s_add_u32 s74, s74, 4096
    ds_read_b64_tr_b16 v[152:153], v10 offset:0
    ds_read_b64_tr_b16 v[154:155], v10 offset:1536
    ds_read_b64_tr_b16 v[156:157], v10 offset:64
    ds_read_b64_tr_b16 v[158:159], v10 offset:1600
    ds_read_b64_tr_b16 v[160:161], v10 offset:128
    ds_read_b64_tr_b16 v[162:163], v10 offset:1664
    s_waitcnt vmcnt(10)
    s_waitcnt lgkmcnt(4)
    v_mfma_f32_32x32x16_bf16 v[16:31], v[152:155], v[112:115], v[16:31]
    v_mfma_f32_32x32x16_bf16 v[64:79], v[152:155], v[116:119], v[64:79]
    ds_read_b64_tr_b16 v[152:153], v10 offset:3840
    ds_read_b64_tr_b16 v[154:155], v10 offset:5376
    s_waitcnt lgkmcnt(4)
    v_mfma_f32_32x32x16_bf16 v[32:47], v[156:159], v[112:115], v[32:47]
    v_mfma_f32_32x32x16_bf16 v[80:95], v[156:159], v[116:119], v[80:95]
    ds_read_b64_tr_b16 v[156:157], v10 offset:3904
    ds_read_b64_tr_b16 v[158:159], v10 offset:5440
    s_waitcnt lgkmcnt(4)
    v_mfma_f32_32x32x16_bf16 v[48:63], v[160:163], v[112:115], v[48:63]
    v_mfma_f32_32x32x16_bf16 v[96:111], v[160:163], v[116:119], v[96:111]
    ds_read_b64_tr_b16 v[160:161], v10 offset:3968
    ds_read_b64_tr_b16 v[162:163], v10 offset:5504
    s_add_u32 m0, s71, 0
    s_add_u32 s73, s77, 184320
    buffer_load_dwordx4 v6, s[24:27], s73 offen offset:0 lds
    buffer_load_dwordx4 v7, s[24:27], s73 offen offset:1024 lds
    buffer_load_dwordx4 v8, s[24:27], s73 offen offset:2048 lds
    buffer_load_dwordx4 v[112:115], v9, s[8:11], s68 offen offset:0 sc1
    buffer_load_dwordx4 v[116:119], v9, s[8:11], s74 offen offset:0 sc1
    s_waitcnt vmcnt(13)
    s_waitcnt lgkmcnt(4)
    v_mfma_f32_32x32x16_bf16 v[16:31], v[152:155], v[120:123], v[16:31]
    v_mfma_f32_32x32x16_bf16 v[64:79], v[152:155], v[124:127], v[64:79]
    ds_read_b64_tr_b16 v[152:153], v10 offset:7680
    ds_read_b64_tr_b16 v[154:155], v10 offset:9216
    s_waitcnt lgkmcnt(4)
    v_mfma_f32_32x32x16_bf16 v[32:47], v[156:159], v[120:123], v[32:47]
    v_mfma_f32_32x32x16_bf16 v[80:95], v[156:159], v[124:127], v[80:95]
    ds_read_b64_tr_b16 v[156:157], v10 offset:7744
    ds_read_b64_tr_b16 v[158:159], v10 offset:9280
    s_waitcnt lgkmcnt(4)
    v_mfma_f32_32x32x16_bf16 v[48:63], v[160:163], v[120:123], v[48:63]
    v_mfma_f32_32x32x16_bf16 v[96:111], v[160:163], v[124:127], v[96:111]
    ds_read_b64_tr_b16 v[160:161], v10 offset:7808
    ds_read_b64_tr_b16 v[162:163], v10 offset:9344
    buffer_load_dwordx4 v[120:123], v9, s[8:11], s68 offen offset:1024 sc1
    buffer_load_dwordx4 v[124:127], v9, s[8:11], s74 offen offset:1024 sc1
    s_waitcnt vmcnt(13)
    s_waitcnt lgkmcnt(4)
    v_mfma_f32_32x32x16_bf16 v[16:31], v[152:155], v[128:131], v[16:31]
    v_mfma_f32_32x32x16_bf16 v[64:79], v[152:155], v[132:135], v[64:79]
    ds_read_b64_tr_b16 v[152:153], v10 offset:11520
    ds_read_b64_tr_b16 v[154:155], v10 offset:13056
    s_waitcnt lgkmcnt(4)
    v_mfma_f32_32x32x16_bf16 v[32:47], v[156:159], v[128:131], v[32:47]
    v_mfma_f32_32x32x16_bf16 v[80:95], v[156:159], v[132:135], v[80:95]
    ds_read_b64_tr_b16 v[156:157], v10 offset:11584
    ds_read_b64_tr_b16 v[158:159], v10 offset:13120
    s_waitcnt lgkmcnt(4)
    v_mfma_f32_32x32x16_bf16 v[48:63], v[160:163], v[128:131], v[48:63]
    v_mfma_f32_32x32x16_bf16 v[96:111], v[160:163], v[132:135], v[96:111]
    ds_read_b64_tr_b16 v[160:161], v10 offset:11648
    ds_read_b64_tr_b16 v[162:163], v10 offset:13184
    buffer_load_dwordx4 v[128:131], v9, s[8:11], s68 offen offset:2048 sc1
    buffer_load_dwordx4 v[132:135], v9, s[8:11], s74 offen offset:2048 sc1
    s_waitcnt vmcnt(13)
    s_waitcnt lgkmcnt(4)
    v_mfma_f32_32x32x16_bf16 v[16:31], v[152:155], v[136:139], v[16:31]
    v_mfma_f32_32x32x16_bf16 v[64:79], v[152:155], v[140:143], v[64:79]
    ds_read_b64_tr_b16 v[152:153], v11 offset:3072
    ds_read_b64_tr_b16 v[154:155], v11 offset:6912
    s_waitcnt lgkmcnt(4)
    v_mfma_f32_32x32x16_bf16 v[32:47], v[156:159], v[136:139], v[32:47]
    v_mfma_f32_32x32x16_bf16 v[80:95], v[156:159], v[140:143], v[80:95]
    ds_read_b64_tr_b16 v[156:157], v11 offset:3136
    ds_read_b64_tr_b16 v[158:159], v11 offset:6976
    s_waitcnt lgkmcnt(4)
    v_mfma_f32_32x32x16_bf16 v[48:63], v[160:163], v[136:139], v[48:63]
    v_mfma_f32_32x32x16_bf16 v[96:111], v[160:163], v[140:143], v[96:111]
    ds_read_b64_tr_b16 v[160:161], v11 offset:3200
    ds_read_b64_tr_b16 v[162:163], v11 offset:7040
    buffer_load_dwordx4 v[136:139], v9, s[8:11], s68 offen offset:3072 sc1
    buffer_load_dwordx4 v[140:143], v9, s[8:11], s74 offen offset:3072 sc1
    s_waitcnt vmcnt(11)
    s_waitcnt lgkmcnt(4)
    v_mfma_f32_32x32x16_bf16 v[16:31], v[152:155], v[144:147], v[16:31]
    v_mfma_f32_32x32x16_bf16 v[64:79], v[152:155], v[148:151], v[64:79]
    ds_read_b64_tr_b16 v[152:153], v10 offset:15360
    ds_read_b64_tr_b16 v[154:155], v10 offset:16896
    s_waitcnt lgkmcnt(4)
    v_mfma_f32_32x32x16_bf16 v[32:47], v[156:159], v[144:147], v[32:47]
    v_mfma_f32_32x32x16_bf16 v[80:95], v[156:159], v[148:151], v[80:95]
    ds_read_b64_tr_b16 v[156:157], v10 offset:15424
    ds_read_b64_tr_b16 v[158:159], v10 offset:16960
    s_waitcnt lgkmcnt(4)
    v_mfma_f32_32x32x16_bf16 v[48:63], v[160:163], v[144:147], v[48:63]
    v_mfma_f32_32x32x16_bf16 v[96:111], v[160:163], v[148:151], v[96:111]
    ds_read_b64_tr_b16 v[160:161], v10 offset:15488
    ds_read_b64_tr_b16 v[162:163], v10 offset:17024
    buffer_load_dwordx2 v[144:145], v14, s[8:11], s69 offen offset:1024 sc1
    buffer_load_dwordx2 v[146:147], v14, s[8:11], s69 offen offset:1280 sc1
    buffer_load_dwordx2 v[148:149], v14, s[8:11], s75 offen offset:1024 sc1
    buffer_load_dwordx2 v[150:151], v14, s[8:11], s75 offen offset:1280 sc1
    s_waitcnt vmcnt(10)
    s_waitcnt lgkmcnt(4)
    v_mfma_f32_32x32x16_bf16 v[16:31], v[152:155], v[112:115], v[16:31]
    v_mfma_f32_32x32x16_bf16 v[64:79], v[152:155], v[116:119], v[64:79]
    ds_read_b64_tr_b16 v[152:153], v10 offset:19200
    ds_read_b64_tr_b16 v[154:155], v10 offset:20736
    s_waitcnt lgkmcnt(4)
    v_mfma_f32_32x32x16_bf16 v[32:47], v[156:159], v[112:115], v[32:47]
    v_mfma_f32_32x32x16_bf16 v[80:95], v[156:159], v[116:119], v[80:95]
    ds_read_b64_tr_b16 v[156:157], v10 offset:19264
    ds_read_b64_tr_b16 v[158:159], v10 offset:20800
    s_waitcnt lgkmcnt(4)
    v_mfma_f32_32x32x16_bf16 v[48:63], v[160:163], v[112:115], v[48:63]
    v_mfma_f32_32x32x16_bf16 v[96:111], v[160:163], v[116:119], v[96:111]
    ds_read_b64_tr_b16 v[160:161], v10 offset:19328
    ds_read_b64_tr_b16 v[162:163], v10 offset:20864
    s_waitcnt vmcnt(8)
    s_waitcnt lgkmcnt(4)
    v_mfma_f32_32x32x16_bf16 v[16:31], v[152:155], v[120:123], v[16:31]
    v_mfma_f32_32x32x16_bf16 v[64:79], v[152:155], v[124:127], v[64:79]
    ds_read_b64_tr_b16 v[152:153], v10 offset:23040
    ds_read_b64_tr_b16 v[154:155], v10 offset:24576
    s_waitcnt lgkmcnt(4)
    v_mfma_f32_32x32x16_bf16 v[32:47], v[156:159], v[120:123], v[32:47]
    v_mfma_f32_32x32x16_bf16 v[80:95], v[156:159], v[124:127], v[80:95]
    ds_read_b64_tr_b16 v[156:157], v10 offset:23104
    ds_read_b64_tr_b16 v[158:159], v10 offset:24640
    s_waitcnt lgkmcnt(4)
    v_mfma_f32_32x32x16_bf16 v[48:63], v[160:163], v[120:123], v[48:63]
    v_mfma_f32_32x32x16_bf16 v[96:111], v[160:163], v[124:127], v[96:111]
    ds_read_b64_tr_b16 v[160:161], v10 offset:23168
    ds_read_b64_tr_b16 v[162:163], v10 offset:24704
    s_mul_i32 s72, s61, 81920
    s_mul_i32 s73, s62, 160
    s_add_u32 s72, s72, s73
    buffer_load_dwordx2 v[112:113], v13, s[16:19], s72 offen offset:0
    buffer_load_dwordx2 v[114:115], v13, s[16:19], s72 offen offset:32
    buffer_load_dwordx2 v[116:117], v13, s[16:19], s72 offen offset:64
    buffer_load_dwordx2 v[118:119], v13, s[16:19], s72 offen offset:96
    buffer_load_dwordx2 v[120:121], v13, s[16:19], s72 offen offset:128
    s_waitcnt vmcnt(11)
    s_waitcnt lgkmcnt(4)
    v_mfma_f32_32x32x16_bf16 v[16:31], v[152:155], v[128:131], v[16:31]
    v_mfma_f32_32x32x16_bf16 v[64:79], v[152:155], v[132:135], v[64:79]
    s_waitcnt vmcnt(17)
    ds_read_b64_tr_b16 v[152:153], v165 offset:26880
    ds_read_b64_tr_b16 v[154:155], v15 offset:28416
    s_waitcnt lgkmcnt(4)
    v_mfma_f32_32x32x16_bf16 v[32:47], v[156:159], v[128:131], v[32:47]
    v_mfma_f32_32x32x16_bf16 v[80:95], v[156:159], v[132:135], v[80:95]
    ds_read_b64_tr_b16 v[156:157], v165 offset:26944
    ds_read_b64_tr_b16 v[158:159], v15 offset:28480
    s_waitcnt lgkmcnt(4)
    v_mfma_f32_32x32x16_bf16 v[48:63], v[160:163], v[128:131], v[48:63]
    v_mfma_f32_32x32x16_bf16 v[96:111], v[160:163], v[132:135], v[96:111]
    ds_read_b64_tr_b16 v[160:161], v165 offset:27008
    ds_read_b64_tr_b16 v[162:163], v15 offset:28544
    s_waitcnt vmcnt(9)
    s_waitcnt lgkmcnt(4)
    v_mfma_f32_32x32x16_bf16 v[16:31], v[152:155], v[136:139], v[16:31]
    v_mfma_f32_32x32x16_bf16 v[64:79], v[152:155], v[140:143], v[64:79]
    ds_read_b64_tr_b16 v[152:153], v11 offset:18432
    ds_read_b64_tr_b16 v[154:155], v164 offset:22272
    s_waitcnt lgkmcnt(4)
    v_mfma_f32_32x32x16_bf16 v[32:47], v[156:159], v[136:139], v[32:47]
    v_mfma_f32_32x32x16_bf16 v[80:95], v[156:159], v[140:143], v[80:95]
    ds_read_b64_tr_b16 v[156:157], v11 offset:18496
    ds_read_b64_tr_b16 v[158:159], v164 offset:22336
    s_waitcnt lgkmcnt(4)
    v_mfma_f32_32x32x16_bf16 v[48:63], v[160:163], v[136:139], v[48:63]
    v_mfma_f32_32x32x16_bf16 v[96:111], v[160:163], v[140:143], v[96:111]
    ds_read_b64_tr_b16 v[160:161], v11 offset:18560
    ds_read_b64_tr_b16 v[162:163], v164 offset:22400
    s_waitcnt vmcnt(5)
    s_waitcnt lgkmcnt(4)
    v_mfma_f32_32x32x16_bf16 v[16:31], v[152:155], v[144:147], v[16:31]
    v_mfma_f32_32x32x16_bf16 v[64:79], v[152:155], v[148:151], v[64:79]
    s_waitcnt lgkmcnt(2)
    v_mfma_f32_32x32x16_bf16 v[32:47], v[156:159], v[144:147], v[32:47]
    v_mfma_f32_32x32x16_bf16 v[80:95], v[156:159], v[148:151], v[80:95]
    s_waitcnt lgkmcnt(0)
    v_mfma_f32_32x32x16_bf16 v[48:63], v[160:163], v[144:147], v[48:63]
    v_mfma_f32_32x32x16_bf16 v[96:111], v[160:163], v[148:151], v[96:111]
    v_and_b32 v153, 31, v1
    v_mul_u32_u24 v152, 336, v153
    v_lshrrev_b32_e64 v153, 5, v1
    v_lshl_add_u32 v152, v153, 4, v152
    v_add_u32_e64 v152, s71, v152
    v_add_u32 v153, 60864, v12
    s_nop 6
    ds_write_b128 v152, v[16:19] offset:0
    ds_write_b128 v152, v[20:23] offset:32
    ds_write_b128 v152, v[24:27] offset:64
    ds_write_b128 v152, v[28:31] offset:96
    ds_write_b128 v152, v[32:35] offset:128
    ds_write_b128 v152, v[36:39] offset:160
    ds_write_b128 v152, v[40:43] offset:192
    ds_write_b128 v152, v[44:47] offset:224
    ds_write_b128 v152, v[48:51] offset:256
    ds_write_b128 v152, v[52:55] offset:288
    ds_write_b128 v152, v[64:67] offset:10752
    ds_write_b128 v152, v[68:71] offset:10784
    ds_write_b128 v152, v[72:75] offset:10816
    ds_write_b128 v152, v[76:79] offset:10848
    ds_write_b128 v152, v[80:83] offset:10880
    ds_write_b128 v152, v[84:87] offset:10912
    ds_write_b128 v152, v[88:91] offset:10944
    ds_write_b128 v152, v[92:95] offset:10976
    ds_write_b128 v152, v[96:99] offset:11008
    ds_write_b128 v152, v[100:103] offset:11040
    s_mov_b64 exec, 1
    ds_add_u32 v2, v3
    s_mov_b64 exec, -1
    s_add_u32 s48, s48, 4
    s_waitcnt vmcnt(0)
    v_lshlrev_b32 v128, 16, v112
    v_and_b32 v129, 0xffff0000, v112
    v_lshlrev_b32_e64 v130, 16, v113
    v_and_b32 v131, 0xffff0000, v113
    v_lshlrev_b32_e64 v132, 16, v114
    v_and_b32 v133, 0xffff0000, v114
    v_lshlrev_b32_e64 v134, 16, v115
    v_and_b32 v135, 0xffff0000, v115
    v_lshlrev_b32_e64 v136, 16, v116
    v_and_b32 v137, 0xffff0000, v116
    v_lshlrev_b32_e64 v138, 16, v117
    v_and_b32 v139, 0xffff0000, v117
    v_lshlrev_b32_e64 v140, 16, v118
    v_and_b32 v141, 0xffff0000, v118
    v_lshlrev_b32_e64 v142, 16, v119
    v_and_b32 v143, 0xffff0000, v119
    v_lshlrev_b32_e64 v144, 16, v120
    v_and_b32 v145, 0xffff0000, v120
    v_lshlrev_b32_e64 v146, 16, v121
    v_and_b32 v147, 0xffff0000, v121
poll_84:
    ds_read_b32 v4, v2
    s_waitcnt lgkmcnt(0)
    v_readfirstlane_b32 s49, v4
    s_cmp_ge_u32 s49, s48
    s_cbranch_scc1 polldone_85
    s_sleep 1
    s_branch poll_84
polldone_85:
    ds_read_b128 v[16:19], v12 offset:0
    ds_read_b128 v[20:23], v12 offset:30432
    ds_read_b128 v[24:27], v153 offset:0
    ds_read_b128 v[28:31], v153 offset:30432
    ds_read_b128 v[32:35], v12 offset:64
    ds_read_b128 v[36:39], v12 offset:30496
    ds_read_b128 v[40:43], v153 offset:64
    ds_read_b128 v[44:47], v153 offset:30496
    ds_read_b128 v[48:51], v12 offset:128
    ds_read_b128 v[52:55], v12 offset:30560
    ds_read_b128 v[56:59], v153 offset:128
    ds_read_b128 v[60:63], v153 offset:30560
    ds_read_b128 v[64:67], v12 offset:192
    ds_read_b128 v[68:71], v12 offset:30624
    ds_read_b128 v[72:75], v153 offset:192
    ds_read_b128 v[76:79], v153 offset:30624
    ds_read_b128 v[80:83], v12 offset:256
    ds_read_b128 v[84:87], v12 offset:30688
    ds_read_b128 v[88:91], v153 offset:256
    ds_read_b128 v[92:95], v153 offset:30688
    s_waitcnt lgkmcnt(15)
    v_add_f32 v16, v16, v20
    v_add_f32 v24, v24, v28
    v_add_f32 v17, v17, v21
    v_add_f32 v25, v25, v29
    v_add_f32 v18, v18, v22
    v_add_f32 v26, v26, v30
    v_add_f32 v19, v19, v23
    v_add_f32 v27, v27, v31
    v_add_f32 v16, v16, v128
    v_add_f32 v17, v17, v129
    v_add_f32 v18, v18, v130
    v_add_f32 v19, v19, v131
    v_add_f32 v16, v16, v24
    v_add_f32 v17, v17, v25
    v_add_f32 v18, v18, v26
    v_add_f32_e64 v19, v19, v27
    v_cvt_pk_bf16_f32 v16, v16, v17
    v_cvt_pk_bf16_f32 v17, v18, v19
    buffer_store_dwordx2 v[16:17], v13, s[28:31], s72 offen offset:0
    s_waitcnt lgkmcnt(12)
    v_add_f32 v32, v32, v36
    v_add_f32 v40, v40, v44
    v_add_f32 v33, v33, v37
    v_add_f32 v41, v41, v45
    v_add_f32 v34, v34, v38
    v_add_f32 v42, v42, v46
    v_add_f32 v35, v35, v39
    v_add_f32 v43, v43, v47
    v_add_f32 v32, v32, v132
    v_add_f32 v33, v33, v133
    v_add_f32 v34, v34, v134
    v_add_f32 v35, v35, v135
    v_add_f32 v32, v32, v40
    v_add_f32 v33, v33, v41
    v_add_f32 v34, v34, v42
    v_add_f32_e64 v35, v35, v43
    v_cvt_pk_bf16_f32 v32, v32, v33
    v_cvt_pk_bf16_f32 v33, v34, v35
    buffer_store_dwordx2 v[32:33], v13, s[28:31], s72 offen offset:32
    s_waitcnt lgkmcnt(8)
    v_add_f32 v48, v48, v52
    v_add_f32 v56, v56, v60
    v_add_f32 v49, v49, v53
    v_add_f32 v57, v57, v61
    v_add_f32 v50, v50, v54
    v_add_f32 v58, v58, v62
    v_add_f32 v51, v51, v55
    v_add_f32 v59, v59, v63
    v_add_f32 v48, v48, v136
    v_add_f32 v49, v49, v137
    v_add_f32 v50, v50, v138
    v_add_f32 v51, v51, v139
    v_add_f32 v48, v48, v56
    v_add_f32 v49, v49, v57
    v_add_f32 v50, v50, v58
    v_add_f32_e64 v51, v51, v59
    v_cvt_pk_bf16_f32 v48, v48, v49
    v_cvt_pk_bf16_f32 v49, v50, v51
    buffer_store_dwordx2 v[48:49], v13, s[28:31], s72 offen offset:64
    s_waitcnt lgkmcnt(4)
    v_add_f32 v64, v64, v68
    v_add_f32 v72, v72, v76
    v_add_f32 v65, v65, v69
    v_add_f32 v73, v73, v77
    v_add_f32 v66, v66, v70
    v_add_f32 v74, v74, v78
    v_add_f32 v67, v67, v71
    v_add_f32 v75, v75, v79
    v_add_f32 v64, v64, v140
    v_add_f32 v65, v65, v141
    v_add_f32 v66, v66, v142
    v_add_f32 v67, v67, v143
    v_add_f32 v64, v64, v72
    v_add_f32 v65, v65, v73
    v_add_f32 v66, v66, v74
    v_add_f32_e64 v67, v67, v75
    v_cvt_pk_bf16_f32 v64, v64, v65
    v_cvt_pk_bf16_f32 v65, v66, v67
    buffer_store_dwordx2 v[64:65], v13, s[28:31], s72 offen offset:96
    s_waitcnt lgkmcnt(0)
    v_add_f32 v80, v80, v84
    v_add_f32 v88, v88, v92
    v_add_f32 v81, v81, v85
    v_add_f32 v89, v89, v93
    v_add_f32 v82, v82, v86
    v_add_f32 v90, v90, v94
    v_add_f32 v83, v83, v87
    v_add_f32 v91, v91, v95
    v_add_f32 v80, v80, v144
    v_add_f32 v81, v81, v145
    v_add_f32 v82, v82, v146
    v_add_f32 v83, v83, v147
    v_add_f32 v80, v80, v88
    v_add_f32 v81, v81, v89
    v_add_f32 v82, v82, v90
    v_add_f32_e64 v83, v83, v91
    v_cvt_pk_bf16_f32 v80, v80, v81
    v_cvt_pk_bf16_f32 v81, v82, v83
    buffer_store_dwordx2 v[80:81], v13, s[28:31], s72 offen offset:128
z_end:
    s_endpgm
.section .rodata,"a"
.p2align 6
.amdhsa_kernel parallel_sum__mha_block__glu_gated_bilinear__prompt_kernel
  .amdhsa_next_free_vgpr 168
  .amdhsa_next_free_sgpr 88
  .amdhsa_accum_offset 168
  .amdhsa_group_segment_fixed_size 0
  .amdhsa_kernarg_size 80
  .amdhsa_user_sgpr_count 2
  .amdhsa_user_sgpr_kernarg_segment_ptr 1
  .amdhsa_system_sgpr_workgroup_id_x 1
.end_amdhsa_kernel
```
